```python
import torch

def _softmax(x, axis=-1):
    return torch.softmax(x, dim=axis)
def _gelu(x):
    return torch.nn.functional.gelu(x, approximate="tanh")
def _silu(x):
    return torch.nn.functional.silu(x)
def _sigmoid(x):
    return torch.sigmoid(x)
def _layernorm(x, axis=-1, eps=1e-5):
    m = x.mean(dim=axis, keepdim=True)
    v = x.var(dim=axis, keepdim=True, unbiased=False)
    return (x - m) / torch.sqrt(v + eps)
def _scatter_add(tgt, idx, src, axis=0):
    return tgt.clone().index_add_(axis, idx, src)
def _segment_sum(src, seg, n):
    out = torch.zeros((n,) + src.shape[1:], dtype=src.dtype)
    return out.index_add_(0, seg, src)
def _pad(x, pw):
    flat = tuple(v for pair in reversed(pw) for v in pair)
    return torch.nn.functional.pad(x, flat)

kernel_name = 'sequential_preLN__ssm_conv_h3__swiglu_ffn__prompt'

def setup_inputs():

    _w = (lambda a: (lambda t: t.to(torch.bfloat16) if t.is_floating_point() else t)(torch.as_tensor(a)))
    def _A_setup():
        B, S, D = 1, 2048, 640
        ks = 4
        return {
            "q": _w((lambda *s: torch.randn(*s, dtype=torch.bfloat16) * 0.05)(B, S, D)),
            "k": _w((lambda *s: torch.randn(*s, dtype=torch.bfloat16) * 0.4)(B, S, D)),
            "v": _w((lambda *s: torch.randn(*s, dtype=torch.bfloat16) * 0.4)(B, S, D)),
            "shift_k": _w((lambda *s: torch.randn(*s, dtype=torch.bfloat16) * 0.4)(D, ks) * 0.5),
            "ssm_k": _w((lambda *s: torch.randn(*s, dtype=torch.bfloat16) * 0.4)(D, S) * (1.0 / S ** 0.5)),
            "ssm_D": _w((lambda *s: torch.randn(*s, dtype=torch.bfloat16) * 0.4)(D)),
        }
    _A_in = _A_setup()

    def _B_setup():
        B, S, D, F = 1, 2048, 640, 1728
        return {
            "x": _w((lambda *s: torch.randn(*s, dtype=torch.bfloat16) * 0.05)(B, S, D)),
            "w_gate": _w((lambda *s: torch.randn(*s, dtype=torch.bfloat16) * 0.05)(D, F)),
            "w_up": _w((lambda *s: torch.randn(*s, dtype=torch.bfloat16) * 0.05)(D, F)),
            "w_down": _w((lambda *s: torch.randn(*s, dtype=torch.bfloat16) * 0.05)(F, D)),
        }
    _B_in = _B_setup()

    return {
        "A_q": _A_in["q"],
        "A_k": _A_in["k"],
        "A_v": _A_in["v"],
        "A_shift_k": _A_in["shift_k"],
        "A_ssm_k": _A_in["ssm_k"],
        "A_ssm_D": _A_in["ssm_D"],
        "B_x": _B_in["x"],
        "B_w_gate": _B_in["w_gate"],
        "B_w_up": _B_in["w_up"],
        "B_w_down": _B_in["w_down"],
    }

def reference(A_q, A_k, A_v, A_shift_k, A_ssm_k, A_ssm_D, B_x, B_w_gate, B_w_up, B_w_down):
    def _A_ref(q, k, v, shift_k, ssm_k, ssm_D):
        B, S, D = q.shape
        ks = shift_k.shape[-1]
        k_pad = _pad(k, ((0, 0), (ks - 1, 0), (0, 0)))
        k_shift = torch.zeros_like(k)
        for t in range(ks):
            k_shift = k_shift + k_pad[:, t:t + S, :] * shift_k[:, ks - 1 - t][None, None, :]
        kv = k_shift * v
        L = 2 * S
        kv_pad = _pad(kv, ((0, 0), (0, S), (0, 0)))
        kf_pad = _pad(ssm_k, ((0, 0), (0, S)))
        kv_f = (lambda x, axes=(-2,-1): torch.fft.rfft2(x.float(), dim=axes))(kv_pad[:, None, :, :], axes=(1, 2))
        kf_f = (lambda x, axes=(-2,-1): torch.fft.rfft2(x.float(), dim=axes))(kf_pad[:, None, :], axes=(1, 2))
        kf_f = (lambda x, *d: x.permute(*d))(kf_f, 1, 2, 0)
        y_f = kv_f * kf_f[None, :, :, :]
        y = (lambda x, s, axes=(-2,-1): torch.fft.irfft2(x, s=s, dim=axes).to(torch.bfloat16))(y_f, (1, L), axes=(1, 2))[:, 0, :S, :]
        y = y + kv * ssm_D[None, None, :]
        return q * y

    def _B_ref(x, w_gate, w_up, w_down):
        g = _silu(x @ w_gate)
        u = x @ w_up
        return (g * u) @ w_down

    x = A_q
    h = x + _A_ref(_layernorm(x, axis=-1), A_k, A_v, A_shift_k, A_ssm_k, A_ssm_D)
    h2 = h + _B_ref(_layernorm(h, axis=-1), B_w_gate, B_w_up, B_w_down)
    return h2
```

```asm
; @launch kernel=sequential_preLN__ssm_conv_h3__swiglu_ffn__prompt_kernel grid=(256,1,1) block=(256,1,1) lds=163840
.amdgcn_target "amdgcn-amd-amdhsa--gfx950"
.text
.globl sequential_preLN__ssm_conv_h3__swiglu_ffn__prompt_kernel
.p2align 8
.type sequential_preLN__ssm_conv_h3__swiglu_ffn__prompt_kernel,@function
sequential_preLN__ssm_conv_h3__swiglu_ffn__prompt_kernel:
    s_cmp_ge_u32 s2, 160
    s_cbranch_scc1 .Lfz_h
    s_load_dwordx4 s[4:7], s[0:1], 8
    s_load_dwordx4 s[8:11], s[0:1], 24
    s_load_dwordx2 s[12:13], s[0:1], 40
    s_load_dwordx4 s[16:19], s[0:1], 88
    s_load_dwordx2 s[94:95], s[0:1], 80
    v_lshrrev_b32 v1, 6, v0
    v_and_b32 v2, 63, v0
    v_readfirstlane_b32 s3, v1
    s_and_b32 s14, s2, 7
    s_lshr_b32 s15, s2, 3
    s_mul_i32 s24, s14, 160
    s_mul_i32 s14, s14, 20
    s_add_u32 s27, s14, s15
    v_lshrrev_b32 v4, 1, v2
    v_and_b32 v5, 1, v2
    v_mul_u32_u24 v5, 156, v5
    v_add_u32 v5, s24, v5
    s_lshl_b32 s25, s15, 2
    s_add_u32 s25, s25, s3
    s_movk_i32 s24, 1280
    v_lshlrev_b32 v3, 4, v2
    s_lshl_b32 s14, s27, 2
    s_add_u32 s14, s14, s3
    s_lshl_b32 s15, s14, 12
    s_lshl_b32 s29, s27, 3
    v_lshrrev_b32 v9, 2, v2
    v_and_b32 v10, 3, v2
    v_lshl_add_u32 v9, v9, 9, v10
    v_mul_u32_u24 v9, 1280, v9
    s_mul_i32 s26, s3, 163840
    s_add_u32 s26, s26, s29
    s_sub_u32 s26, s26, 3840
    v_add_u32 v9, s26, v9
    v_mul_u32_u24 v245, 2560, v0
    v_add_u32 v245, s29, v245
    s_mov_b32 s22, 4096
    s_mov_b32 s23, 0x00020000
    s_mov_b32 s42, 2621440
    s_mov_b32 s43, 0x00020000
    s_lshl_b32 s28, s27, 5
    s_waitcnt lgkmcnt(0)
    s_add_u32 s20, s10, s15
    s_addc_u32 s21, s11, 0
    s_mov_b32 s40, s4
    s_mov_b32 s41, s5
    buffer_load_dwordx4 v[144:147], v3, s[20:23], 0 offen offset:0
    buffer_load_dwordx4 v[148:151], v3, s[20:23], 0 offen offset:1024
    buffer_load_dwordx4 v[152:155], v3, s[20:23], 0 offen offset:2048
    buffer_load_dwordx4 v[156:159], v3, s[20:23], 0 offen offset:3072
    s_mov_b64 exec, 0xffff
    buffer_load_dwordx2 v[250:251], v9, s[40:43], 0 offen
    s_mov_b64 exec, -1
    s_load_dwordx8 s[32:39], s[8:9], s28
    s_load_dwordx2 s[14:15], s[12:13], s29
    global_load_dwordx2 v[112:113], v245, s[4:5] offset:1280
    global_load_dwordx2 v[114:115], v245, s[4:5] offset:0
    global_load_dwordx2 v[116:117], v245, s[6:7] offset:1280
    global_load_dwordx2 v[118:119], v245, s[6:7] offset:0
    s_mul_i32 s26, s25, 20
    s_add_u32 s26, s26, 512
    v_add_u32 v6, s26, v4
    v_min_u32 v6, 0x7ff, v6
    v_mad_u32_u24 v244, v6, s24, v5
    v_add_u32 v246, 655360, v245
    v_add_u32 v247, 1310720, v245
    v_add_u32 v248, 1966080, v245
    s_lshl_b32 s30, s27, 8
    s_add_u32 s30, s30, 8388608
    s_mov_b32 s10, 11018240
    s_mul_i32 s24, s3, 8448
    s_mul_i32 s25, s3, 4608
    s_add_u32 s25, s25, 33792
    s_mov_b32 s26, 0xffff0000
    s_mov_b32 s27, 0x01000504
    s_mov_b32 s28, 0x03020706
    v_mov_b32 v180, 0
    v_mov_b32 v181, 0
    v_mov_b32 v182, 0
    v_mov_b32 v183, 0
    v_add_u32 v8, s25, v3
    v_add_u32 v9, s24, v3
    s_mov_b32 exec_lo, 0x3fffffff
    s_mov_b32 exec_hi, 0
    ds_write_b128 v8, v[180:183] offset:4096
    s_mov_b32 exec_lo, 3
    ds_write_b128 v9, v[180:183]
    ds_write_b128 v9, v[180:183] offset:4160
    s_mov_b64 exec, -1
    v_and_b32 v10, 15, v2
    v_lshrrev_b32 v11, 4, v2
    v_and_b32 v12, 1, v10
    v_xor_b32 v12, 1, v12
    v_mul_u32_u24 v12, 4160, v12
    v_lshrrev_b32 v13, 1, v10
    v_lshl_add_u32 v13, v11, 2, v13
    v_lshl_add_u32 v12, v13, 2, v12
    v_lshrrev_b32 v6, 4, v0
    v_lshl_add_u32 v8, v6, 5, v10
    v_lshlrev_b32 v8, 2, v8
    v_mul_u32_u24 v7, 40960, v6
    v_lshl_add_u32 v7, v10, 4, v7
    s_add_u32 s29, s24, 4
    v_add_u32 v12, s29, v12
    v_add_u32 v13, 1024, v12
    v_add_u32 v14, 2048, v12
    v_add_u32 v15, 3072, v12
    v_lshlrev_b32 v1, 5, v10
    v_lshlrev_b32 v4, 4, v11
    v_sub_u32 v1, v4, v1
    s_add_u32 s29, s25, 480
    v_add_u32 v1, s29, v1
    v_lshlrev_b32 v4, 2, v0
    v_sub_u32 v4, 34812, v4
    v_lshlrev_b32 v5, 3, v11
    v_add_u32 v5, v5, v10
    v_sub_u32 v5, 15, v5
    v_mov_b32 v160, 0
    v_mov_b32 v16, 0
    v_mov_b32 v17, 0
    v_mov_b32 v18, 0
    v_mov_b32 v19, 0
    v_mov_b32 v20, 0
    v_mov_b32 v21, 0
    v_mov_b32 v22, 0
    v_mov_b32 v23, 0
    v_mov_b32 v24, 0
    v_mov_b32 v25, 0
    v_mov_b32 v26, 0
    v_mov_b32 v27, 0
    v_mov_b32 v28, 0
    v_mov_b32 v29, 0
    v_mov_b32 v30, 0
    v_mov_b32 v31, 0
    v_mov_b32 v32, 0
    v_mov_b32 v33, 0
    v_mov_b32 v34, 0
    v_mov_b32 v35, 0
    v_mov_b32 v36, 0
    v_mov_b32 v37, 0
    v_mov_b32 v38, 0
    v_mov_b32 v39, 0
    v_mov_b32 v40, 0
    v_mov_b32 v41, 0
    v_mov_b32 v42, 0
    v_mov_b32 v43, 0
    v_mov_b32 v44, 0
    v_mov_b32 v45, 0
    v_mov_b32 v46, 0
    v_mov_b32 v47, 0
    s_waitcnt vmcnt(8)
    ds_write_b128 v9, v[144:147] offset:32
    v_mov_b32_dpp v160, v147 wave_shr:1 row_mask:0xf bank_mask:0xf
    v_mov_b32_dpp v161, v147 wave_ror:1 row_mask:0xf bank_mask:0xf
    v_alignbit_b32 v165, v145, v144, 16
    v_alignbit_b32 v166, v146, v145, 16
    v_alignbit_b32 v167, v147, v146, 16
    v_alignbit_b32 v164, v144, v160, 16
    ds_write_b128 v9, v[164:167] offset:4192
    s_waitcnt vmcnt(7)
    ds_write_b128 v9, v[148:151] offset:1056
    v_mov_b32_dpp v161, v151 wave_shr:1 row_mask:0xf bank_mask:0xf
    v_mov_b32_dpp v162, v151 wave_ror:1 row_mask:0xf bank_mask:0xf
    v_alignbit_b32 v169, v149, v148, 16
    v_alignbit_b32 v170, v150, v149, 16
    v_alignbit_b32 v171, v151, v150, 16
    v_alignbit_b32 v168, v148, v161, 16
    ds_write_b128 v9, v[168:171] offset:5216
    s_waitcnt vmcnt(6)
    ds_write_b128 v9, v[152:155] offset:2080
    v_mov_b32_dpp v162, v155 wave_shr:1 row_mask:0xf bank_mask:0xf
    v_mov_b32_dpp v163, v155 wave_ror:1 row_mask:0xf bank_mask:0xf
    v_alignbit_b32 v173, v153, v152, 16
    v_alignbit_b32 v174, v154, v153, 16
    v_alignbit_b32 v175, v155, v154, 16
    v_alignbit_b32 v172, v152, v162, 16
    ds_write_b128 v9, v[172:175] offset:6240
    s_waitcnt vmcnt(5)
    ds_write_b128 v9, v[156:159] offset:3104
    v_mov_b32_dpp v163, v159 wave_shr:1 row_mask:0xf bank_mask:0xf
    v_alignbit_b32 v177, v157, v156, 16
    v_alignbit_b32 v178, v158, v157, 16
    v_alignbit_b32 v179, v159, v158, 16
    v_alignbit_b32 v176, v156, v163, 16
    ds_write_b128 v9, v[176:179] offset:7264
    s_mov_b32 s20, s18
    s_mov_b32 s21, s19
    s_mov_b32 s22, 0x10000000
    s_waitcnt lgkmcnt(0)
    ds_read2_b32 a[0:1], v12 offset0:0 offset1:1
    s_lshl_b32 s29, s3, 4
    ds_read2_b32 a[2:3], v12 offset0:2 offset1:3
    s_lshr_b64 s[14:15], s[14:15], s29
    ds_read2_b32 a[4:5], v12 offset0:128 offset1:129
    s_and_b32 s14, s14, 0xffff
    ds_read2_b32 a[6:7], v12 offset0:130 offset1:131
    v_and_b32 v9, 1, v5
    ds_read2_b32 a[8:9], v13 offset0:0 offset1:1
    v_lshlrev_b32 v9, 4, v9
    ds_read2_b32 a[10:11], v13 offset0:2 offset1:3
    v_lshlrev_b32 v9, v9, s14
    ds_read2_b32 a[12:13], v13 offset0:128 offset1:129
    v_ashrrev_i32 v5, 1, v5
    ds_read2_b32 a[14:15], v13 offset0:130 offset1:131
    v_cmp_eq_u32 vcc, 0, v5
    ds_read2_b32 a[16:17], v14 offset0:0 offset1:1
    v_cndmask_b32 v180, 0, v9, vcc
    ds_read2_b32 a[18:19], v14 offset0:2 offset1:3
    v_cmp_eq_u32 vcc, 1, v5
    ds_read2_b32 a[20:21], v14 offset0:128 offset1:129
    v_cndmask_b32 v181, 0, v9, vcc
    ds_read2_b32 a[22:23], v14 offset0:130 offset1:131
    v_cmp_eq_u32 vcc, 2, v5
    ds_read2_b32 a[24:25], v15 offset0:0 offset1:1
    v_cndmask_b32 v182, 0, v9, vcc
    ds_read2_b32 a[26:27], v15 offset0:2 offset1:3
    v_cmp_eq_u32 vcc, 3, v5
    ds_read2_b32 a[28:29], v15 offset0:128 offset1:129
    v_cndmask_b32 v183, 0, v9, vcc
    ds_read2_b32 a[30:31], v15 offset0:130 offset1:131
    v_lshlrev_b32 v5, 6, v10
    s_mov_b32 exec_lo, 0xffffffff
    s_mov_b32 exec_hi, 0xff
    global_load_dword v252, v244, s[4:5]
    global_load_dword v253, v244, s[6:7]
    s_mov_b64 exec, -1
    ds_read2_b32 a[32:33], v12 offset0:16 offset1:17
    v_lshl_add_u32 v5, v11, 4, v5
    ds_read2_b32 a[34:35], v12 offset0:18 offset1:19
    v_add_u32 v11, s24, v5
    ds_read2_b32 a[36:37], v12 offset0:144 offset1:145
    v_lshlrev_b32 v6, 4, v0
    ds_read2_b32 a[38:39], v12 offset0:146 offset1:147
    v_and_b32 v10, 7, v2
    ds_read2_b32 a[40:41], v13 offset0:16 offset1:17
    v_lshlrev_b32 v10, 2, v10
    ds_read2_b32 a[42:43], v13 offset0:18 offset1:19
    v_mov_b32 v212, -1
    ds_read2_b32 a[44:45], v13 offset0:144 offset1:145
    v_mov_b32 v213, -1
    ds_read2_b32 a[46:47], v13 offset0:146 offset1:147
    v_mov_b32 v214, -1
    ds_read2_b32 a[48:49], v14 offset0:16 offset1:17
    v_mov_b32 v215, -1
    ds_read2_b32 a[50:51], v14 offset0:18 offset1:19
    s_waitcnt vmcnt(6)
    ds_read2_b32 a[52:53], v14 offset0:144 offset1:145
    v_readlane_b32 s52, v250, 0
    ds_read2_b32 a[54:55], v14 offset0:146 offset1:147
    v_readlane_b32 s53, v251, 0
    ds_read2_b32 a[56:57], v15 offset0:16 offset1:17
    v_readlane_b32 s54, v250, 1
    ds_read2_b32 a[58:59], v15 offset0:18 offset1:19
    v_readlane_b32 s55, v251, 1
    ds_read2_b32 a[60:61], v15 offset0:144 offset1:145
    v_readlane_b32 s56, v250, 2
    ds_read2_b32 a[62:63], v15 offset0:146 offset1:147
    v_readlane_b32 s57, v251, 2
    ds_read2_b32 a[64:65], v12 offset0:32 offset1:33
    v_readlane_b32 s58, v250, 4
    ds_read2_b32 a[66:67], v12 offset0:34 offset1:35
    v_readlane_b32 s59, v251, 4
    ds_read2_b32 a[68:69], v12 offset0:160 offset1:161
    v_readlane_b32 s60, v250, 5
    ds_read2_b32 a[70:71], v12 offset0:162 offset1:163
    v_readlane_b32 s61, v251, 5
    ds_read2_b32 a[72:73], v13 offset0:32 offset1:33
    v_readlane_b32 s62, v250, 6
    ds_read2_b32 a[74:75], v13 offset0:34 offset1:35
    v_readlane_b32 s63, v251, 6
    ds_read2_b32 a[76:77], v13 offset0:160 offset1:161
    v_readlane_b32 s84, v250, 8
    ds_read2_b32 a[78:79], v13 offset0:162 offset1:163
    v_readlane_b32 s85, v251, 8
    ds_read2_b32 a[80:81], v14 offset0:32 offset1:33
    v_readlane_b32 s86, v250, 9
    ds_read2_b32 a[82:83], v14 offset0:34 offset1:35
    v_readlane_b32 s87, v251, 9
    ds_read2_b32 a[84:85], v14 offset0:160 offset1:161
    v_readlane_b32 s88, v250, 10
    ds_read2_b32 a[86:87], v14 offset0:162 offset1:163
    v_readlane_b32 s89, v251, 10
    ds_read2_b32 a[88:89], v15 offset0:32 offset1:33
    v_readlane_b32 s90, v250, 12
    ds_read2_b32 a[90:91], v15 offset0:34 offset1:35
    v_readlane_b32 s91, v251, 12
    ds_read2_b32 a[92:93], v15 offset0:160 offset1:161
    v_readlane_b32 s92, v250, 13
    ds_read2_b32 a[94:95], v15 offset0:162 offset1:163
    v_readlane_b32 s93, v251, 13
    ds_read2_b32 a[96:97], v12 offset0:48 offset1:49
    v_readlane_b32 s12, v250, 14
    ds_read2_b32 a[98:99], v12 offset0:50 offset1:51
    v_readlane_b32 s13, v251, 14
    ds_read2_b32 a[100:101], v12 offset0:176 offset1:177
    s_lshl_b32 s40, s32, 16
    ds_read2_b32 a[102:103], v12 offset0:178 offset1:179
    s_lshr_b32 s44, s32, 16
    ds_read2_b32 a[104:105], v13 offset0:48 offset1:49
    s_pack_ll_b32_b16 s44, s44, s33
    ds_read2_b32 a[106:107], v13 offset0:50 offset1:51
    s_lshr_b32 s48, s33, 16
    ds_read2_b32 a[108:109], v13 offset0:176 offset1:177
    s_lshl_b32 s41, s34, 16
    ds_read2_b32 a[110:111], v13 offset0:178 offset1:179
    s_lshr_b32 s45, s34, 16
    ds_read2_b32 a[112:113], v14 offset0:48 offset1:49
    s_pack_ll_b32_b16 s45, s45, s35
    ds_read2_b32 a[114:115], v14 offset0:50 offset1:51
    s_lshr_b32 s49, s35, 16
    ds_read2_b32 a[116:117], v14 offset0:176 offset1:177
    s_lshl_b32 s42, s36, 16
    ds_read2_b32 a[118:119], v14 offset0:178 offset1:179
    s_lshr_b32 s46, s36, 16
    ds_read2_b32 a[120:121], v15 offset0:48 offset1:49
    s_pack_ll_b32_b16 s46, s46, s37
    ds_read2_b32 a[122:123], v15 offset0:50 offset1:51
    s_lshr_b32 s50, s37, 16
    ds_read2_b32 a[124:125], v15 offset0:176 offset1:177
    s_lshl_b32 s43, s38, 16
    ds_read2_b32 a[126:127], v15 offset0:178 offset1:179
    s_lshr_b32 s47, s38, 16
    s_pack_ll_b32_b16 s47, s47, s39
    s_lshr_b32 s51, s39, 16
    global_load_dwordx2 v[120:121], v246, s[4:5] offset:1280
    global_load_dwordx2 v[122:123], v246, s[4:5] offset:0
    s_pack_ll_b32_b16 s8, s56, s54
    s_pack_hh_b32_b16 s9, s56, s54
    s_pack_ll_b32_b16 s14, s57, s55
    s_pack_hh_b32_b16 s15, s57, s55
    s_lshr_b32 s54, s52, 16
    s_lshr_b32 s55, s53, 16
    s_waitcnt vmcnt(6)
    v_perm_b32 v184, v112, v114, s27
    v_perm_b32 v185, v112, v114, s28
    v_perm_b32 v186, v113, v115, s27
    v_perm_b32 v187, v113, v115, s28
    v_dot2_f32_bf16 v196, v184, s32, 0
    v_dot2_f32_bf16 v198, v185, s34, 0
    v_dot2_f32_bf16 v200, v186, s36, 0
    v_dot2_f32_bf16 v202, v187, s38, 0
    v_mov_b32_dpp v188, v184 wave_shr:1 row_mask:0xf bank_mask:0xf
    v_mov_b32_dpp v189, v185 wave_shr:1 row_mask:0xf bank_mask:0xf
    v_mov_b32_dpp v190, v186 wave_shr:1 row_mask:0xf bank_mask:0xf
    v_mov_b32_dpp v191, v187 wave_shr:1 row_mask:0xf bank_mask:0xf
    v_writelane_b32 v188, s8, 0
    v_writelane_b32 v189, s9, 0
    v_writelane_b32 v190, s14, 0
    v_writelane_b32 v191, s15, 0
    v_dot2_f32_bf16 v197, v184, s40, 0
    v_dot2_f32_bf16 v199, v185, s41, 0
    v_dot2_f32_bf16 v201, v186, s42, 0
    v_dot2_f32_bf16 v203, v187, s43, 0
    v_mov_b32_dpp v192, v188 wave_shr:1 row_mask:0xf bank_mask:0xf
    v_mov_b32_dpp v193, v189 wave_shr:1 row_mask:0xf bank_mask:0xf
    v_mov_b32_dpp v194, v190 wave_shr:1 row_mask:0xf bank_mask:0xf
    v_mov_b32_dpp v195, v191 wave_shr:1 row_mask:0xf bank_mask:0xf
    v_writelane_b32 v192, s52, 0
    v_writelane_b32 v193, s54, 0
    v_writelane_b32 v194, s53, 0
    v_writelane_b32 v195, s55, 0
    v_dot2_f32_bf16 v196, v188, s33, v196
    v_dot2_f32_bf16 v198, v189, s35, v198
    v_dot2_f32_bf16 v200, v190, s37, v200
    v_dot2_f32_bf16 v202, v191, s39, v202
    v_dot2_f32_bf16 v197, v188, s44, v197
    v_dot2_f32_bf16 v199, v189, s45, v199
    v_dot2_f32_bf16 v201, v190, s46, v201
    v_dot2_f32_bf16 v203, v191, s47, v203
    v_dot2_f32_bf16 v197, v192, s48, v197
    v_dot2_f32_bf16 v199, v193, s49, v199
    v_dot2_f32_bf16 v201, v194, s50, v201
    v_dot2_f32_bf16 v203, v195, s51, v203
    s_waitcnt vmcnt(4)
    v_lshlrev_b32 v204, 16, v116
    v_lshlrev_b32 v205, 16, v118
    v_and_b32 v206, s26, v116
    v_and_b32 v207, s26, v118
    v_lshlrev_b32 v208, 16, v117
    v_lshlrev_b32 v209, 16, v119
    v_and_b32 v210, s26, v117
    v_and_b32 v211, s26, v119
    v_pk_mul_f32 v[196:197], v[196:197], v[204:205]
    v_pk_mul_f32 v[198:199], v[198:199], v[206:207]
    v_pk_mul_f32 v[200:201], v[200:201], v[208:209]
    v_pk_mul_f32 v[202:203], v[202:203], v[210:211]
    v_cvt_pk_bf16_f32 v196, v196, v197
    v_cvt_pk_bf16_f32 v198, v198, v199
    v_cvt_pk_bf16_f32 v200, v200, v201
    v_cvt_pk_bf16_f32 v202, v202, v203
    ds_write_b32 v4, v196 offset:3072
    ds_write_b32 v4, v198 offset:7680
    ds_write_b32 v4, v200 offset:12288
    ds_write_b32 v4, v202 offset:16896
    s_waitcnt lgkmcnt(0)
    s_barrier
    ds_read_b128 v[48:51], v1 offset:3584
    ds_read_b128 v[52:55], v1 offset:3072
    ds_read_b128 v[56:59], v1 offset:3648
    ds_read_b128 v[60:63], v1 offset:3136
    s_waitcnt lgkmcnt(3)
    v_mfma_f32_16x16x32_bf16 v[16:19], v[180:183], v[48:51], v[16:19]
    ds_read_b128 v[64:67], v1 offset:3712
    s_waitcnt lgkmcnt(3)
    v_mfma_f32_16x16x32_bf16 v[20:23], v[180:183], v[52:55], v[20:23]
    ds_read_b128 v[68:71], v1 offset:3200
    v_mfma_f32_16x16x32_bf16 v[16:19], a[0:3], v[48:51], v[16:19]
    ds_read_b128 v[72:75], v1 offset:3776
    v_mfma_f32_16x16x32_bf16 v[20:23], a[4:7], v[48:51], v[20:23]
    ds_read_b128 v[76:79], v1 offset:3264
    global_load_dwordx2 v[124:125], v246, s[6:7] offset:1280
    v_mfma_f32_16x16x32_bf16 v[20:23], a[0:3], v[52:55], v[20:23]
    ds_read2_b32 a[128:129], v12 offset0:64 offset1:65
    v_mfma_f32_16x16x32_bf16 v[24:27], a[8:11], v[48:51], v[24:27]
    ds_read2_b32 a[130:131], v12 offset0:66 offset1:67
    v_mfma_f32_16x16x32_bf16 v[28:31], a[12:15], v[48:51], v[28:31]
    ds_read2_b32 a[132:133], v12 offset0:192 offset1:193
    v_mfma_f32_16x16x32_bf16 v[32:35], a[16:19], v[48:51], v[32:35]
    ds_read2_b32 a[134:135], v12 offset0:194 offset1:195
    v_mfma_f32_16x16x32_bf16 v[36:39], a[20:23], v[48:51], v[36:39]
    ds_read2_b32 a[136:137], v13 offset0:64 offset1:65
    s_add_u32 s29, s30, 0
    buffer_store_dwordx4 v[212:215], v7, s[20:23], s29 offen sc1
    v_mfma_f32_16x16x32_bf16 v[40:43], a[24:27], v[48:51], v[40:43]
    ds_read2_b32 a[138:139], v13 offset0:66 offset1:67
    v_mfma_f32_16x16x32_bf16 v[44:47], a[28:31], v[48:51], v[44:47]
    ds_read2_b32 a[140:141], v13 offset0:192 offset1:193
    v_mfma_f32_16x16x32_bf16 v[24:27], a[4:7], v[52:55], v[24:27]
    ds_read2_b32 a[142:143], v13 offset0:194 offset1:195
    v_mfma_f32_16x16x32_bf16 v[28:31], a[8:11], v[52:55], v[28:31]
    ds_read2_b32 a[144:145], v14 offset0:64 offset1:65
    v_mfma_f32_16x16x32_bf16 v[32:35], a[12:15], v[52:55], v[32:35]
    ds_read2_b32 a[146:147], v14 offset0:66 offset1:67
    v_mfma_f32_16x16x32_bf16 v[36:39], a[16:19], v[52:55], v[36:39]
    ds_read2_b32 a[148:149], v14 offset0:192 offset1:193
    s_add_u32 s29, s30, 655360
    buffer_store_dwordx4 v[212:215], v7, s[20:23], s29 offen sc1
    v_mfma_f32_16x16x32_bf16 v[40:43], a[20:23], v[52:55], v[40:43]
    ds_read2_b32 a[150:151], v14 offset0:194 offset1:195
    v_mfma_f32_16x16x32_bf16 v[44:47], a[24:27], v[52:55], v[44:47]
    ds_read2_b32 a[152:153], v15 offset0:64 offset1:65
    s_waitcnt lgkmcnt(15)
    v_mfma_f32_16x16x32_bf16 v[16:19], a[32:35], v[56:59], v[16:19]
    ds_read2_b32 a[154:155], v15 offset0:66 offset1:67
    v_mfma_f32_16x16x32_bf16 v[20:23], a[36:39], v[56:59], v[20:23]
    ds_read2_b32 a[156:157], v15 offset0:192 offset1:193
    v_mfma_f32_16x16x32_bf16 v[20:23], a[32:35], v[60:63], v[20:23]
    ds_read2_b32 a[158:159], v15 offset0:194 offset1:195
    v_mfma_f32_16x16x32_bf16 v[24:27], a[40:43], v[56:59], v[24:27]
    ds_read_b128 v[80:83], v1 offset:3840
    s_add_u32 s29, s30, 1310720
    buffer_store_dwordx4 v[212:215], v7, s[20:23], s29 offen sc1
    v_mfma_f32_16x16x32_bf16 v[28:31], a[44:47], v[56:59], v[28:31]
    ds_read_b128 v[84:87], v1 offset:3328
    v_mfma_f32_16x16x32_bf16 v[32:35], a[48:51], v[56:59], v[32:35]
    ds_read2_b32 a[160:161], v12 offset0:80 offset1:81
    v_mfma_f32_16x16x32_bf16 v[36:39], a[52:55], v[56:59], v[36:39]
    ds_read2_b32 a[162:163], v12 offset0:82 offset1:83
    v_mfma_f32_16x16x32_bf16 v[40:43], a[56:59], v[56:59], v[40:43]
    ds_read2_b32 a[164:165], v12 offset0:208 offset1:209
    v_mfma_f32_16x16x32_bf16 v[44:47], a[60:63], v[56:59], v[44:47]
    ds_read2_b32 a[166:167], v12 offset0:210 offset1:211
    v_mfma_f32_16x16x32_bf16 v[24:27], a[36:39], v[60:63], v[24:27]
    ds_read2_b32 a[168:169], v13 offset0:80 offset1:81
    s_add_u32 s29, s30, 1966080
    buffer_store_dwordx4 v[212:215], v7, s[20:23], s29 offen sc1
    v_mfma_f32_16x16x32_bf16 v[28:31], a[40:43], v[60:63], v[28:31]
    ds_read2_b32 a[170:171], v13 offset0:82 offset1:83
    v_mfma_f32_16x16x32_bf16 v[32:35], a[44:47], v[60:63], v[32:35]
    ds_read2_b32 a[172:173], v13 offset0:208 offset1:209
    v_mfma_f32_16x16x32_bf16 v[36:39], a[48:51], v[60:63], v[36:39]
    ds_read2_b32 a[174:175], v13 offset0:210 offset1:211
    v_mfma_f32_16x16x32_bf16 v[40:43], a[52:55], v[60:63], v[40:43]
    ds_read2_b32 a[176:177], v14 offset0:80 offset1:81
    v_mfma_f32_16x16x32_bf16 v[44:47], a[56:59], v[60:63], v[44:47]
    ds_read2_b32 a[178:179], v14 offset0:82 offset1:83
    global_load_dwordx2 v[126:127], v246, s[6:7] offset:0
    v_mfma_f32_16x16x32_bf16 v[16:19], a[64:67], v[64:67], v[16:19]
    ds_read2_b32 a[180:181], v14 offset0:208 offset1:209
    v_mfma_f32_16x16x32_bf16 v[20:23], a[68:71], v[64:67], v[20:23]
    ds_read2_b32 a[182:183], v14 offset0:210 offset1:211
    v_mfma_f32_16x16x32_bf16 v[20:23], a[64:67], v[68:71], v[20:23]
    ds_read2_b32 a[184:185], v15 offset0:80 offset1:81
    v_mfma_f32_16x16x32_bf16 v[24:27], a[72:75], v[64:67], v[24:27]
    ds_read2_b32 a[186:187], v15 offset0:82 offset1:83
    v_mfma_f32_16x16x32_bf16 v[28:31], a[76:79], v[64:67], v[28:31]
    ds_read2_b32 a[188:189], v15 offset0:208 offset1:209
    v_mfma_f32_16x16x32_bf16 v[32:35], a[80:83], v[64:67], v[32:35]
    ds_read2_b32 a[190:191], v15 offset0:210 offset1:211
    v_mfma_f32_16x16x32_bf16 v[36:39], a[84:87], v[64:67], v[36:39]
    ds_read_b128 v[88:91], v1 offset:3904
    v_mfma_f32_16x16x32_bf16 v[40:43], a[88:91], v[64:67], v[40:43]
    ds_read_b128 v[92:95], v1 offset:3392
    v_mfma_f32_16x16x32_bf16 v[44:47], a[92:95], v[64:67], v[44:47]
    ds_read2_b32 a[192:193], v12 offset0:96 offset1:97
    v_mfma_f32_16x16x32_bf16 v[24:27], a[68:71], v[68:71], v[24:27]
    ds_read2_b32 a[194:195], v12 offset0:98 offset1:99
    v_mfma_f32_16x16x32_bf16 v[28:31], a[72:75], v[68:71], v[28:31]
    ds_read2_b32 a[196:197], v12 offset0:224 offset1:225
    v_mfma_f32_16x16x32_bf16 v[32:35], a[76:79], v[68:71], v[32:35]
    ds_read2_b32 a[198:199], v12 offset0:226 offset1:227
    v_mfma_f32_16x16x32_bf16 v[36:39], a[80:83], v[68:71], v[36:39]
    ds_read2_b32 a[200:201], v13 offset0:96 offset1:97
    v_mfma_f32_16x16x32_bf16 v[40:43], a[84:87], v[68:71], v[40:43]
    ds_read2_b32 a[202:203], v13 offset0:98 offset1:99
    v_mfma_f32_16x16x32_bf16 v[44:47], a[88:91], v[68:71], v[44:47]
    ds_read2_b32 a[204:205], v13 offset0:224 offset1:225
    s_waitcnt lgkmcnt(15)
    v_mfma_f32_16x16x32_bf16 v[16:19], a[96:99], v[72:75], v[16:19]
    ds_read2_b32 a[206:207], v13 offset0:226 offset1:227
    v_mfma_f32_16x16x32_bf16 v[20:23], a[100:103], v[72:75], v[20:23]
    ds_read2_b32 a[208:209], v14 offset0:96 offset1:97
    v_mfma_f32_16x16x32_bf16 v[20:23], a[96:99], v[76:79], v[20:23]
    ds_read2_b32 a[210:211], v14 offset0:98 offset1:99
    v_mfma_f32_16x16x32_bf16 v[24:27], a[104:107], v[72:75], v[24:27]
    ds_read2_b32 a[212:213], v14 offset0:224 offset1:225
    v_mfma_f32_16x16x32_bf16 v[28:31], a[108:111], v[72:75], v[28:31]
    ds_read2_b32 a[214:215], v14 offset0:226 offset1:227
    v_mfma_f32_16x16x32_bf16 v[32:35], a[112:115], v[72:75], v[32:35]
    ds_read2_b32 a[216:217], v15 offset0:96 offset1:97
    v_mfma_f32_16x16x32_bf16 v[36:39], a[116:119], v[72:75], v[36:39]
    ds_read2_b32 a[218:219], v15 offset0:98 offset1:99
    v_mfma_f32_16x16x32_bf16 v[40:43], a[120:123], v[72:75], v[40:43]
    ds_read2_b32 a[220:221], v15 offset0:224 offset1:225
    v_mfma_f32_16x16x32_bf16 v[44:47], a[124:127], v[72:75], v[44:47]
    ds_read2_b32 a[222:223], v15 offset0:226 offset1:227
    v_mfma_f32_16x16x32_bf16 v[24:27], a[100:103], v[76:79], v[24:27]
    ds_read_b128 v[96:99], v1 offset:3968
    v_mfma_f32_16x16x32_bf16 v[28:31], a[104:107], v[76:79], v[28:31]
    ds_read_b128 v[100:103], v1 offset:3456
    v_mfma_f32_16x16x32_bf16 v[32:35], a[108:111], v[76:79], v[32:35]
    ds_read2_b32 a[224:225], v12 offset0:112 offset1:113
    v_mfma_f32_16x16x32_bf16 v[36:39], a[112:115], v[76:79], v[36:39]
    ds_read2_b32 a[226:227], v12 offset0:114 offset1:115
    global_load_dwordx2 v[128:129], v247, s[4:5] offset:1280
    v_mfma_f32_16x16x32_bf16 v[40:43], a[116:119], v[76:79], v[40:43]
    ds_read2_b32 a[228:229], v12 offset0:240 offset1:241
    v_mfma_f32_16x16x32_bf16 v[44:47], a[120:123], v[76:79], v[44:47]
    ds_read2_b32 a[230:231], v12 offset0:242 offset1:243
    v_mfma_f32_16x16x32_bf16 v[16:19], a[128:131], v[80:83], v[16:19]
    ds_read2_b32 a[232:233], v13 offset0:112 offset1:113
    v_mfma_f32_16x16x32_bf16 v[20:23], a[132:135], v[80:83], v[20:23]
    ds_read2_b32 a[234:235], v13 offset0:114 offset1:115
    v_mfma_f32_16x16x32_bf16 v[20:23], a[128:131], v[84:87], v[20:23]
    ds_read2_b32 a[236:237], v13 offset0:240 offset1:241
    global_load_dword v244, v10, s[16:17]
    v_mfma_f32_16x16x32_bf16 v[24:27], a[136:139], v[80:83], v[24:27]
    ds_read2_b32 a[238:239], v13 offset0:242 offset1:243
    v_mfma_f32_16x16x32_bf16 v[28:31], a[140:143], v[80:83], v[28:31]
    ds_read2_b32 a[240:241], v14 offset0:112 offset1:113
    v_mfma_f32_16x16x32_bf16 v[32:35], a[144:147], v[80:83], v[32:35]
    ds_read2_b32 a[242:243], v14 offset0:114 offset1:115
    v_mfma_f32_16x16x32_bf16 v[36:39], a[148:151], v[80:83], v[36:39]
    ds_read2_b32 a[244:245], v14 offset0:240 offset1:241
    v_mfma_f32_16x16x32_bf16 v[40:43], a[152:155], v[80:83], v[40:43]
    ds_read2_b32 a[246:247], v14 offset0:242 offset1:243
    v_mfma_f32_16x16x32_bf16 v[44:47], a[156:159], v[80:83], v[44:47]
    ds_read2_b32 a[248:249], v15 offset0:112 offset1:113
    v_mfma_f32_16x16x32_bf16 v[24:27], a[132:135], v[84:87], v[24:27]
    ds_read2_b32 a[250:251], v15 offset0:114 offset1:115
    v_mfma_f32_16x16x32_bf16 v[28:31], a[136:139], v[84:87], v[28:31]
    ds_read2_b32 a[252:253], v15 offset0:240 offset1:241
    v_mfma_f32_16x16x32_bf16 v[32:35], a[140:143], v[84:87], v[32:35]
    ds_read2_b32 a[254:255], v15 offset0:242 offset1:243
    v_mfma_f32_16x16x32_bf16 v[36:39], a[144:147], v[84:87], v[36:39]
    ds_read_b128 v[104:107], v1 offset:4032
    v_mfma_f32_16x16x32_bf16 v[40:43], a[148:151], v[84:87], v[40:43]
    ds_read_b128 v[108:111], v1 offset:3520
    v_mfma_f32_16x16x32_bf16 v[44:47], a[152:155], v[84:87], v[44:47]
    s_waitcnt lgkmcnt(15)
    v_mfma_f32_16x16x32_bf16 v[16:19], a[160:163], v[88:91], v[16:19]
    v_mfma_f32_16x16x32_bf16 v[20:23], a[164:167], v[88:91], v[20:23]
    v_mfma_f32_16x16x32_bf16 v[20:23], a[160:163], v[92:95], v[20:23]
    v_mfma_f32_16x16x32_bf16 v[24:27], a[168:171], v[88:91], v[24:27]
    v_mfma_f32_16x16x32_bf16 v[28:31], a[172:175], v[88:91], v[28:31]
    v_mfma_f32_16x16x32_bf16 v[32:35], a[176:179], v[88:91], v[32:35]
    v_mfma_f32_16x16x32_bf16 v[36:39], a[180:183], v[88:91], v[36:39]
    v_mfma_f32_16x16x32_bf16 v[40:43], a[184:187], v[88:91], v[40:43]
    v_mfma_f32_16x16x32_bf16 v[44:47], a[188:191], v[88:91], v[44:47]
    v_mfma_f32_16x16x32_bf16 v[24:27], a[164:167], v[92:95], v[24:27]
    v_mfma_f32_16x16x32_bf16 v[28:31], a[168:171], v[92:95], v[28:31]
    global_load_dwordx2 v[130:131], v247, s[4:5] offset:0
    v_mfma_f32_16x16x32_bf16 v[32:35], a[172:175], v[92:95], v[32:35]
    v_mfma_f32_16x16x32_bf16 v[36:39], a[176:179], v[92:95], v[36:39]
    v_mfma_f32_16x16x32_bf16 v[40:43], a[180:183], v[92:95], v[40:43]
    v_mfma_f32_16x16x32_bf16 v[44:47], a[184:187], v[92:95], v[44:47]
    v_mfma_f32_16x16x32_bf16 v[16:19], a[192:195], v[96:99], v[16:19]
    v_mfma_f32_16x16x32_bf16 v[20:23], a[196:199], v[96:99], v[20:23]
    v_mfma_f32_16x16x32_bf16 v[20:23], a[192:195], v[100:103], v[20:23]
    v_mfma_f32_16x16x32_bf16 v[24:27], a[200:203], v[96:99], v[24:27]
    v_mfma_f32_16x16x32_bf16 v[28:31], a[204:207], v[96:99], v[28:31]
    v_mfma_f32_16x16x32_bf16 v[32:35], a[208:211], v[96:99], v[32:35]
    v_mfma_f32_16x16x32_bf16 v[36:39], a[212:215], v[96:99], v[36:39]
    v_mfma_f32_16x16x32_bf16 v[40:43], a[216:219], v[96:99], v[40:43]
    v_mfma_f32_16x16x32_bf16 v[44:47], a[220:223], v[96:99], v[44:47]
    v_mfma_f32_16x16x32_bf16 v[24:27], a[196:199], v[100:103], v[24:27]
    v_mfma_f32_16x16x32_bf16 v[28:31], a[200:203], v[100:103], v[28:31]
    v_mfma_f32_16x16x32_bf16 v[32:35], a[204:207], v[100:103], v[32:35]
    v_mfma_f32_16x16x32_bf16 v[36:39], a[208:211], v[100:103], v[36:39]
    s_waitcnt vmcnt(1)
    v_cmp_eq_u32 vcc, 0, v244
    s_cbranch_vccnz .rl1
.rl1b:
    s_mul_i32 s29, s3, 640
    s_lshr_b32 s31, s30, 6
    s_add_u32 s29, s29, s31
    s_add_u32 s29, s29, 10883072
    s_mov_b64 exec, 1
    buffer_store_dword v3, off, s[20:23], s29 sc1
    s_mov_b64 exec, -1
    v_mfma_f32_16x16x32_bf16 v[40:43], a[212:215], v[100:103], v[40:43]
    v_mfma_f32_16x16x32_bf16 v[44:47], a[216:219], v[100:103], v[44:47]
    s_waitcnt lgkmcnt(1)
    v_mfma_f32_16x16x32_bf16 v[16:19], a[224:227], v[104:107], v[16:19]
    v_mfma_f32_16x16x32_bf16 v[20:23], a[228:231], v[104:107], v[20:23]
    s_waitcnt lgkmcnt(0)
    v_mfma_f32_16x16x32_bf16 v[20:23], a[224:227], v[108:111], v[20:23]
    v_mfma_f32_16x16x32_bf16 v[24:27], a[232:235], v[104:107], v[24:27]
    v_mfma_f32_16x16x32_bf16 v[28:31], a[236:239], v[104:107], v[28:31]
    v_mfma_f32_16x16x32_bf16 v[32:35], a[240:243], v[104:107], v[32:35]
    v_mfma_f32_16x16x32_bf16 v[36:39], a[244:247], v[104:107], v[36:39]
    v_mfma_f32_16x16x32_bf16 v[40:43], a[248:251], v[104:107], v[40:43]
    v_mfma_f32_16x16x32_bf16 v[44:47], a[252:255], v[104:107], v[44:47]
    global_load_dwordx2 v[132:133], v247, s[6:7] offset:1280
    v_mfma_f32_16x16x32_bf16 v[24:27], a[228:231], v[108:111], v[24:27]
    v_mfma_f32_16x16x32_bf16 v[28:31], a[232:235], v[108:111], v[28:31]
    v_mfma_f32_16x16x32_bf16 v[32:35], a[236:239], v[108:111], v[32:35]
    v_mfma_f32_16x16x32_bf16 v[36:39], a[240:243], v[108:111], v[36:39]
    v_mfma_f32_16x16x32_bf16 v[40:43], a[244:247], v[108:111], v[40:43]
    v_mfma_f32_16x16x32_bf16 v[44:47], a[248:251], v[108:111], v[44:47]
    ds_write_b128 v11, v[16:19] offset:0
    ds_write_b128 v11, v[20:23] offset:1024
    s_pack_ll_b32_b16 s8, s62, s60
    s_pack_hh_b32_b16 s9, s62, s60
    s_pack_ll_b32_b16 s14, s63, s61
    s_pack_hh_b32_b16 s15, s63, s61
    s_lshr_b32 s60, s58, 16
    s_lshr_b32 s61, s59, 16
    v_perm_b32 v184, v120, v122, s27
    v_perm_b32 v185, v120, v122, s28
    v_perm_b32 v186, v121, v123, s27
    v_perm_b32 v187, v121, v123, s28
    v_dot2_f32_bf16 v196, v184, s32, 0
    v_dot2_f32_bf16 v198, v185, s34, 0
    v_dot2_f32_bf16 v200, v186, s36, 0
    v_dot2_f32_bf16 v202, v187, s38, 0
    v_mov_b32_dpp v188, v184 wave_shr:1 row_mask:0xf bank_mask:0xf
    v_mov_b32_dpp v189, v185 wave_shr:1 row_mask:0xf bank_mask:0xf
    v_mov_b32_dpp v190, v186 wave_shr:1 row_mask:0xf bank_mask:0xf
    v_mov_b32_dpp v191, v187 wave_shr:1 row_mask:0xf bank_mask:0xf
    v_writelane_b32 v188, s8, 0
    v_writelane_b32 v189, s9, 0
    v_writelane_b32 v190, s14, 0
    v_writelane_b32 v191, s15, 0
    v_dot2_f32_bf16 v197, v184, s40, 0
    v_dot2_f32_bf16 v199, v185, s41, 0
    v_dot2_f32_bf16 v201, v186, s42, 0
    v_dot2_f32_bf16 v203, v187, s43, 0
    v_mov_b32_dpp v192, v188 wave_shr:1 row_mask:0xf bank_mask:0xf
    v_mov_b32_dpp v193, v189 wave_shr:1 row_mask:0xf bank_mask:0xf
    v_mov_b32_dpp v194, v190 wave_shr:1 row_mask:0xf bank_mask:0xf
    v_mov_b32_dpp v195, v191 wave_shr:1 row_mask:0xf bank_mask:0xf
    v_writelane_b32 v192, s58, 0
    v_writelane_b32 v193, s60, 0
    v_writelane_b32 v194, s59, 0
    v_writelane_b32 v195, s61, 0
    v_dot2_f32_bf16 v196, v188, s33, v196
    v_dot2_f32_bf16 v198, v189, s35, v198
    v_dot2_f32_bf16 v200, v190, s37, v200
    v_dot2_f32_bf16 v202, v191, s39, v202
    v_dot2_f32_bf16 v197, v188, s44, v197
    v_dot2_f32_bf16 v199, v189, s45, v199
    v_dot2_f32_bf16 v201, v190, s46, v201
    v_dot2_f32_bf16 v203, v191, s47, v203
    v_dot2_f32_bf16 v197, v192, s48, v197
    v_dot2_f32_bf16 v199, v193, s49, v199
    v_dot2_f32_bf16 v201, v194, s50, v201
    v_dot2_f32_bf16 v203, v195, s51, v203
    v_lshlrev_b32 v204, 16, v124
    v_lshlrev_b32 v205, 16, v126
    v_and_b32 v206, s26, v124
    v_and_b32 v207, s26, v126
    v_lshlrev_b32 v208, 16, v125
    v_lshlrev_b32 v209, 16, v127
    v_and_b32 v210, s26, v125
    v_and_b32 v211, s26, v127
    v_pk_mul_f32 v[196:197], v[196:197], v[204:205]
    v_pk_mul_f32 v[198:199], v[198:199], v[206:207]
    v_pk_mul_f32 v[200:201], v[200:201], v[208:209]
    v_pk_mul_f32 v[202:203], v[202:203], v[210:211]
    v_cvt_pk_bf16_f32 v196, v196, v197
    v_cvt_pk_bf16_f32 v198, v198, v199
    v_cvt_pk_bf16_f32 v200, v200, v201
    v_cvt_pk_bf16_f32 v202, v202, v203
    ds_write_b32 v4, v196 offset:2048
    ds_write_b32 v4, v198 offset:6656
    ds_write_b32 v4, v200 offset:11264
    ds_write_b32 v4, v202 offset:15872
    s_waitcnt lgkmcnt(0)
    s_barrier
    ds_read_b128 v[48:51], v1 offset:2560
    ds_read_b128 v[52:55], v1 offset:2048
    ds_read_b128 v[56:59], v1 offset:2624
    ds_read_b128 v[60:63], v1 offset:2112
    s_waitcnt lgkmcnt(3)
    v_mfma_f32_16x16x32_bf16 v[24:27], v[180:183], v[48:51], v[24:27]
    ds_read_b128 v[64:67], v1 offset:2688
    v_add_u32 v249, 4096, v6
    s_waitcnt lgkmcnt(3)
    v_mfma_f32_16x16x32_bf16 v[28:31], v[180:183], v[52:55], v[28:31]
    ds_read_b128 v[68:71], v1 offset:2176
    v_add_u32 v250, 8192, v6
    v_mfma_f32_16x16x32_bf16 v[24:27], a[0:3], v[48:51], v[24:27]
    ds_read_b128 v[72:75], v1 offset:2752
    v_add_u32 v251, 12288, v6
    v_mfma_f32_16x16x32_bf16 v[28:31], a[4:7], v[48:51], v[28:31]
    ds_read_b128 v[76:79], v1 offset:2240
    v_mfma_f32_16x16x32_bf16 v[28:31], a[0:3], v[52:55], v[28:31]
    ds_read_b128 v[80:83], v1 offset:2816
    v_mfma_f32_16x16x32_bf16 v[32:35], a[8:11], v[48:51], v[32:35]
    ds_read_b128 v[84:87], v1 offset:2304
    global_load_dwordx2 v[134:135], v247, s[6:7] offset:0
    v_mfma_f32_16x16x32_bf16 v[36:39], a[12:15], v[48:51], v[36:39]
    ds_read_b128 v[88:91], v1 offset:2880
    v_mfma_f32_16x16x32_bf16 v[40:43], a[16:19], v[48:51], v[40:43]
    ds_read_b128 v[92:95], v1 offset:2368
    v_mfma_f32_16x16x32_bf16 v[44:47], a[20:23], v[48:51], v[44:47]
    ds_read_b128 v[96:99], v1 offset:2944
    v_mfma_f32_16x16x32_bf16 v[32:35], a[4:7], v[52:55], v[32:35]
    ds_read_b128 v[100:103], v1 offset:2432
    v_mfma_f32_16x16x32_bf16 v[36:39], a[8:11], v[52:55], v[36:39]
    ds_read_b128 v[104:107], v1 offset:3008
    v_mfma_f32_16x16x32_bf16 v[40:43], a[12:15], v[52:55], v[40:43]
    ds_read_b128 v[108:111], v1 offset:2496
    v_mfma_f32_16x16x32_bf16 v[44:47], a[16:19], v[52:55], v[44:47]
    ds_read_b32 v112, v8 offset:0
    s_waitcnt lgkmcnt(14)
    v_mfma_f32_16x16x32_bf16 v[24:27], a[32:35], v[56:59], v[24:27]
    ds_read_b32 v113, v8 offset:8448
    v_mfma_f32_16x16x32_bf16 v[28:31], a[36:39], v[56:59], v[28:31]
    ds_read_b32 v114, v8 offset:16896
    s_waitcnt lgkmcnt(15)
    v_mfma_f32_16x16x32_bf16 v[28:31], a[32:35], v[60:63], v[28:31]
    ds_read_b32 v115, v8 offset:25344
    v_mfma_f32_16x16x32_bf16 v[32:35], a[40:43], v[56:59], v[32:35]
    ds_read_b32 v116, v8 offset:64
    v_mfma_f32_16x16x32_bf16 v[36:39], a[44:47], v[56:59], v[36:39]
    ds_read_b32 v117, v8 offset:8512
    v_mfma_f32_16x16x32_bf16 v[40:43], a[48:51], v[56:59], v[40:43]
    ds_read_b32 v118, v8 offset:16960
    v_mfma_f32_16x16x32_bf16 v[44:47], a[52:55], v[56:59], v[44:47]
    ds_read_b32 v119, v8 offset:25408
    v_mfma_f32_16x16x32_bf16 v[32:35], a[36:39], v[60:63], v[32:35]
    v_mfma_f32_16x16x32_bf16 v[36:39], a[40:43], v[60:63], v[36:39]
    v_mfma_f32_16x16x32_bf16 v[40:43], a[44:47], v[60:63], v[40:43]
    v_mfma_f32_16x16x32_bf16 v[44:47], a[48:51], v[60:63], v[44:47]
    s_waitcnt lgkmcnt(15)
    v_mfma_f32_16x16x32_bf16 v[24:27], a[64:67], v[64:67], v[24:27]
    v_mfma_f32_16x16x32_bf16 v[28:31], a[68:71], v[64:67], v[28:31]
    v_mfma_f32_16x16x32_bf16 v[28:31], a[64:67], v[68:71], v[28:31]
    v_mfma_f32_16x16x32_bf16 v[32:35], a[72:75], v[64:67], v[32:35]
    v_mfma_f32_16x16x32_bf16 v[36:39], a[76:79], v[64:67], v[36:39]
    v_mfma_f32_16x16x32_bf16 v[40:43], a[80:83], v[64:67], v[40:43]
    v_mfma_f32_16x16x32_bf16 v[44:47], a[84:87], v[64:67], v[44:47]
    v_mfma_f32_16x16x32_bf16 v[32:35], a[68:71], v[68:71], v[32:35]
    v_mfma_f32_16x16x32_bf16 v[36:39], a[72:75], v[68:71], v[36:39]
    v_mfma_f32_16x16x32_bf16 v[40:43], a[76:79], v[68:71], v[40:43]
    global_load_dwordx2 v[136:137], v248, s[4:5] offset:1280
    v_mfma_f32_16x16x32_bf16 v[44:47], a[80:83], v[68:71], v[44:47]
    v_mfma_f32_16x16x32_bf16 v[24:27], a[96:99], v[72:75], v[24:27]
    v_mfma_f32_16x16x32_bf16 v[28:31], a[100:103], v[72:75], v[28:31]
    v_mfma_f32_16x16x32_bf16 v[28:31], a[96:99], v[76:79], v[28:31]
    v_mfma_f32_16x16x32_bf16 v[32:35], a[104:107], v[72:75], v[32:35]
    v_mfma_f32_16x16x32_bf16 v[36:39], a[108:111], v[72:75], v[36:39]
    v_mfma_f32_16x16x32_bf16 v[40:43], a[112:115], v[72:75], v[40:43]
    v_mfma_f32_16x16x32_bf16 v[44:47], a[116:119], v[72:75], v[44:47]
    v_mfma_f32_16x16x32_bf16 v[32:35], a[100:103], v[76:79], v[32:35]
    v_mfma_f32_16x16x32_bf16 v[36:39], a[104:107], v[76:79], v[36:39]
    v_mfma_f32_16x16x32_bf16 v[40:43], a[108:111], v[76:79], v[40:43]
    v_mfma_f32_16x16x32_bf16 v[44:47], a[112:115], v[76:79], v[44:47]
    v_mfma_f32_16x16x32_bf16 v[24:27], a[128:131], v[80:83], v[24:27]
    v_mfma_f32_16x16x32_bf16 v[28:31], a[132:135], v[80:83], v[28:31]
    s_waitcnt lgkmcnt(14)
    v_mfma_f32_16x16x32_bf16 v[28:31], a[128:131], v[84:87], v[28:31]
    v_mfma_f32_16x16x32_bf16 v[32:35], a[136:139], v[80:83], v[32:35]
    v_mfma_f32_16x16x32_bf16 v[36:39], a[140:143], v[80:83], v[36:39]
    v_mfma_f32_16x16x32_bf16 v[40:43], a[144:147], v[80:83], v[40:43]
    v_mfma_f32_16x16x32_bf16 v[44:47], a[148:151], v[80:83], v[44:47]
    v_mfma_f32_16x16x32_bf16 v[32:35], a[132:135], v[84:87], v[32:35]
    v_mfma_f32_16x16x32_bf16 v[36:39], a[136:139], v[84:87], v[36:39]
    v_mfma_f32_16x16x32_bf16 v[40:43], a[140:143], v[84:87], v[40:43]
    v_mfma_f32_16x16x32_bf16 v[44:47], a[144:147], v[84:87], v[44:47]
    s_waitcnt lgkmcnt(13)
    v_mfma_f32_16x16x32_bf16 v[24:27], a[160:163], v[88:91], v[24:27]
    v_mfma_f32_16x16x32_bf16 v[28:31], a[164:167], v[88:91], v[28:31]
    s_waitcnt lgkmcnt(12)
    v_mfma_f32_16x16x32_bf16 v[28:31], a[160:163], v[92:95], v[28:31]
    v_mfma_f32_16x16x32_bf16 v[32:35], a[168:171], v[88:91], v[32:35]
    v_mfma_f32_16x16x32_bf16 v[36:39], a[172:175], v[88:91], v[36:39]
    global_load_dwordx2 v[138:139], v248, s[4:5] offset:0
    v_mfma_f32_16x16x32_bf16 v[40:43], a[176:179], v[88:91], v[40:43]
    v_mfma_f32_16x16x32_bf16 v[44:47], a[180:183], v[88:91], v[44:47]
    v_mfma_f32_16x16x32_bf16 v[32:35], a[164:167], v[92:95], v[32:35]
    v_mfma_f32_16x16x32_bf16 v[36:39], a[168:171], v[92:95], v[36:39]
    v_mfma_f32_16x16x32_bf16 v[40:43], a[172:175], v[92:95], v[40:43]
    v_mfma_f32_16x16x32_bf16 v[44:47], a[176:179], v[92:95], v[44:47]
    s_waitcnt lgkmcnt(11)
    v_mfma_f32_16x16x32_bf16 v[24:27], a[192:195], v[96:99], v[24:27]
    v_mfma_f32_16x16x32_bf16 v[28:31], a[196:199], v[96:99], v[28:31]
    s_waitcnt lgkmcnt(10)
    v_mfma_f32_16x16x32_bf16 v[28:31], a[192:195], v[100:103], v[28:31]
    v_mfma_f32_16x16x32_bf16 v[32:35], a[200:203], v[96:99], v[32:35]
    v_mfma_f32_16x16x32_bf16 v[36:39], a[204:207], v[96:99], v[36:39]
    v_mfma_f32_16x16x32_bf16 v[40:43], a[208:211], v[96:99], v[40:43]
    v_mfma_f32_16x16x32_bf16 v[44:47], a[212:215], v[96:99], v[44:47]
    v_mfma_f32_16x16x32_bf16 v[32:35], a[196:199], v[100:103], v[32:35]
    v_mfma_f32_16x16x32_bf16 v[36:39], a[200:203], v[100:103], v[36:39]
    v_mfma_f32_16x16x32_bf16 v[40:43], a[204:207], v[100:103], v[40:43]
    v_mfma_f32_16x16x32_bf16 v[44:47], a[208:211], v[100:103], v[44:47]
    s_waitcnt lgkmcnt(9)
    v_mfma_f32_16x16x32_bf16 v[24:27], a[224:227], v[104:107], v[24:27]
    v_mfma_f32_16x16x32_bf16 v[28:31], a[228:231], v[104:107], v[28:31]
    buffer_load_dwordx4 v[160:163], v6, s[20:23], s10 offen
    s_waitcnt lgkmcnt(8)
    v_mfma_f32_16x16x32_bf16 v[28:31], a[224:227], v[108:111], v[28:31]
    buffer_load_dwordx4 v[164:167], v249, s[20:23], s10 offen
    v_mfma_f32_16x16x32_bf16 v[32:35], a[232:235], v[104:107], v[32:35]
    buffer_load_dwordx4 v[168:171], v250, s[20:23], s10 offen
    v_mfma_f32_16x16x32_bf16 v[36:39], a[236:239], v[104:107], v[36:39]
    buffer_load_dwordx4 v[172:175], v251, s[20:23], s10 offen
    v_mfma_f32_16x16x32_bf16 v[40:43], a[240:243], v[104:107], v[40:43]
    v_mfma_f32_16x16x32_bf16 v[44:47], a[244:247], v[104:107], v[44:47]
    v_mfma_f32_16x16x32_bf16 v[32:35], a[228:231], v[108:111], v[32:35]
    v_mfma_f32_16x16x32_bf16 v[36:39], a[232:235], v[108:111], v[36:39]
    v_mfma_f32_16x16x32_bf16 v[40:43], a[236:239], v[108:111], v[40:43]
    v_mfma_f32_16x16x32_bf16 v[44:47], a[240:243], v[108:111], v[44:47]
    global_load_dwordx2 v[140:141], v248, s[6:7] offset:1280
    ds_write_b128 v11, v[24:27] offset:2048
    ds_write_b128 v11, v[28:31] offset:3072
    s_pack_ll_b32_b16 s8, s88, s86
    s_pack_hh_b32_b16 s9, s88, s86
    s_pack_ll_b32_b16 s14, s89, s87
    s_pack_hh_b32_b16 s15, s89, s87
    s_lshr_b32 s86, s84, 16
    s_lshr_b32 s87, s85, 16
    s_waitcnt vmcnt(10)
    v_perm_b32 v184, v128, v130, s27
    v_perm_b32 v185, v128, v130, s28
    v_perm_b32 v186, v129, v131, s27
    v_perm_b32 v187, v129, v131, s28
    v_dot2_f32_bf16 v196, v184, s32, 0
    v_dot2_f32_bf16 v198, v185, s34, 0
    v_dot2_f32_bf16 v200, v186, s36, 0
    v_dot2_f32_bf16 v202, v187, s38, 0
    v_mov_b32_dpp v188, v184 wave_shr:1 row_mask:0xf bank_mask:0xf
    v_mov_b32_dpp v189, v185 wave_shr:1 row_mask:0xf bank_mask:0xf
    v_mov_b32_dpp v190, v186 wave_shr:1 row_mask:0xf bank_mask:0xf
    v_mov_b32_dpp v191, v187 wave_shr:1 row_mask:0xf bank_mask:0xf
    v_writelane_b32 v188, s8, 0
    v_writelane_b32 v189, s9, 0
    v_writelane_b32 v190, s14, 0
    v_writelane_b32 v191, s15, 0
    v_dot2_f32_bf16 v197, v184, s40, 0
    v_dot2_f32_bf16 v199, v185, s41, 0
    v_dot2_f32_bf16 v201, v186, s42, 0
    v_dot2_f32_bf16 v203, v187, s43, 0
    v_mov_b32_dpp v192, v188 wave_shr:1 row_mask:0xf bank_mask:0xf
    v_mov_b32_dpp v193, v189 wave_shr:1 row_mask:0xf bank_mask:0xf
    v_mov_b32_dpp v194, v190 wave_shr:1 row_mask:0xf bank_mask:0xf
    v_mov_b32_dpp v195, v191 wave_shr:1 row_mask:0xf bank_mask:0xf
    v_writelane_b32 v192, s84, 0
    v_writelane_b32 v193, s86, 0
    v_writelane_b32 v194, s85, 0
    v_writelane_b32 v195, s87, 0
    v_dot2_f32_bf16 v196, v188, s33, v196
    v_dot2_f32_bf16 v198, v189, s35, v198
    v_dot2_f32_bf16 v200, v190, s37, v200
    v_dot2_f32_bf16 v202, v191, s39, v202
    v_dot2_f32_bf16 v197, v188, s44, v197
    v_dot2_f32_bf16 v199, v189, s45, v199
    v_dot2_f32_bf16 v201, v190, s46, v201
    v_dot2_f32_bf16 v203, v191, s47, v203
    v_dot2_f32_bf16 v197, v192, s48, v197
    v_dot2_f32_bf16 v199, v193, s49, v199
    v_dot2_f32_bf16 v201, v194, s50, v201
    v_dot2_f32_bf16 v203, v195, s51, v203
    s_waitcnt vmcnt(7)
    v_lshlrev_b32 v204, 16, v132
    v_lshlrev_b32 v205, 16, v134
    v_and_b32 v206, s26, v132
    v_and_b32 v207, s26, v134
    v_lshlrev_b32 v208, 16, v133
    v_lshlrev_b32 v209, 16, v135
    v_and_b32 v210, s26, v133
    v_and_b32 v211, s26, v135
    v_pk_mul_f32 v[196:197], v[196:197], v[204:205]
    v_pk_mul_f32 v[198:199], v[198:199], v[206:207]
    v_pk_mul_f32 v[200:201], v[200:201], v[208:209]
    v_pk_mul_f32 v[202:203], v[202:203], v[210:211]
    v_cvt_pk_bf16_f32 v196, v196, v197
    v_cvt_pk_bf16_f32 v198, v198, v199
    v_cvt_pk_bf16_f32 v200, v200, v201
    v_cvt_pk_bf16_f32 v202, v202, v203
    ds_write_b32 v4, v196 offset:1024
    ds_write_b32 v4, v198 offset:5632
    ds_write_b32 v4, v200 offset:10240
    ds_write_b32 v4, v202 offset:14848
    s_waitcnt lgkmcnt(0)
    s_barrier
    s_waitcnt vmcnt(1)
    v_max3_u32 v244, v160, v162, v164
    v_max3_u32 v244, v244, v166, v168
    v_max3_u32 v244, v244, v170, v172
    v_max_u32 v244, v244, v174
    v_cmp_eq_u32 vcc, -1, v244
    s_cbranch_vccnz .rl2
.rl2b:
    s_add_u32 s31, s30, 3145728
    buffer_load_dwordx4 v[144:147], v7, s[20:23], s31 offen
    s_add_u32 s31, s30, 3801088
    buffer_load_dwordx4 v[148:151], v7, s[20:23], s31 offen
    s_add_u32 s31, s30, 4456448
    buffer_load_dwordx4 v[152:155], v7, s[20:23], s31 offen
    s_add_u32 s31, s30, 5111808
    buffer_load_dwordx4 v[156:159], v7, s[20:23], s31 offen
    ds_read_b128 v[48:51], v1 offset:1536
    ds_read_b128 v[52:55], v1 offset:1024
    ds_read_b128 v[56:59], v1 offset:1600
    ds_read_b128 v[60:63], v1 offset:1088
    s_waitcnt lgkmcnt(3)
    v_mfma_f32_16x16x32_bf16 v[32:35], v[180:183], v[48:51], v[32:35]
    ds_read_b128 v[64:67], v1 offset:1664
    s_waitcnt lgkmcnt(3)
    v_mfma_f32_16x16x32_bf16 v[36:39], v[180:183], v[52:55], v[36:39]
    ds_read_b128 v[68:71], v1 offset:1152
    v_mfma_f32_16x16x32_bf16 v[32:35], a[0:3], v[48:51], v[32:35]
    ds_read_b128 v[72:75], v1 offset:1728
    v_mfma_f32_16x16x32_bf16 v[36:39], a[4:7], v[48:51], v[36:39]
    ds_read_b128 v[76:79], v1 offset:1216
    v_mfma_f32_16x16x32_bf16 v[36:39], a[0:3], v[52:55], v[36:39]
    ds_read_b128 v[80:83], v1 offset:1792
    v_mfma_f32_16x16x32_bf16 v[40:43], a[8:11], v[48:51], v[40:43]
    ds_read_b128 v[84:87], v1 offset:1280
    v_mfma_f32_16x16x32_bf16 v[44:47], a[12:15], v[48:51], v[44:47]
    ds_read_b128 v[88:91], v1 offset:1856
    v_mfma_f32_16x16x32_bf16 v[40:43], a[4:7], v[52:55], v[40:43]
    ds_read_b128 v[92:95], v1 offset:1344
    v_mfma_f32_16x16x32_bf16 v[44:47], a[8:11], v[52:55], v[44:47]
    ds_read_b128 v[96:99], v1 offset:1920
    s_waitcnt lgkmcnt(10)
    v_mfma_f32_16x16x32_bf16 v[32:35], a[32:35], v[56:59], v[32:35]
    ds_read_b128 v[100:103], v1 offset:1408
    v_mfma_f32_16x16x32_bf16 v[36:39], a[36:39], v[56:59], v[36:39]
    ds_read_b128 v[104:107], v1 offset:1984
    s_waitcnt lgkmcnt(11)
    v_mfma_f32_16x16x32_bf16 v[36:39], a[32:35], v[60:63], v[36:39]
    ds_read_b128 v[108:111], v1 offset:1472
    global_load_dwordx2 v[142:143], v248, s[6:7] offset:0
    v_mfma_f32_16x16x32_bf16 v[40:43], a[40:43], v[56:59], v[40:43]
    ds_read_b32 v120, v8 offset:2048
    v_mfma_f32_16x16x32_bf16 v[44:47], a[44:47], v[56:59], v[44:47]
    ds_read_b32 v121, v8 offset:10496
    v_mfma_f32_16x16x32_bf16 v[40:43], a[36:39], v[60:63], v[40:43]
    ds_read_b32 v122, v8 offset:18944
    v_mfma_f32_16x16x32_bf16 v[44:47], a[40:43], v[60:63], v[44:47]
    ds_read_b32 v123, v8 offset:27392
    s_waitcnt lgkmcnt(15)
    v_mfma_f32_16x16x32_bf16 v[32:35], a[64:67], v[64:67], v[32:35]
    ds_read_b32 v124, v8 offset:2112
    v_mfma_f32_16x16x32_bf16 v[36:39], a[68:71], v[64:67], v[36:39]
    ds_read_b32 v125, v8 offset:10560
    s_waitcnt lgkmcnt(15)
    v_mfma_f32_16x16x32_bf16 v[36:39], a[64:67], v[68:71], v[36:39]
    ds_read_b32 v126, v8 offset:19008
    v_mfma_f32_16x16x32_bf16 v[40:43], a[72:75], v[64:67], v[40:43]
    ds_read_b32 v127, v8 offset:27456
    v_mfma_f32_16x16x32_bf16 v[44:47], a[76:79], v[64:67], v[44:47]
    v_mfma_f32_16x16x32_bf16 v[40:43], a[68:71], v[68:71], v[40:43]
    v_mfma_f32_16x16x32_bf16 v[44:47], a[72:75], v[68:71], v[44:47]
    v_mfma_f32_16x16x32_bf16 v[32:35], a[96:99], v[72:75], v[32:35]
    v_mfma_f32_16x16x32_bf16 v[36:39], a[100:103], v[72:75], v[36:39]
    s_waitcnt lgkmcnt(15)
    v_mfma_f32_16x16x32_bf16 v[36:39], a[96:99], v[76:79], v[36:39]
    v_mfma_f32_16x16x32_bf16 v[40:43], a[104:107], v[72:75], v[40:43]
    v_mfma_f32_16x16x32_bf16 v[44:47], a[108:111], v[72:75], v[44:47]
    v_mfma_f32_16x16x32_bf16 v[40:43], a[100:103], v[76:79], v[40:43]
    v_mfma_f32_16x16x32_bf16 v[44:47], a[104:107], v[76:79], v[44:47]
    v_mfma_f32_16x16x32_bf16 v[32:35], a[128:131], v[80:83], v[32:35]
    s_waitcnt vmcnt(4)
    v_lshlrev_b32 v212, 16, v144
    v_and_b32 v213, s26, v144
    v_mfma_f32_16x16x32_bf16 v[36:39], a[132:135], v[80:83], v[36:39]
    v_lshlrev_b32 v214, 16, v145
    v_and_b32 v215, s26, v145
    s_waitcnt lgkmcnt(14)
    v_mfma_f32_16x16x32_bf16 v[36:39], a[128:131], v[84:87], v[36:39]
    v_lshlrev_b32 v216, 16, v146
    v_and_b32 v217, s26, v146
    v_mfma_f32_16x16x32_bf16 v[40:43], a[136:139], v[80:83], v[40:43]
    v_lshlrev_b32 v218, 16, v147
    v_and_b32 v219, s26, v147
    v_mfma_f32_16x16x32_bf16 v[44:47], a[140:143], v[80:83], v[44:47]
    v_fma_f32 v220, v212, v160, -v161
    v_fma_f32 v221, v213, v160, -v161
    v_mfma_f32_16x16x32_bf16 v[40:43], a[132:135], v[84:87], v[40:43]
    v_fma_f32 v222, v214, v160, -v161
    v_fma_f32 v223, v215, v160, -v161
    v_mfma_f32_16x16x32_bf16 v[44:47], a[136:139], v[84:87], v[44:47]
    v_fma_f32 v224, v216, v162, -v163
    v_fma_f32 v225, v217, v162, -v163
    s_waitcnt lgkmcnt(13)
    v_mfma_f32_16x16x32_bf16 v[32:35], a[160:163], v[88:91], v[32:35]
    v_fma_f32 v226, v218, v162, -v163
    v_fma_f32 v227, v219, v162, -v163
    v_mfma_f32_16x16x32_bf16 v[36:39], a[164:167], v[88:91], v[36:39]
    v_pk_fma_f32 v[112:113], v[112:113], v[220:221], v[212:213]
    v_pk_fma_f32 v[114:115], v[114:115], v[222:223], v[214:215]
    s_waitcnt lgkmcnt(12)
    v_mfma_f32_16x16x32_bf16 v[36:39], a[160:163], v[92:95], v[36:39]
    v_pk_fma_f32 v[116:117], v[116:117], v[224:225], v[216:217]
    v_pk_fma_f32 v[118:119], v[118:119], v[226:227], v[218:219]
    v_mfma_f32_16x16x32_bf16 v[40:43], a[168:171], v[88:91], v[40:43]
    v_cvt_pk_bf16_f32 v112, v112, v113
    v_cvt_pk_bf16_f32 v113, v114, v115
    v_mfma_f32_16x16x32_bf16 v[44:47], a[172:175], v[88:91], v[44:47]
    v_cvt_pk_bf16_f32 v114, v116, v117
    v_cvt_pk_bf16_f32 v115, v118, v119
    v_mfma_f32_16x16x32_bf16 v[40:43], a[164:167], v[92:95], v[40:43]
    v_min_u32 v112, -2, v112
    buffer_store_dwordx4 v[112:115], v7, s[20:23], s30 offen sc1
    s_add_u32 s30, s30, 655360
    s_waitcnt vmcnt(4)
    v_lshlrev_b32 v228, 16, v148
    v_mfma_f32_16x16x32_bf16 v[44:47], a[168:171], v[92:95], v[44:47]
    v_and_b32 v229, s26, v148
    v_lshlrev_b32 v230, 16, v149
    s_waitcnt lgkmcnt(11)
    v_mfma_f32_16x16x32_bf16 v[32:35], a[192:195], v[96:99], v[32:35]
    v_and_b32 v231, s26, v149
    v_lshlrev_b32 v232, 16, v150
    v_mfma_f32_16x16x32_bf16 v[36:39], a[196:199], v[96:99], v[36:39]
    v_and_b32 v233, s26, v150
    v_lshlrev_b32 v234, 16, v151
    s_waitcnt lgkmcnt(10)
    v_mfma_f32_16x16x32_bf16 v[36:39], a[192:195], v[100:103], v[36:39]
    v_and_b32 v235, s26, v151
    v_fma_f32 v236, v228, v164, -v165
    v_mfma_f32_16x16x32_bf16 v[40:43], a[200:203], v[96:99], v[40:43]
    v_fma_f32 v237, v229, v164, -v165
    v_fma_f32 v238, v230, v164, -v165
    v_mfma_f32_16x16x32_bf16 v[44:47], a[204:207], v[96:99], v[44:47]
    v_fma_f32 v239, v231, v164, -v165
    v_fma_f32 v240, v232, v166, -v167
    v_mfma_f32_16x16x32_bf16 v[40:43], a[196:199], v[100:103], v[40:43]
    v_fma_f32 v241, v233, v166, -v167
    v_fma_f32 v242, v234, v166, -v167
    v_mfma_f32_16x16x32_bf16 v[44:47], a[200:203], v[100:103], v[44:47]
    v_fma_f32 v243, v235, v166, -v167
    s_waitcnt lgkmcnt(0)
    v_pk_fma_f32 v[120:121], v[120:121], v[236:237], v[228:229]
    v_mfma_f32_16x16x32_bf16 v[32:35], a[224:227], v[104:107], v[32:35]
    v_pk_fma_f32 v[122:123], v[122:123], v[238:239], v[230:231]
    v_pk_fma_f32 v[124:125], v[124:125], v[240:241], v[232:233]
    v_mfma_f32_16x16x32_bf16 v[36:39], a[228:231], v[104:107], v[36:39]
    v_pk_fma_f32 v[126:127], v[126:127], v[242:243], v[234:235]
    v_cvt_pk_bf16_f32 v120, v120, v121
    v_mfma_f32_16x16x32_bf16 v[36:39], a[224:227], v[108:111], v[36:39]
    v_cvt_pk_bf16_f32 v121, v122, v123
    v_cvt_pk_bf16_f32 v122, v124, v125
    v_mfma_f32_16x16x32_bf16 v[40:43], a[232:235], v[104:107], v[40:43]
    v_cvt_pk_bf16_f32 v123, v126, v127
    v_min_u32 v120, -2, v120
    v_mfma_f32_16x16x32_bf16 v[44:47], a[236:239], v[104:107], v[44:47]
    buffer_store_dwordx4 v[120:123], v7, s[20:23], s30 offen sc1
    s_add_u32 s30, s30, 655360
    v_mfma_f32_16x16x32_bf16 v[40:43], a[228:231], v[108:111], v[40:43]
    v_mfma_f32_16x16x32_bf16 v[44:47], a[232:235], v[108:111], v[44:47]
    ds_write_b128 v11, v[32:35] offset:4096
    ds_write_b128 v11, v[36:39] offset:5120
    s_pack_ll_b32_b16 s8, s12, s92
    s_pack_hh_b32_b16 s9, s12, s92
    s_pack_ll_b32_b16 s14, s13, s93
    s_pack_hh_b32_b16 s15, s13, s93
    s_lshr_b32 s92, s90, 16
    s_lshr_b32 s93, s91, 16
    v_perm_b32 v184, v136, v138, s27
    v_perm_b32 v185, v136, v138, s28
    v_perm_b32 v186, v137, v139, s27
    v_perm_b32 v187, v137, v139, s28
    v_dot2_f32_bf16 v196, v184, s32, 0
    v_dot2_f32_bf16 v198, v185, s34, 0
    v_dot2_f32_bf16 v200, v186, s36, 0
    v_dot2_f32_bf16 v202, v187, s38, 0
    v_mov_b32_dpp v188, v184 wave_shr:1 row_mask:0xf bank_mask:0xf
    v_mov_b32_dpp v189, v185 wave_shr:1 row_mask:0xf bank_mask:0xf
    v_mov_b32_dpp v190, v186 wave_shr:1 row_mask:0xf bank_mask:0xf
    v_mov_b32_dpp v191, v187 wave_shr:1 row_mask:0xf bank_mask:0xf
    v_writelane_b32 v188, s8, 0
    v_writelane_b32 v189, s9, 0
    v_writelane_b32 v190, s14, 0
    v_writelane_b32 v191, s15, 0
    v_dot2_f32_bf16 v197, v184, s40, 0
    v_dot2_f32_bf16 v199, v185, s41, 0
    v_dot2_f32_bf16 v201, v186, s42, 0
    v_dot2_f32_bf16 v203, v187, s43, 0
    v_mov_b32_dpp v192, v188 wave_shr:1 row_mask:0xf bank_mask:0xf
    v_mov_b32_dpp v193, v189 wave_shr:1 row_mask:0xf bank_mask:0xf
    v_mov_b32_dpp v194, v190 wave_shr:1 row_mask:0xf bank_mask:0xf
    v_mov_b32_dpp v195, v191 wave_shr:1 row_mask:0xf bank_mask:0xf
    v_writelane_b32 v192, s90, 0
    v_writelane_b32 v193, s92, 0
    v_writelane_b32 v194, s91, 0
    v_writelane_b32 v195, s93, 0
    v_dot2_f32_bf16 v196, v188, s33, v196
    v_dot2_f32_bf16 v198, v189, s35, v198
    v_dot2_f32_bf16 v200, v190, s37, v200
    v_dot2_f32_bf16 v202, v191, s39, v202
    v_dot2_f32_bf16 v197, v188, s44, v197
    v_dot2_f32_bf16 v199, v189, s45, v199
    v_dot2_f32_bf16 v201, v190, s46, v201
    v_dot2_f32_bf16 v203, v191, s47, v203
    v_dot2_f32_bf16 v197, v192, s48, v197
    v_dot2_f32_bf16 v199, v193, s49, v199
    v_dot2_f32_bf16 v201, v194, s50, v201
    v_dot2_f32_bf16 v203, v195, s51, v203
    s_waitcnt vmcnt(2)
    v_lshlrev_b32 v204, 16, v140
    v_lshlrev_b32 v205, 16, v142
    v_and_b32 v206, s26, v140
    v_and_b32 v207, s26, v142
    v_lshlrev_b32 v208, 16, v141
    v_lshlrev_b32 v209, 16, v143
    v_and_b32 v210, s26, v141
    v_and_b32 v211, s26, v143
    v_pk_mul_f32 v[196:197], v[196:197], v[204:205]
    v_pk_mul_f32 v[198:199], v[198:199], v[206:207]
    v_pk_mul_f32 v[200:201], v[200:201], v[208:209]
    v_pk_mul_f32 v[202:203], v[202:203], v[210:211]
    v_cvt_pk_bf16_f32 v196, v196, v197
    v_cvt_pk_bf16_f32 v198, v198, v199
    v_cvt_pk_bf16_f32 v200, v200, v201
    v_cvt_pk_bf16_f32 v202, v202, v203
    ds_write_b32 v4, v196 offset:0
    ds_write_b32 v4, v198 offset:4608
    ds_write_b32 v4, v200 offset:9216
    ds_write_b32 v4, v202 offset:13824
    s_waitcnt lgkmcnt(0)
    s_barrier
    ds_read_b128 v[48:51], v1 offset:512
    ds_read_b128 v[52:55], v1 offset:0
    ds_read_b128 v[56:59], v1 offset:576
    ds_read_b128 v[60:63], v1 offset:64
    ds_read_b128 v[64:67], v1 offset:640
    ds_read_b128 v[68:71], v1 offset:128
    ds_read_b128 v[72:75], v1 offset:704
    ds_read_b128 v[76:79], v1 offset:192
    ds_read_b128 v[80:83], v1 offset:768
    ds_read_b128 v[84:87], v1 offset:256
    ds_read_b128 v[88:91], v1 offset:832
    ds_read_b128 v[92:95], v1 offset:320
    ds_read_b128 v[96:99], v1 offset:896
    ds_read_b128 v[100:103], v1 offset:384
    ds_read_b128 v[104:107], v1 offset:960
    ds_read_b128 v[108:111], v1 offset:448
    s_waitcnt lgkmcnt(15)
    v_mfma_f32_16x16x32_bf16 v[40:43], v[180:183], v[48:51], v[40:43]
    ds_read_b32 v128, v8 offset:4096
    s_mov_b32 s63, s30
    s_mov_b32 s59, 0xffff0000
    s_waitcnt lgkmcnt(15)
    v_mfma_f32_16x16x32_bf16 v[44:47], v[180:183], v[52:55], v[44:47]
    ds_read_b32 v129, v8 offset:12544
    s_and_b32 s6, s2, 1
    s_lshr_b32 s7, s2, 5
    v_mfma_f32_16x16x32_bf16 v[40:43], a[0:3], v[48:51], v[40:43]
    ds_read_b32 v130, v8 offset:20992
    s_lshl_b32 s8, s7, 1
    v_mfma_f32_16x16x32_bf16 v[44:47], a[4:7], v[48:51], v[44:47]
    ds_read_b32 v131, v8 offset:29440
    s_add_u32 s6, s6, s8
    v_mfma_f32_16x16x32_bf16 v[44:47], a[0:3], v[52:55], v[44:47]
    ds_read_b32 v132, v8 offset:4160
    v_lshlrev_b32 v212, 16, v152
    v_and_b32 v213, s59, v152
    s_bfe_u32 s8, s2, 0x20001
    s_waitcnt lgkmcnt(15)
    v_mfma_f32_16x16x32_bf16 v[40:43], a[32:35], v[56:59], v[40:43]
    ds_read_b32 v133, v8 offset:12608
    v_lshlrev_b32 v214, 16, v153
    v_and_b32 v215, s59, v153
    s_mul_i32 s13, s8, 27
    v_mfma_f32_16x16x32_bf16 v[44:47], a[36:39], v[56:59], v[44:47]
    ds_read_b32 v134, v8 offset:21056
    v_lshlrev_b32 v216, 16, v154
    v_and_b32 v217, s59, v154
    s_and_b32 s13, s13, -4
    v_mfma_f32_16x16x32_bf16 v[44:47], a[32:35], v[60:63], v[44:47]
    ds_read_b32 v135, v8 offset:29504
    v_lshlrev_b32 v218, 16, v155
    v_and_b32 v219, s59, v155
    v_and_b32 v189, 31, v2
    v_mfma_f32_16x16x32_bf16 v[40:43], a[64:67], v[64:67], v[40:43]
    v_fma_f32 v220, v212, v168, -v169
    v_fma_f32 v221, v213, v168, -v169
    v_add_u32 v189, s13, v189
    v_mfma_f32_16x16x32_bf16 v[44:47], a[68:71], v[64:67], v[44:47]
    v_fma_f32 v222, v214, v168, -v169
    v_fma_f32 v223, v215, v168, -v169
    v_min_u32 v189, 0x6b, v189
    v_mfma_f32_16x16x32_bf16 v[44:47], a[64:67], v[68:71], v[44:47]
    v_fma_f32 v224, v216, v170, -v171
    v_fma_f32 v225, v217, v170, -v171
    v_lshlrev_b32 v189, 7, v189
    s_waitcnt lgkmcnt(15)
    v_mfma_f32_16x16x32_bf16 v[40:43], a[96:99], v[72:75], v[40:43]
    v_fma_f32 v226, v218, v170, -v171
    v_fma_f32 v227, v219, v170, -v171
    s_mov_b32 s13, 11034624
    v_mfma_f32_16x16x32_bf16 v[44:47], a[100:103], v[72:75], v[44:47]
    s_waitcnt lgkmcnt(0)
    v_pk_fma_f32 v[128:129], v[128:129], v[220:221], v[212:213]
    v_pk_fma_f32 v[130:131], v[130:131], v[222:223], v[214:215]
    v_min_u32 v190, 624, v3
    v_mfma_f32_16x16x32_bf16 v[44:47], a[96:99], v[76:79], v[44:47]
    v_pk_fma_f32 v[132:133], v[132:133], v[224:225], v[216:217]
    v_pk_fma_f32 v[134:135], v[134:135], v[226:227], v[218:219]
    s_and_b32 s15, s6, 3
    v_mfma_f32_16x16x32_bf16 v[40:43], a[128:131], v[80:83], v[40:43]
    v_cvt_pk_bf16_f32 v128, v128, v129
    v_cvt_pk_bf16_f32 v129, v130, v131
    s_mul_i32 s15, s15, 640
    v_mfma_f32_16x16x32_bf16 v[44:47], a[132:135], v[80:83], v[44:47]
    v_cvt_pk_bf16_f32 v130, v132, v133
    v_cvt_pk_bf16_f32 v131, v134, v135
    s_add_u32 s15, s15, 11014144
    v_mfma_f32_16x16x32_bf16 v[44:47], a[128:131], v[84:87], v[44:47]
    v_min_u32 v128, -2, v128
    buffer_store_dwordx4 v[128:131], v7, s[20:23], s63 offen sc1
    s_add_u32 s63, s63, 655360
    v_lshlrev_b32 v228, 16, v156
    buffer_load_dword v188, v189, s[20:23], s13 offen sc1
    v_mfma_f32_16x16x32_bf16 v[40:43], a[160:163], v[88:91], v[40:43]
    v_and_b32 v229, s59, v156
    v_lshlrev_b32 v230, 16, v157
    buffer_load_dwordx4 v[184:187], v190, s[20:23], s15 offen sc1
    v_mfma_f32_16x16x32_bf16 v[44:47], a[164:167], v[88:91], v[44:47]
    v_and_b32 v231, s59, v157
    v_lshlrev_b32 v232, 16, v158
    s_bfe_u32 s9, s2, 0x20003
    v_mfma_f32_16x16x32_bf16 v[44:47], a[160:163], v[92:95], v[44:47]
    v_and_b32 v233, s59, v158
    v_lshlrev_b32 v234, 16, v159
    s_lshl_b32 s10, s8, 2
    v_mfma_f32_16x16x32_bf16 v[40:43], a[192:195], v[96:99], v[40:43]
    v_and_b32 v235, s59, v159
    v_fma_f32 v236, v228, v172, -v173
    s_add_u32 s10, s10, s9
    v_mfma_f32_16x16x32_bf16 v[44:47], a[196:199], v[96:99], v[44:47]
    v_fma_f32 v237, v229, v172, -v173
    v_fma_f32 v238, v230, v172, -v173
    s_lshl_b32 s12, s6, 2
    v_mfma_f32_16x16x32_bf16 v[44:47], a[192:195], v[100:103], v[44:47]
    v_fma_f32 v239, v231, v172, -v173
    v_fma_f32 v240, v232, v174, -v175
    s_add_u32 s12, s12, s3
    v_mfma_f32_16x16x32_bf16 v[40:43], a[224:227], v[104:107], v[40:43]
    v_fma_f32 v241, v233, v174, -v175
    v_fma_f32 v242, v234, v174, -v175
    s_mul_i32 s24, s12, 40960
    v_mfma_f32_16x16x32_bf16 v[44:47], a[228:231], v[104:107], v[44:47]
    v_fma_f32 v243, v235, v174, -v175
    s_add_u32 s24, s24, 8388608
    v_mfma_f32_16x16x32_bf16 v[44:47], a[224:227], v[108:111], v[44:47]
    s_add_u32 s25, s24, 10240
    s_nop 7
    ds_write_b128 v11, v[40:43] offset:6144
    ds_write_b128 v11, v[44:47] offset:7168
    s_add_u32 s26, s24, 20480
    s_add_u32 s27, s24, 30720
    s_mul_i32 s34, s3, 5120
    s_mul_i32 s14, s10, 286720
    s_waitcnt lgkmcnt(0)
    s_barrier
    ds_read_b32 v136, v8 offset:6144
    ds_read_b32 v137, v8 offset:14592
    ds_read_b32 v138, v8 offset:23040
    ds_read_b32 v139, v8 offset:31488
    ds_read_b32 v140, v8 offset:6208
    ds_read_b32 v141, v8 offset:14656
    ds_read_b32 v142, v8 offset:23104
    ds_read_b32 v143, v8 offset:31552
    s_add_u32 s14, s14, 25165824
    s_add_u32 s28, s14, s34
    s_add_u32 s29, s28, 20480
    s_add_u32 s30, s28, 40960
    s_add_u32 s31, s28, 61440
    v_add_u32 v4, 4096, v3
    v_add_u32 v5, 8192, v3
    s_and_b32 s5, s3, 1
    s_waitcnt lgkmcnt(0)
    v_pk_fma_f32 v[136:137], v[136:137], v[236:237], v[228:229]
    v_pk_fma_f32 v[138:139], v[138:139], v[238:239], v[230:231]
    v_pk_fma_f32 v[140:141], v[140:141], v[240:241], v[232:233]
    v_pk_fma_f32 v[142:143], v[142:143], v[242:243], v[234:235]
    v_cvt_pk_bf16_f32 v136, v136, v137
    v_cvt_pk_bf16_f32 v137, v138, v139
    v_cvt_pk_bf16_f32 v138, v140, v141
    v_cvt_pk_bf16_f32 v139, v142, v143
    v_min_u32 v136, -2, v136
    buffer_store_dwordx4 v[136:139], v7, s[20:23], s63 offen sc1
    s_add_u32 s32, s28, 245760
    s_add_u32 s33, s32, 20480
    s_lshl_b32 s4, s12, 3
    s_add_u32 s4, s4, s8
    s_mul_i32 s4, s4, 14336
    s_lshl_b32 s18, s9, 9
    s_add_u32 s4, s4, s18
    s_add_u32 s35, s4, s18
    s_add_u32 s36, s35, 57344
    s_add_u32 s37, s4, 12288
    s_add_u32 s38, s37, 57344
    s_lshr_b32 s4, s12, 1
    s_lshl_b32 s4, s4, 2
    s_add_u32 s4, s4, s8
    s_lshl_b32 s4, s4, 2
    s_add_u32 s4, s4, s9
    s_lshl_b32 s4, s4, 1
    s_add_u32 s4, s4, s5
    s_lshl_b32 s62, s4, 2
    s_add_u32 s62, s62, 11010048
    s_lshl_b32 s51, s10, 12
    s_add_u32 s51, s51, 18874368
    s_mov_b32 s52, 0xaaaaaaaa
    s_mov_b32 s53, s52
    s_mov_b32 s54, 0xcccccccc
    s_mov_b32 s55, s54
    s_mov_b32 s58, 0x3acccccd
    s_lshl_b32 s4, s6, 1
    s_bfe_u32 s18, s2, 0x10001
    s_add_u32 s4, s4, s18
    s_lshl_b32 s4, s4, 2
    s_bfe_u32 s18, s2, 0x10002
    s_lshl_b32 s18, s18, 2
    s_add_u32 s18, s18, s9
    s_mul_i32 s19, s18, 54
    s_lshr_b32 s39, s3, 1
    s_mul_i32 s39, s39, 27
    s_mul_i32 s56, s5, 13
    s_add_u32 s56, s56, s39
    s_lshl_b32 s56, s56, 1
    s_bfe_u32 s57, s2, 0x10002
    s_add_u32 s56, s56, s57
    s_lshl_b32 s56, s56, 7
    s_add_u32 s56, s56, 11048448
    s_add_u32 s19, s19, s39
    s_add_u32 s49, s19, 13
    s_mul_i32 s39, s5, 14
    s_add_u32 s19, s19, s39
    s_mul_i32 s19, s19, 5120
    s_add_u32 s44, s19, 30408704
    s_add_u32 s45, s44, 5120
    s_add_u32 s46, s44, 10240
    s_add_u32 s47, s44, 15360
    s_add_u32 s48, s44, 61440
    s_mul_i32 s49, s49, 5120
    s_lshl_b32 s39, s5, 3
    s_add_u32 s49, s49, s39
    s_add_u32 s49, s49, 30408704
    s_add_u32 s60, s4, s3
    s_lshl_b32 s11, s60, 5
    s_add_u32 s11, s11, 11010048
    s_lshr_b32 s50, s60, 1
    s_mul_i32 s50, s50, 40960
    s_add_u32 s50, s50, s39
    s_mul_i32 s39, s18, 5120
    s_add_u32 s50, s50, s39
    s_add_u32 s50, s50, 8388608
    s_mul_i32 s60, s60, 20480
    s_mul_i32 s39, s18, 160
    s_add_u32 s60, s60, s39
    s_add_u32 s94, s94, s60
    s_addc_u32 s95, s95, 0
    s_add_u32 s39, s3, 1
    s_and_b32 s39, s39, 3
    s_add_u32 s39, s39, s4
    s_lshl_b32 s39, s39, 2
    s_add_u32 s39, s39, s3
    s_mul_i32 s40, s39, 14336
    s_add_u32 s39, s3, 2
    s_and_b32 s39, s39, 3
    s_add_u32 s39, s39, s4
    s_lshl_b32 s39, s39, 2
    s_add_u32 s39, s39, s3
    s_mul_i32 s41, s39, 14336
    s_add_u32 s39, s3, 3
    s_and_b32 s39, s39, 3
    s_add_u32 s39, s39, s4
    s_lshl_b32 s39, s39, 2
    s_add_u32 s39, s39, s3
    s_mul_i32 s42, s39, 14336
    s_add_u32 s39, s3, 4
    s_and_b32 s39, s39, 3
    s_add_u32 s39, s39, s4
    s_lshl_b32 s39, s39, 2
    s_add_u32 s39, s39, s3
    s_mul_i32 s43, s39, 14336
    s_waitcnt vmcnt(1)
    v_max3_u32 v184, v184, v185, v186
    v_max3_u32 v184, v184, v187, v188
    v_cmp_eq_u32 vcc, -1, v184
    s_cbranch_vccnz .rl3
.rl3b:
    buffer_load_dwordx4 v[16:19], v3, s[20:23], s24 offen offset:0
    buffer_load_dwordx4 v[20:23], v3, s[20:23], s24 offen offset:1024
    s_add_u32 m0, s34, 61440
    s_nop 0
    buffer_load_dwordx4 v3, s[20:23], s28 offen offset:0 lds
    buffer_load_dwordx4 v3, s[20:23], s28 offen offset:1024 lds
    buffer_load_dwordx4 v3, s[20:23], s28 offen offset:2048 lds
    buffer_load_dwordx4 v3, s[20:23], s28 offen offset:3072 lds
    s_add_u32 m0, s34, 65536
    s_nop 0
    buffer_load_dwordx4 v4, s[20:23], s28 offen offset:0 lds
    s_add_u32 s28, s28, 81920
    buffer_load_dwordx4 v[24:27], v3, s[20:23], s24 offen offset:2048
    buffer_load_dwordx4 v[28:31], v3, s[20:23], s24 offen offset:3072
    buffer_load_dwordx4 v[32:35], v4, s[20:23], s24 offen offset:0
    buffer_load_dwordx4 v[36:39], v4, s[20:23], s24 offen offset:1024
    v_add_u32 v6, 61440, v3
    v_add_u32 v7, 122880, v3
    v_mov_b32 v1, 0x3f803f80
    v_accvgpr_write_b32 a56, v1
    buffer_load_dwordx4 v[40:43], v4, s[20:23], s24 offen offset:2048
    v_accvgpr_write_b32 a57, v1
    v_accvgpr_write_b32 a58, v1
    v_accvgpr_write_b32 a59, v1
    v_accvgpr_write_b32 a49, 0
    buffer_load_dwordx4 v[44:47], v4, s[20:23], s24 offen offset:3072
    v_accvgpr_write_b32 a50, 0
    v_accvgpr_write_b32 a53, 0
    v_accvgpr_write_b32 a54, 0
    v_lshlrev_b32 v12, 3, v2
    buffer_load_dwordx4 v[48:51], v5, s[20:23], s24 offen offset:0
    v_and_b32 v13, 15, v2
    v_lshrrev_b32 v8, 2, v13
    v_lshl_add_u32 v13, v8, 4, v13
    v_lshlrev_b32 v13, 2, v13
    buffer_load_dwordx4 v[52:55], v5, s[20:23], s24 offen offset:1024
    v_mov_b32 v8, v3
    v_add_u32 v9, 1024, v3
    v_add_u32 v10, 2048, v3
    v_add_u32 v11, 3072, v3
    buffer_load_dwordx4 v[56:59], v3, s[20:23], s25 offen offset:0
    v_min_u32 v238, 13, v2
    v_lshlrev_b32 v238, 8, v238
    v_mov_b32 v232, -1
    v_mov_b32 v233, -1
    v_mov_b32 v234, -1
    v_mov_b32 v235, -1
    s_waitcnt vmcnt(14)
    v_max_u32 v2, v16, v20
    v_cmp_eq_u32 vcc, -1, v2
    s_cbranch_vccnz .hr4
.hr4b:
    v_swap_b32 v18, v20
    v_swap_b32 v19, v21
    s_nop 1
    v_mfma_f32_16x16x32_bf16 v[240:243], v[16:19], v[16:19], 0
    s_waitcnt vmcnt(9)
    s_barrier
    ds_read_b128 a[0:3], v6 offset:0
    s_waitcnt vmcnt(7)
    v_max_u32 v2, v24, v28
    v_mfma_f32_16x16x32_bf16 v[244:247], a[56:59], v[16:19], 0
    ds_read_b128 a[4:7], v6 offset:1024
    v_cmp_eq_u32 vcc, -1, v2
    s_cbranch_vccnz .hr5
.hr5b:
    v_mfma_f32_16x16x32_bf16 v[248:251], v[20:23], v[20:23], 0
    ds_read_b128 a[8:11], v6 offset:2048
    v_swap_b32 v26, v28
    v_mfma_f32_16x16x32_bf16 v[252:255], a[56:59], v[20:23], 0
    buffer_load_dwordx4 v[60:63], v3, s[20:23], s25 offen offset:1024
    v_swap_b32 v27, v29
    s_nop 1
    v_mfma_f32_16x16x32_bf16 v[240:243], v[24:27], v[24:27], v[240:243]
    ds_read_b128 a[12:15], v6 offset:3072
    v_mfma_f32_16x16x32_bf16 v[244:247], a[56:59], v[24:27], v[244:247]
    s_add_u32 m0, s34, 81920
    s_nop 0
    buffer_load_dwordx4 v3, s[20:23], s29 offen offset:0 lds
    v_mfma_f32_16x16x32_bf16 v[248:251], v[28:31], v[28:31], v[248:251]
    buffer_load_dwordx4 v3, s[20:23], s29 offen offset:1024 lds
    v_mfma_f32_16x16x32_bf16 v[252:255], a[56:59], v[28:31], v[252:255]
    s_waitcnt lgkmcnt(2)
    v_mfma_f32_16x16x32_bf16 v[176:179], a[0:3], v[16:19], 0
    v_mfma_f32_16x16x32_bf16 v[192:195], a[0:3], v[20:23], 0
    buffer_load_dwordx4 v3, s[20:23], s29 offen offset:2048 lds
    v_mfma_f32_16x16x32_bf16 v[180:183], a[4:7], v[16:19], 0
    ds_read_b128 a[16:19], v6 offset:4096
    s_waitcnt vmcnt(9)
    v_max_u32 v2, v32, v36
    v_mfma_f32_16x16x32_bf16 v[196:199], a[4:7], v[20:23], 0
    v_cmp_eq_u32 vcc, -1, v2
    s_cbranch_vccnz .hr6
.hr6b:
    v_swap_b32 v34, v36
    s_waitcnt lgkmcnt(1)
    v_mfma_f32_16x16x32_bf16 v[184:187], a[8:11], v[16:19], 0
    ds_read_b128 a[20:23], v6 offset:5120
    v_swap_b32 v35, v37
    v_mfma_f32_16x16x32_bf16 v[200:203], a[8:11], v[20:23], 0
    buffer_load_dwordx4 v3, s[20:23], s29 offen offset:3072 lds
    v_mfma_f32_16x16x32_bf16 v[188:191], a[12:15], v[16:19], 0
    ds_read_b128 a[24:27], v6 offset:6144
    v_mfma_f32_16x16x32_bf16 v[204:207], a[12:15], v[20:23], 0
    s_add_u32 m0, s34, 86016
    s_nop 0
    buffer_load_dwordx4 v4, s[20:23], s29 offen offset:0 lds
    s_add_u32 s29, s29, 81920
    v_mfma_f32_16x16x32_bf16 v[240:243], v[32:35], v[32:35], v[240:243]
    ds_read_b128 a[28:31], v6 offset:7168
    v_mfma_f32_16x16x32_bf16 v[244:247], a[56:59], v[32:35], v[244:247]
    v_mfma_f32_16x16x32_bf16 v[248:251], v[36:39], v[36:39], v[248:251]
    buffer_load_dwordx4 v[64:67], v3, s[20:23], s25 offen offset:2048
    v_mfma_f32_16x16x32_bf16 v[252:255], a[56:59], v[36:39], v[252:255]
    s_waitcnt lgkmcnt(2)
    v_mfma_f32_16x16x32_bf16 v[176:179], a[16:19], v[24:27], v[176:179]
    v_mfma_f32_16x16x32_bf16 v[192:195], a[16:19], v[28:31], v[192:195]
    buffer_load_dwordx4 v[68:71], v3, s[20:23], s25 offen offset:3072
    v_mfma_f32_16x16x32_bf16 v[180:183], a[20:23], v[24:27], v[180:183]
    ds_read_b128 a[0:3], v6 offset:8192
    s_waitcnt vmcnt(11)
    v_max_u32 v2, v40, v44
    v_mfma_f32_16x16x32_bf16 v[196:199], a[20:23], v[28:31], v[196:199]
    v_cmp_eq_u32 vcc, -1, v2
    s_cbranch_vccnz .hr7
.hr7b:
    v_swap_b32 v42, v44
    s_waitcnt lgkmcnt(1)
    v_mfma_f32_16x16x32_bf16 v[184:187], a[24:27], v[24:27], v[184:187]
    ds_read_b128 a[4:7], v6 offset:9216
    v_swap_b32 v43, v45
    v_mfma_f32_16x16x32_bf16 v[200:203], a[24:27], v[28:31], v[200:203]
    buffer_load_dwordx4 v[72:75], v4, s[20:23], s25 offen offset:0
    v_mfma_f32_16x16x32_bf16 v[188:191], a[28:31], v[24:27], v[188:191]
    ds_read_b128 a[8:11], v6 offset:10240
    v_mfma_f32_16x16x32_bf16 v[204:207], a[28:31], v[28:31], v[204:207]
    buffer_load_dwordx4 v[76:79], v4, s[20:23], s25 offen offset:1024
    v_mfma_f32_16x16x32_bf16 v[240:243], v[40:43], v[40:43], v[240:243]
    ds_read_b128 a[12:15], v6 offset:11264
    v_mfma_f32_16x16x32_bf16 v[244:247], a[56:59], v[40:43], v[244:247]
    v_mfma_f32_16x16x32_bf16 v[248:251], v[44:47], v[44:47], v[248:251]
    buffer_load_dwordx4 v[80:83], v4, s[20:23], s25 offen offset:2048
    v_mfma_f32_16x16x32_bf16 v[252:255], a[56:59], v[44:47], v[252:255]
    s_waitcnt lgkmcnt(2)
    v_mfma_f32_16x16x32_bf16 v[176:179], a[0:3], v[32:35], v[176:179]
    v_mfma_f32_16x16x32_bf16 v[192:195], a[0:3], v[36:39], v[192:195]
    buffer_load_dwordx4 v[84:87], v4, s[20:23], s25 offen offset:3072
    v_mfma_f32_16x16x32_bf16 v[180:183], a[4:7], v[32:35], v[180:183]
    ds_read_b128 a[16:19], v6 offset:12288
    s_waitcnt vmcnt(13)
    v_max_u32 v2, v48, v52
    v_mfma_f32_16x16x32_bf16 v[196:199], a[4:7], v[36:39], v[196:199]
    v_cmp_eq_u32 vcc, -1, v2
    s_cbranch_vccnz .hr8
.hr8b:
    v_swap_b32 v50, v52
    s_waitcnt lgkmcnt(1)
    v_mfma_f32_16x16x32_bf16 v[184:187], a[8:11], v[32:35], v[184:187]
    ds_read_b128 a[20:23], v6 offset:13312
    v_swap_b32 v51, v53
    v_mfma_f32_16x16x32_bf16 v[200:203], a[8:11], v[36:39], v[200:203]
    buffer_load_dwordx4 v[88:91], v5, s[20:23], s25 offen offset:0
    v_mfma_f32_16x16x32_bf16 v[188:191], a[12:15], v[32:35], v[188:191]
    ds_read_b128 a[24:27], v6 offset:14336
    v_mfma_f32_16x16x32_bf16 v[204:207], a[12:15], v[36:39], v[204:207]
    buffer_load_dwordx4 v[92:95], v5, s[20:23], s25 offen offset:1024
    v_mfma_f32_16x16x32_bf16 v[240:243], v[48:51], v[48:51], v[240:243]
    ds_read_b128 a[28:31], v6 offset:15360
    v_mfma_f32_16x16x32_bf16 v[244:247], a[56:59], v[48:51], v[244:247]
    v_mfma_f32_16x16x32_bf16 v[248:251], v[52:55], v[52:55], v[248:251]
    buffer_load_dwordx4 v[96:99], v3, s[20:23], s26 offen offset:0
    v_mfma_f32_16x16x32_bf16 v[252:255], a[56:59], v[52:55], v[252:255]
    s_waitcnt lgkmcnt(2)
    v_mfma_f32_16x16x32_bf16 v[176:179], a[16:19], v[40:43], v[176:179]
    v_mfma_f32_16x16x32_bf16 v[192:195], a[16:19], v[44:47], v[192:195]
    buffer_load_dwordx4 v[100:103], v3, s[20:23], s26 offen offset:1024
    v_mfma_f32_16x16x32_bf16 v[180:183], a[20:23], v[40:43], v[180:183]
    ds_read_b128 a[0:3], v6 offset:16384
    s_waitcnt vmcnt(15)
    v_max_u32 v2, v56, v60
    v_mfma_f32_16x16x32_bf16 v[196:199], a[20:23], v[44:47], v[196:199]
    v_cmp_eq_u32 vcc, -1, v2
    s_cbranch_vccnz .hr9
.hr9b:
    v_swap_b32 v58, v60
    s_waitcnt lgkmcnt(1)
    v_mfma_f32_16x16x32_bf16 v[184:187], a[24:27], v[40:43], v[184:187]
    ds_read_b128 a[4:7], v6 offset:17408
    v_swap_b32 v59, v61
    v_mfma_f32_16x16x32_bf16 v[200:203], a[24:27], v[44:47], v[200:203]
    s_add_u32 m0, s34, 102400
    s_nop 0
    buffer_load_dwordx4 v3, s[20:23], s30 offen offset:0 lds
    v_mfma_f32_16x16x32_bf16 v[188:191], a[28:31], v[40:43], v[188:191]
    ds_read_b128 a[8:11], v6 offset:18432
    v_mfma_f32_16x16x32_bf16 v[204:207], a[28:31], v[44:47], v[204:207]
    buffer_load_dwordx4 v3, s[20:23], s30 offen offset:1024 lds
    v_mfma_f32_16x16x32_bf16 v[240:243], v[56:59], v[56:59], v[240:243]
    ds_read_b128 a[12:15], v6 offset:19456
    v_mfma_f32_16x16x32_bf16 v[244:247], a[56:59], v[56:59], v[244:247]
    v_mfma_f32_16x16x32_bf16 v[248:251], v[60:63], v[60:63], v[248:251]
    buffer_load_dwordx4 v3, s[20:23], s30 offen offset:2048 lds
    v_mfma_f32_16x16x32_bf16 v[252:255], a[56:59], v[60:63], v[252:255]
    s_waitcnt lgkmcnt(2)
    v_mfma_f32_16x16x32_bf16 v[176:179], a[0:3], v[48:51], v[176:179]
    v_mfma_f32_16x16x32_bf16 v[192:195], a[0:3], v[52:55], v[192:195]
    buffer_load_dwordx4 v3, s[20:23], s30 offen offset:3072 lds
    v_mfma_f32_16x16x32_bf16 v[180:183], a[4:7], v[48:51], v[180:183]
    s_waitcnt vmcnt(14)
    s_barrier
    ds_read_b128 a[16:19], v6 offset:20480
    s_waitcnt vmcnt(12)
    v_max_u32 v2, v64, v68
    v_mfma_f32_16x16x32_bf16 v[196:199], a[4:7], v[52:55], v[196:199]
    v_cmp_eq_u32 vcc, -1, v2
    s_cbranch_vccnz .hr10
.hr10b:
    v_swap_b32 v66, v68
    s_waitcnt lgkmcnt(1)
    v_mfma_f32_16x16x32_bf16 v[184:187], a[8:11], v[48:51], v[184:187]
    buffer_load_dword v239, v238, s[20:23], s56 offen sc1
    ds_read_b128 a[20:23], v6 offset:21504
    v_swap_b32 v67, v69
    v_mfma_f32_16x16x32_bf16 v[200:203], a[8:11], v[52:55], v[200:203]
    s_add_u32 m0, s34, 106496
    s_nop 0
    buffer_load_dwordx4 v4, s[20:23], s30 offen offset:0 lds
    s_add_u32 s30, s30, 81920
    v_mfma_f32_16x16x32_bf16 v[188:191], a[12:15], v[48:51], v[188:191]
    ds_read_b128 a[24:27], v6 offset:22528
    v_mfma_f32_16x16x32_bf16 v[204:207], a[12:15], v[52:55], v[204:207]
    buffer_load_dwordx4 v[104:107], v3, s[20:23], s26 offen offset:2048
    v_mfma_f32_16x16x32_bf16 v[240:243], v[64:67], v[64:67], v[240:243]
    ds_read_b128 a[28:31], v6 offset:23552
    v_mfma_f32_16x16x32_bf16 v[244:247], a[56:59], v[64:67], v[244:247]
    v_mfma_f32_16x16x32_bf16 v[248:251], v[68:71], v[68:71], v[248:251]
    buffer_load_dwordx4 v[108:111], v3, s[20:23], s26 offen offset:3072
    v_mfma_f32_16x16x32_bf16 v[252:255], a[56:59], v[68:71], v[252:255]
    s_waitcnt lgkmcnt(2)
    v_mfma_f32_16x16x32_bf16 v[176:179], a[16:19], v[56:59], v[176:179]
    v_mfma_f32_16x16x32_bf16 v[192:195], a[16:19], v[60:63], v[192:195]
    buffer_store_dwordx4 v[232:235], v3, s[20:23], s35 offen sc1
    v_mfma_f32_16x16x32_bf16 v[180:183], a[20:23], v[56:59], v[180:183]
    ds_read_b128 a[0:3], v6 offset:24576
    s_waitcnt vmcnt(15)
    v_max_u32 v2, v72, v76
    v_mfma_f32_16x16x32_bf16 v[196:199], a[20:23], v[60:63], v[196:199]
    v_cmp_eq_u32 vcc, -1, v2
    s_cbranch_vccnz .hr11
.hr11b:
    v_swap_b32 v74, v76
    s_waitcnt lgkmcnt(1)
    v_mfma_f32_16x16x32_bf16 v[184:187], a[24:27], v[56:59], v[184:187]
    ds_read_b128 a[4:7], v6 offset:25600
    v_swap_b32 v75, v77
    v_mfma_f32_16x16x32_bf16 v[200:203], a[24:27], v[60:63], v[200:203]
    buffer_load_dwordx4 v[112:115], v4, s[20:23], s26 offen offset:0
    v_mfma_f32_16x16x32_bf16 v[188:191], a[28:31], v[56:59], v[188:191]
    ds_read_b128 a[8:11], v6 offset:26624
    v_mfma_f32_16x16x32_bf16 v[204:207], a[28:31], v[60:63], v[204:207]
    buffer_load_dwordx4 v[116:119], v4, s[20:23], s26 offen offset:1024
    v_mfma_f32_16x16x32_bf16 v[240:243], v[72:75], v[72:75], v[240:243]
    ds_read_b128 a[12:15], v6 offset:27648
    v_mfma_f32_16x16x32_bf16 v[244:247], a[56:59], v[72:75], v[244:247]
    v_mfma_f32_16x16x32_bf16 v[248:251], v[76:79], v[76:79], v[248:251]
    buffer_store_dwordx4 v[232:235], v3, s[20:23], s36 offen sc1
    v_mfma_f32_16x16x32_bf16 v[252:255], a[56:59], v[76:79], v[252:255]
    s_waitcnt lgkmcnt(2)
    v_mfma_f32_16x16x32_bf16 v[176:179], a[0:3], v[64:67], v[176:179]
    v_mfma_f32_16x16x32_bf16 v[192:195], a[0:3], v[68:71], v[192:195]
    buffer_load_dwordx4 v[120:123], v4, s[20:23], s26 offen offset:2048
    v_mfma_f32_16x16x32_bf16 v[180:183], a[4:7], v[64:67], v[180:183]
    ds_read_b128 a[16:19], v6 offset:28672
    s_waitcnt vmcnt(17)
    v_max_u32 v2, v80, v84
    v_mfma_f32_16x16x32_bf16 v[196:199], a[4:7], v[68:71], v[196:199]
    v_cmp_eq_u32 vcc, -1, v2
    s_cbranch_vccnz .hr12
.hr12b:
    v_swap_b32 v82, v84
    s_waitcnt lgkmcnt(1)
    v_mfma_f32_16x16x32_bf16 v[184:187], a[8:11], v[64:67], v[184:187]
    ds_read_b128 a[20:23], v6 offset:29696
    v_swap_b32 v83, v85
    v_mfma_f32_16x16x32_bf16 v[200:203], a[8:11], v[68:71], v[200:203]
    buffer_load_dwordx4 v[124:127], v4, s[20:23], s26 offen offset:3072
    v_mfma_f32_16x16x32_bf16 v[188:191], a[12:15], v[64:67], v[188:191]
    ds_read_b128 a[24:27], v6 offset:30720
    v_mfma_f32_16x16x32_bf16 v[204:207], a[12:15], v[68:71], v[204:207]
    buffer_store_dwordx4 v[232:235], v4, s[20:23], s35 offen sc1
    v_mfma_f32_16x16x32_bf16 v[240:243], v[80:83], v[80:83], v[240:243]
    ds_read_b128 a[28:31], v6 offset:31744
    v_mfma_f32_16x16x32_bf16 v[244:247], a[56:59], v[80:83], v[244:247]
    v_mfma_f32_16x16x32_bf16 v[248:251], v[84:87], v[84:87], v[248:251]
    buffer_store_dwordx4 v[232:235], v4, s[20:23], s36 offen sc1
    v_mfma_f32_16x16x32_bf16 v[252:255], a[56:59], v[84:87], v[252:255]
    s_waitcnt lgkmcnt(2)
    v_mfma_f32_16x16x32_bf16 v[176:179], a[16:19], v[72:75], v[176:179]
    v_mfma_f32_16x16x32_bf16 v[192:195], a[16:19], v[76:79], v[192:195]
    buffer_load_dwordx4 v[128:131], v5, s[20:23], s26 offen offset:0
    v_mfma_f32_16x16x32_bf16 v[180:183], a[20:23], v[72:75], v[180:183]
    ds_read_b128 a[0:3], v6 offset:32768
    s_waitcnt vmcnt(19)
    v_max_u32 v2, v88, v92
    v_mfma_f32_16x16x32_bf16 v[196:199], a[20:23], v[76:79], v[196:199]
    v_cmp_eq_u32 vcc, -1, v2
    s_cbranch_vccnz .hr13
.hr13b:
    v_swap_b32 v90, v92
    s_waitcnt lgkmcnt(1)
    v_mfma_f32_16x16x32_bf16 v[184:187], a[24:27], v[72:75], v[184:187]
    ds_read_b128 a[4:7], v6 offset:33792
    v_swap_b32 v91, v93
    v_mfma_f32_16x16x32_bf16 v[200:203], a[24:27], v[76:79], v[200:203]
    buffer_load_dwordx4 v[132:135], v5, s[20:23], s26 offen offset:1024
    v_mfma_f32_16x16x32_bf16 v[188:191], a[28:31], v[72:75], v[188:191]
    ds_read_b128 a[8:11], v6 offset:34816
    v_mfma_f32_16x16x32_bf16 v[204:207], a[28:31], v[76:79], v[204:207]
    buffer_store_dwordx4 v[232:235], v5, s[20:23], s35 offen sc1
    v_mfma_f32_16x16x32_bf16 v[240:243], v[88:91], v[88:91], v[240:243]
    s_waitcnt vmcnt(14)
    v_cmp_eq_u32 vcc, -1, v239
    s_cbranch_vccnz .rl14
.rl14b:
    ds_read_b128 a[12:15], v6 offset:35840
    v_mfma_f32_16x16x32_bf16 v[244:247], a[56:59], v[88:91], v[244:247]
    v_mfma_f32_16x16x32_bf16 v[248:251], v[92:95], v[92:95], v[248:251]
    buffer_load_dwordx4 v[136:139], v3, s[20:23], s27 offen offset:0
    v_mfma_f32_16x16x32_bf16 v[252:255], a[56:59], v[92:95], v[252:255]
    s_waitcnt lgkmcnt(2)
    v_mfma_f32_16x16x32_bf16 v[176:179], a[0:3], v[80:83], v[176:179]
    v_mfma_f32_16x16x32_bf16 v[192:195], a[0:3], v[84:87], v[192:195]
    buffer_load_dwordx4 v[140:143], v3, s[20:23], s27 offen offset:1024
    v_mfma_f32_16x16x32_bf16 v[180:183], a[4:7], v[80:83], v[180:183]
    ds_read_b128 a[16:19], v6 offset:36864
    v_max_u32 v2, v96, v100
    v_mfma_f32_16x16x32_bf16 v[196:199], a[4:7], v[84:87], v[196:199]
    v_cmp_eq_u32 vcc, -1, v2
    s_cbranch_vccnz .hr15
.hr15b:
    v_swap_b32 v98, v100
    s_waitcnt lgkmcnt(1)
    v_mfma_f32_16x16x32_bf16 v[184:187], a[8:11], v[80:83], v[184:187]
    ds_read_b128 a[20:23], v6 offset:37888
    v_swap_b32 v99, v101
    v_mfma_f32_16x16x32_bf16 v[200:203], a[8:11], v[84:87], v[200:203]
    buffer_store_dwordx4 v[232:235], v5, s[20:23], s36 offen sc1
    v_mfma_f32_16x16x32_bf16 v[188:191], a[12:15], v[80:83], v[188:191]
    ds_read_b128 a[24:27], v6 offset:38912
    v_mfma_f32_16x16x32_bf16 v[204:207], a[12:15], v[84:87], v[204:207]
    s_add_u32 m0, s34, 122880
    s_nop 0
    buffer_load_dwordx4 v3, s[20:23], s31 offen offset:0 lds
    v_mfma_f32_16x16x32_bf16 v[240:243], v[96:99], v[96:99], v[240:243]
    ds_read_b128 a[28:31], v6 offset:39936
    v_mfma_f32_16x16x32_bf16 v[244:247], a[56:59], v[96:99], v[244:247]
    v_mfma_f32_16x16x32_bf16 v[248:251], v[100:103], v[100:103], v[248:251]
    buffer_load_dwordx4 v3, s[20:23], s31 offen offset:1024 lds
    v_mfma_f32_16x16x32_bf16 v[252:255], a[56:59], v[100:103], v[252:255]
    s_waitcnt lgkmcnt(2)
    v_mfma_f32_16x16x32_bf16 v[176:179], a[16:19], v[88:91], v[176:179]
    v_mfma_f32_16x16x32_bf16 v[192:195], a[16:19], v[92:95], v[192:195]
    buffer_load_dwordx4 v3, s[20:23], s31 offen offset:2048 lds
    v_mfma_f32_16x16x32_bf16 v[180:183], a[20:23], v[88:91], v[180:183]
    s_waitcnt vmcnt(19)
    s_barrier
    ds_read_b128 a[0:3], v6 offset:40960
    s_waitcnt vmcnt(17)
    v_max_u32 v2, v104, v108
    v_mfma_f32_16x16x32_bf16 v[196:199], a[20:23], v[92:95], v[196:199]
    v_cmp_eq_u32 vcc, -1, v2
    s_cbranch_vccnz .hr16
.hr16b:
    v_swap_b32 v106, v108
    s_waitcnt lgkmcnt(1)
    v_mfma_f32_16x16x32_bf16 v[184:187], a[24:27], v[88:91], v[184:187]
    ds_read_b128 a[4:7], v6 offset:41984
    v_swap_b32 v107, v109
    v_mfma_f32_16x16x32_bf16 v[200:203], a[24:27], v[92:95], v[200:203]
    buffer_load_dwordx4 v3, s[20:23], s31 offen offset:3072 lds
    v_mfma_f32_16x16x32_bf16 v[188:191], a[28:31], v[88:91], v[188:191]
    ds_read_b128 a[8:11], v6 offset:43008
    v_mfma_f32_16x16x32_bf16 v[204:207], a[28:31], v[92:95], v[204:207]
    s_add_u32 m0, s34, 126976
    s_nop 0
    buffer_load_dwordx4 v4, s[20:23], s31 offen offset:0 lds
    s_add_u32 s31, s31, 81920
    v_mfma_f32_16x16x32_bf16 v[240:243], v[104:107], v[104:107], v[240:243]
    ds_read_b128 a[12:15], v6 offset:44032
    v_mfma_f32_16x16x32_bf16 v[244:247], a[56:59], v[104:107], v[244:247]
    v_mfma_f32_16x16x32_bf16 v[248:251], v[108:111], v[108:111], v[248:251]
    s_add_u32 m0, s34, 143360
    s_nop 0
    buffer_load_dwordx4 v3, s[20:23], s28 offen offset:0 lds
    v_mfma_f32_16x16x32_bf16 v[252:255], a[56:59], v[108:111], v[252:255]
    s_waitcnt lgkmcnt(2)
    v_mfma_f32_16x16x32_bf16 v[176:179], a[0:3], v[96:99], v[176:179]
    v_mfma_f32_16x16x32_bf16 v[192:195], a[0:3], v[100:103], v[192:195]
    buffer_load_dwordx4 v3, s[20:23], s28 offen offset:1024 lds
    v_mfma_f32_16x16x32_bf16 v[180:183], a[4:7], v[96:99], v[180:183]
    ds_read_b128 a[16:19], v6 offset:45056
    s_waitcnt vmcnt(18)
    v_max_u32 v2, v112, v116
    v_mfma_f32_16x16x32_bf16 v[196:199], a[4:7], v[100:103], v[196:199]
    v_cmp_eq_u32 vcc, -1, v2
    s_cbranch_vccnz .hr17
.hr17b:
    v_swap_b32 v114, v116
    s_waitcnt lgkmcnt(1)
    v_mfma_f32_16x16x32_bf16 v[184:187], a[8:11], v[96:99], v[184:187]
    ds_read_b128 a[20:23], v6 offset:46080
    v_swap_b32 v115, v117
    v_mfma_f32_16x16x32_bf16 v[200:203], a[8:11], v[100:103], v[200:203]
    buffer_load_dwordx4 v3, s[20:23], s28 offen offset:2048 lds
    v_mfma_f32_16x16x32_bf16 v[188:191], a[12:15], v[96:99], v[188:191]
    ds_read_b128 a[24:27], v6 offset:47104
    v_mfma_f32_16x16x32_bf16 v[204:207], a[12:15], v[100:103], v[204:207]
    buffer_load_dwordx4 v3, s[20:23], s28 offen offset:3072 lds
    v_mfma_f32_16x16x32_bf16 v[240:243], v[112:115], v[112:115], v[240:243]
    ds_read_b128 a[28:31], v6 offset:48128
    v_mfma_f32_16x16x32_bf16 v[244:247], a[56:59], v[112:115], v[244:247]
    v_mfma_f32_16x16x32_bf16 v[248:251], v[116:119], v[116:119], v[248:251]
    s_add_u32 m0, s34, 147456
    s_nop 0
    buffer_load_dwordx4 v4, s[20:23], s28 offen offset:0 lds
    s_add_u32 s28, s28, 81920
    v_mfma_f32_16x16x32_bf16 v[252:255], a[56:59], v[116:119], v[252:255]
    s_waitcnt lgkmcnt(2)
    v_mfma_f32_16x16x32_bf16 v[176:179], a[16:19], v[104:107], v[176:179]
    v_mfma_f32_16x16x32_bf16 v[192:195], a[16:19], v[108:111], v[192:195]
    s_add_u32 m0, s34, 0
    s_nop 0
    buffer_load_dwordx4 v3, s[20:23], s29 offen offset:0 lds
    v_mfma_f32_16x16x32_bf16 v[180:183], a[20:23], v[104:107], v[180:183]
    ds_read_b128 a[0:3], v6 offset:49152
    s_waitcnt vmcnt(19)
    v_max_u32 v2, v120, v124
    v_mfma_f32_16x16x32_bf16 v[196:199], a[20:23], v[108:111], v[196:199]
    v_cmp_eq_u32 vcc, -1, v2
    s_cbranch_vccnz .hr18
.hr18b:
    v_swap_b32 v122, v124
    s_waitcnt lgkmcnt(1)
    v_mfma_f32_16x16x32_bf16 v[184:187], a[24:27], v[104:107], v[184:187]
    ds_read_b128 a[4:7], v6 offset:50176
    v_swap_b32 v123, v125
    v_mfma_f32_16x16x32_bf16 v[200:203], a[24:27], v[108:111], v[200:203]
    buffer_load_dwordx4 v3, s[20:23], s29 offen offset:1024 lds
    v_mfma_f32_16x16x32_bf16 v[188:191], a[28:31], v[104:107], v[188:191]
    ds_read_b128 a[8:11], v6 offset:51200
    v_mfma_f32_16x16x32_bf16 v[204:207], a[28:31], v[108:111], v[204:207]
    buffer_load_dwordx4 v3, s[20:23], s29 offen offset:2048 lds
    v_mfma_f32_16x16x32_bf16 v[240:243], v[120:123], v[120:123], v[240:243]
    ds_read_b128 a[12:15], v6 offset:52224
    v_mfma_f32_16x16x32_bf16 v[244:247], a[56:59], v[120:123], v[244:247]
    v_mfma_f32_16x16x32_bf16 v[248:251], v[124:127], v[124:127], v[248:251]
    buffer_load_dwordx4 v3, s[20:23], s29 offen offset:3072 lds
    v_mfma_f32_16x16x32_bf16 v[252:255], a[56:59], v[124:127], v[252:255]
    s_waitcnt lgkmcnt(2)
    v_mfma_f32_16x16x32_bf16 v[176:179], a[0:3], v[112:115], v[176:179]
    v_mfma_f32_16x16x32_bf16 v[192:195], a[0:3], v[116:119], v[192:195]
    s_add_u32 m0, s34, 4096
    s_nop 0
    buffer_load_dwordx4 v4, s[20:23], s29 offen offset:0 lds
    s_add_u32 s29, s29, 81920
    v_mfma_f32_16x16x32_bf16 v[180:183], a[4:7], v[112:115], v[180:183]
    ds_read_b128 a[16:19], v6 offset:53248
    s_waitcnt vmcnt(19)
    v_max_u32 v2, v128, v132
    v_mfma_f32_16x16x32_bf16 v[196:199], a[4:7], v[116:119], v[196:199]
    v_cmp_eq_u32 vcc, -1, v2
    s_cbranch_vccnz .hr19
.hr19b:
    v_swap_b32 v130, v132
    s_waitcnt lgkmcnt(1)
    v_mfma_f32_16x16x32_bf16 v[184:187], a[8:11], v[112:115], v[184:187]
    ds_read_b128 a[20:23], v6 offset:54272
    v_swap_b32 v131, v133
    v_mfma_f32_16x16x32_bf16 v[200:203], a[8:11], v[116:119], v[200:203]
    buffer_store_dwordx2 v[232:233], v12, s[20:23], s37 offen sc1
    v_mfma_f32_16x16x32_bf16 v[188:191], a[12:15], v[112:115], v[188:191]
    ds_read_b128 a[24:27], v6 offset:55296
    v_mfma_f32_16x16x32_bf16 v[204:207], a[12:15], v[116:119], v[204:207]
    buffer_load_dwordx4 v[144:147], v3, s[20:23], s27 offen offset:2048
    v_mfma_f32_16x16x32_bf16 v[240:243], v[128:131], v[128:131], v[240:243]
    ds_read_b128 a[28:31], v6 offset:56320
    v_mfma_f32_16x16x32_bf16 v[244:247], a[56:59], v[128:131], v[244:247]
    v_mfma_f32_16x16x32_bf16 v[248:251], v[132:135], v[132:135], v[248:251]
    buffer_load_dwordx4 v[148:151], v3, s[20:23], s27 offen offset:3072
    v_mfma_f32_16x16x32_bf16 v[252:255], a[56:59], v[132:135], v[252:255]
    s_waitcnt lgkmcnt(2)
    v_mfma_f32_16x16x32_bf16 v[176:179], a[16:19], v[120:123], v[176:179]
    v_mfma_f32_16x16x32_bf16 v[192:195], a[16:19], v[124:127], v[192:195]
    buffer_store_dwordx2 v[232:233], v12, s[20:23], s38 offen sc1
    v_mfma_f32_16x16x32_bf16 v[180:183], a[20:23], v[120:123], v[180:183]
    ds_read_b128 a[0:3], v6 offset:57344
    s_waitcnt vmcnt(20)
    v_max_u32 v2, v136, v140
    v_mfma_f32_16x16x32_bf16 v[196:199], a[20:23], v[124:127], v[196:199]
    v_cmp_eq_u32 vcc, -1, v2
    s_cbranch_vccnz .hr20
.hr20b:
    v_swap_b32 v138, v140
    s_waitcnt lgkmcnt(1)
    v_mfma_f32_16x16x32_bf16 v[184:187], a[24:27], v[120:123], v[184:187]
    ds_read_b128 a[4:7], v6 offset:58368
    v_swap_b32 v139, v141
    v_mfma_f32_16x16x32_bf16 v[200:203], a[24:27], v[124:127], v[200:203]
    buffer_load_dwordx4 v[152:155], v4, s[20:23], s27 offen offset:0
    v_mfma_f32_16x16x32_bf16 v[188:191], a[28:31], v[120:123], v[188:191]
    ds_read_b128 a[8:11], v6 offset:59392
    v_mfma_f32_16x16x32_bf16 v[204:207], a[28:31], v[124:127], v[204:207]
    buffer_load_dwordx4 v[156:159], v4, s[20:23], s27 offen offset:1024
    v_mfma_f32_16x16x32_bf16 v[240:243], v[136:139], v[136:139], v[240:243]
    ds_read_b128 a[12:15], v6 offset:60416
    v_mfma_f32_16x16x32_bf16 v[244:247], a[56:59], v[136:139], v[244:247]
    v_mfma_f32_16x16x32_bf16 v[248:251], v[140:143], v[140:143], v[248:251]
    buffer_load_dwordx4 a[32:35], v3, s[20:23], s51 offen offset:0 sc1
    v_mfma_f32_16x16x32_bf16 v[252:255], a[56:59], v[140:143], v[252:255]
    s_waitcnt lgkmcnt(2)
    v_mfma_f32_16x16x32_bf16 v[176:179], a[0:3], v[128:131], v[176:179]
    v_mfma_f32_16x16x32_bf16 v[192:195], a[0:3], v[132:135], v[192:195]
    buffer_load_dwordx4 v[160:163], v4, s[20:23], s27 offen offset:2048
    v_mfma_f32_16x16x32_bf16 v[180:183], a[4:7], v[128:131], v[180:183]
    s_waitcnt vmcnt(18)
    s_barrier
    ds_read_b128 a[16:19], v7 offset:0
    s_waitcnt vmcnt(5)
    v_max_u32 v2, v144, v148
    v_mfma_f32_16x16x32_bf16 v[196:199], a[4:7], v[132:135], v[196:199]
    v_cmp_eq_u32 vcc, -1, v2
    s_cbranch_vccnz .hr21
.hr21b:
    v_swap_b32 v146, v148
    s_waitcnt lgkmcnt(1)
    v_mfma_f32_16x16x32_bf16 v[184:187], a[8:11], v[128:131], v[184:187]
    ds_read_b128 a[20:23], v7 offset:1024
    v_swap_b32 v147, v149
    v_mfma_f32_16x16x32_bf16 v[200:203], a[8:11], v[132:135], v[200:203]
    buffer_load_dwordx4 v[164:167], v4, s[20:23], s27 offen offset:3072
    v_mfma_f32_16x16x32_bf16 v[188:191], a[12:15], v[128:131], v[188:191]
    ds_read_b128 a[24:27], v7 offset:2048
    v_mfma_f32_16x16x32_bf16 v[204:207], a[12:15], v[132:135], v[204:207]
    buffer_load_dwordx4 v[168:171], v5, s[20:23], s27 offen offset:0
    v_mfma_f32_16x16x32_bf16 v[240:243], v[144:147], v[144:147], v[240:243]
    ds_read_b128 a[28:31], v7 offset:3072
    v_mfma_f32_16x16x32_bf16 v[244:247], a[56:59], v[144:147], v[244:247]
    v_mfma_f32_16x16x32_bf16 v[248:251], v[148:151], v[148:151], v[248:251]
    buffer_load_dwordx4 v[172:175], v5, s[20:23], s27 offen offset:1024
    v_mfma_f32_16x16x32_bf16 v[252:255], a[56:59], v[148:151], v[252:255]
    s_waitcnt lgkmcnt(2)
    v_mfma_f32_16x16x32_bf16 v[176:179], a[16:19], v[136:139], v[176:179]
    v_mfma_f32_16x16x32_bf16 v[192:195], a[16:19], v[140:143], v[192:195]
    v_mfma_f32_16x16x32_bf16 v[180:183], a[20:23], v[136:139], v[180:183]
    ds_read_b128 a[0:3], v7 offset:4096
    s_waitcnt vmcnt(5)
    v_max_u32 v2, v152, v156
    v_mfma_f32_16x16x32_bf16 v[196:199], a[20:23], v[140:143], v[196:199]
    s_add_u32 m0, s34, 20480
    s_nop 0
    buffer_load_dwordx4 v3, s[20:23], s30 offen offset:0 lds
    v_cmp_eq_u32 vcc, -1, v2
    s_cbranch_vccnz .hr22
.hr22b:
    v_swap_b32 v154, v156
    s_waitcnt lgkmcnt(1)
    v_mfma_f32_16x16x32_bf16 v[184:187], a[24:27], v[136:139], v[184:187]
    ds_read_b128 a[4:7], v7 offset:5120
    v_swap_b32 v155, v157
    v_mfma_f32_16x16x32_bf16 v[200:203], a[24:27], v[140:143], v[200:203]
    v_mfma_f32_16x16x32_bf16 v[188:191], a[28:31], v[136:139], v[188:191]
    ds_read_b128 a[8:11], v7 offset:6144
    v_mfma_f32_16x16x32_bf16 v[204:207], a[28:31], v[140:143], v[204:207]
    buffer_load_dwordx4 v3, s[20:23], s30 offen offset:1024 lds
    v_mfma_f32_16x16x32_bf16 v[240:243], v[152:155], v[152:155], v[240:243]
    ds_read_b128 a[12:15], v7 offset:7168
    v_mfma_f32_16x16x32_bf16 v[244:247], a[56:59], v[152:155], v[244:247]
    v_mfma_f32_16x16x32_bf16 v[248:251], v[156:159], v[156:159], v[248:251]
    buffer_load_dwordx4 v3, s[20:23], s30 offen offset:2048 lds
    v_mfma_f32_16x16x32_bf16 v[252:255], a[56:59], v[156:159], v[252:255]
    s_waitcnt lgkmcnt(2)
    v_mfma_f32_16x16x32_bf16 v[176:179], a[0:3], v[144:147], v[176:179]
    v_mfma_f32_16x16x32_bf16 v[192:195], a[0:3], v[148:151], v[192:195]
    v_mfma_f32_16x16x32_bf16 v[180:183], a[4:7], v[144:147], v[180:183]
    ds_read_b128 a[16:19], v7 offset:8192
    s_waitcnt vmcnt(5)
    v_max_u32 v2, v160, v164
    v_mfma_f32_16x16x32_bf16 v[196:199], a[4:7], v[148:151], v[196:199]
    buffer_load_dwordx4 v3, s[20:23], s30 offen offset:3072 lds
    v_cmp_eq_u32 vcc, -1, v2
    s_cbranch_vccnz .hr23
.hr23b:
    v_swap_b32 v162, v164
    s_waitcnt lgkmcnt(1)
    v_mfma_f32_16x16x32_bf16 v[184:187], a[8:11], v[144:147], v[184:187]
    ds_read_b128 a[20:23], v7 offset:9216
    v_swap_b32 v163, v165
    v_mfma_f32_16x16x32_bf16 v[200:203], a[8:11], v[148:151], v[200:203]
    v_mfma_f32_16x16x32_bf16 v[188:191], a[12:15], v[144:147], v[188:191]
    ds_read_b128 a[24:27], v7 offset:10240
    v_mfma_f32_16x16x32_bf16 v[204:207], a[12:15], v[148:151], v[204:207]
    s_add_u32 m0, s34, 24576
    s_nop 0
    buffer_load_dwordx4 v4, s[20:23], s30 offen offset:0 lds
    s_add_u32 s30, s30, 81920
    v_mfma_f32_16x16x32_bf16 v[240:243], v[160:163], v[160:163], v[240:243]
    ds_read_b128 a[28:31], v7 offset:11264
    v_mfma_f32_16x16x32_bf16 v[244:247], a[56:59], v[160:163], v[244:247]
    v_mfma_f32_16x16x32_bf16 v[248:251], v[164:167], v[164:167], v[248:251]
    s_add_u32 m0, s34, 40960
    s_nop 0
    buffer_load_dwordx4 v3, s[20:23], s31 offen offset:0 lds
    v_mfma_f32_16x16x32_bf16 v[252:255], a[56:59], v[164:167], v[252:255]
    s_waitcnt lgkmcnt(2)
    v_mfma_f32_16x16x32_bf16 v[176:179], a[16:19], v[152:155], v[176:179]
    v_mfma_f32_16x16x32_bf16 v[192:195], a[16:19], v[156:159], v[192:195]
    v_mfma_f32_16x16x32_bf16 v[180:183], a[20:23], v[152:155], v[180:183]
    ds_read_b128 a[0:3], v7 offset:12288
    s_waitcnt vmcnt(6)
    v_max_u32 v2, v168, v172
    v_mfma_f32_16x16x32_bf16 v[196:199], a[20:23], v[156:159], v[196:199]
    buffer_load_dwordx4 v3, s[20:23], s31 offen offset:1024 lds
    v_cmp_eq_u32 vcc, -1, v2
    s_cbranch_vccnz .hr24
.hr24b:
    v_swap_b32 v170, v172
    s_waitcnt lgkmcnt(1)
    v_mfma_f32_16x16x32_bf16 v[184:187], a[24:27], v[152:155], v[184:187]
    ds_read_b128 a[4:7], v7 offset:13312
    v_swap_b32 v171, v173
    v_mfma_f32_16x16x32_bf16 v[200:203], a[24:27], v[156:159], v[200:203]
    v_mfma_f32_16x16x32_bf16 v[188:191], a[28:31], v[152:155], v[188:191]
    ds_read_b128 a[8:11], v7 offset:14336
    v_mfma_f32_16x16x32_bf16 v[204:207], a[28:31], v[156:159], v[204:207]
    buffer_load_dwordx4 v3, s[20:23], s31 offen offset:2048 lds
    v_mfma_f32_16x16x32_bf16 v[240:243], v[168:171], v[168:171], v[240:243]
    ds_read_b128 a[12:15], v7 offset:15360
    v_mfma_f32_16x16x32_bf16 v[244:247], a[56:59], v[168:171], v[244:247]
    v_mfma_f32_16x16x32_bf16 v[248:251], v[172:175], v[172:175], v[248:251]
    ds_read_b128 a[16:19], v7 offset:16384
    v_mfma_f32_16x16x32_bf16 v[252:255], a[56:59], v[172:175], v[252:255]
    buffer_load_dwordx4 v3, s[20:23], s31 offen offset:3072 lds
    s_waitcnt lgkmcnt(3)
    v_mfma_f32_16x16x32_bf16 v[176:179], a[0:3], v[160:163], v[176:179]
    ds_read_b128 a[20:23], v7 offset:17408
    v_mfma_f32_16x16x32_bf16 v[192:195], a[0:3], v[164:167], v[192:195]
    v_cndmask_b32_e64 v240, v240, v241, s[52:53]
    v_cndmask_b32_e64 v248, v248, v249, s[52:53]
    v_mfma_f32_16x16x32_bf16 v[180:183], a[4:7], v[160:163], v[180:183]
    ds_read_b128 a[24:27], v7 offset:18432
    v_cndmask_b32_e64 v242, v242, v243, s[52:53]
    v_mfma_f32_16x16x32_bf16 v[196:199], a[4:7], v[164:167], v[196:199]
    s_add_u32 m0, s34, 45056
    s_nop 0
    buffer_load_dwordx4 v4, s[20:23], s31 offen offset:0 lds
    s_add_u32 s31, s31, 81920
    v_cndmask_b32_e64 v250, v250, v251, s[52:53]
    v_mul_f32 v244, s58, v244
    s_waitcnt lgkmcnt(3)
    v_mfma_f32_16x16x32_bf16 v[184:187], a[8:11], v[160:163], v[184:187]
    ds_read_b128 a[28:31], v7 offset:19456
    v_mul_f32 v252, s58, v252
    v_mfma_f32_16x16x32_bf16 v[200:203], a[8:11], v[164:167], v[200:203]
    v_cndmask_b32_e64 v240, v240, v242, s[54:55]
    v_cndmask_b32_e64 v248, v248, v250, s[54:55]
    v_mfma_f32_16x16x32_bf16 v[188:191], a[12:15], v[160:163], v[188:191]
    buffer_load_dwordx4 a[36:39], v3, s[20:23], s51 offen offset:1024 sc1
    v_cvt_pk_bf16_f32 v245, -v244, -v244
    v_cvt_pk_bf16_f32 v253, -v252, -v252
    v_mfma_f32_16x16x32_bf16 v[204:207], a[12:15], v[164:167], v[204:207]
    ds_bpermute_b32 v240, v13, v240
    ds_bpermute_b32 v248, v13, v248
    s_waitcnt lgkmcnt(4)
    v_mfma_f32_16x16x32_bf16 v[176:179], a[16:19], v[168:171], v[176:179]
    v_accvgpr_write_b32 a48, v245
    v_accvgpr_write_b32 a52, v253
    v_mfma_f32_16x16x32_bf16 v[192:195], a[16:19], v[172:175], v[192:195]
    v_accvgpr_write_b32 a51, v245
    v_accvgpr_write_b32 a55, v253
    v_mfma_f32_16x16x32_bf16 v[180:183], a[20:23], v[168:171], v[180:183]
    s_add_u32 m0, s34, 61440
    s_nop 0
    buffer_load_dwordx4 v3, s[20:23], s28 offen offset:0 lds
    s_waitcnt lgkmcnt(1)
    s_waitcnt lgkmcnt(0)
    v_mfma_f32_16x16x32_bf16 v[196:199], a[20:23], v[172:175], v[196:199]
    s_mov_b64 exec, 1
    buffer_store_dword v3, off, s[20:23], s62 offset:0 sc1
    s_mov_b64 exec, -1
    v_mul_f32 v240, s58, v240
    v_mul_f32 v248, s58, v248
    v_mfma_f32_16x16x32_bf16 v[184:187], a[24:27], v[168:171], v[184:187]
    v_fma_f32 v240, -v244, v244, v240
    v_fma_f32 v248, -v252, v252, v248
    v_mfma_f32_16x16x32_bf16 v[200:203], a[24:27], v[172:175], v[200:203]
    v_max_f32 v240, 0, v240
    v_max_f32 v248, 0, v248
    v_mfma_f32_16x16x32_bf16 v[188:191], a[28:31], v[168:171], v[188:191]
    s_barrier
    ds_read_b128 a[0:3], v7 offset:20480
    v_cvt_pk_bf16_f32 v240, v240, v240
    v_mfma_f32_16x16x32_bf16 v[204:207], a[28:31], v[172:175], v[204:207]
    buffer_load_dwordx4 v3, s[20:23], s28 offen offset:1024 lds
    v_cvt_pk_bf16_f32 v248, v248, v248
    v_and_b32 v240, s59, v240
    v_mfma_f32_16x16x16_bf16 v[176:179], a[32:33], a[48:49], v[176:179]
    ds_read_b128 a[4:7], v7 offset:21504
    v_mfma_f32_16x16x16_bf16 v[192:195], a[32:33], a[52:53], v[192:195]
    v_and_b32 v248, s59, v248
    v_mfma_f32_16x16x16_bf16 v[180:183], a[32:33], a[50:51], v[180:183]
    ds_read_b128 a[8:11], v7 offset:22528
    v_mfma_f32_16x16x16_bf16 v[196:199], a[32:33], a[54:55], v[196:199]
    buffer_load_dwordx4 v3, s[20:23], s28 offen offset:2048 lds
    v_add_f32 v240, 0x3727c5ac, v240
    v_mfma_f32_16x16x16_bf16 v[184:187], a[34:35], a[48:49], v[184:187]
    ds_read_b128 a[12:15], v7 offset:23552
    v_mfma_f32_16x16x16_bf16 v[200:203], a[34:35], a[52:53], v[200:203]
    v_add_f32 v248, 0x3727c5ac, v248
    v_mfma_f32_16x16x16_bf16 v[188:191], a[34:35], a[50:51], v[188:191]
    ds_read_b128 a[16:19], v7 offset:24576
    v_mfma_f32_16x16x16_bf16 v[204:207], a[34:35], a[54:55], v[204:207]
    buffer_load_dwordx4 v3, s[20:23], s28 offen offset:3072 lds
    v_cvt_pk_bf16_f32 v240, v240, v240
    s_waitcnt lgkmcnt(3)
    v_mfma_f32_16x16x32_bf16 v[208:211], a[0:3], v[16:19], 0
    ds_read_b128 a[20:23], v7 offset:25600
    v_cvt_pk_bf16_f32 v248, v248, v248
    v_mfma_f32_16x16x32_bf16 v[224:227], a[0:3], v[20:23], 0
    v_and_b32 v240, s59, v240
    v_and_b32 v248, s59, v248
    v_mfma_f32_16x16x32_bf16 v[212:215], a[4:7], v[16:19], 0
    ds_read_b128 a[24:27], v7 offset:26624
    v_mfma_f32_16x16x32_bf16 v[228:231], a[4:7], v[20:23], 0
    s_add_u32 m0, s34, 65536
    s_nop 0
    buffer_load_dwordx4 v4, s[20:23], s28 offen offset:0 lds
    v_sqrt_f32 v240, v240
    s_waitcnt lgkmcnt(3)
    v_mfma_f32_16x16x32_bf16 v[216:219], a[8:11], v[16:19], 0
    ds_read_b128 a[28:31], v7 offset:27648
    v_mfma_f32_16x16x32_bf16 v[232:235], a[8:11], v[20:23], 0
    v_sqrt_f32 v248, v248
    v_mfma_f32_16x16x32_bf16 v[220:223], a[12:15], v[16:19], 0
    ds_read_b128 a[0:3], v7 offset:28672
    v_cvt_pk_bf16_f32 v240, v240, v240
    v_mfma_f32_16x16x32_bf16 v[236:239], a[12:15], v[20:23], 0
    s_add_u32 m0, s34, 81920
    s_nop 0
    buffer_load_dwordx4 v3, s[20:23], s29 offen offset:0 lds
    v_cvt_pk_bf16_f32 v248, v248, v248
    v_and_b32 v240, s59, v240
    s_waitcnt lgkmcnt(3)
    v_mfma_f32_16x16x32_bf16 v[208:211], a[16:19], v[24:27], v[208:211]
    ds_read_b128 a[4:7], v7 offset:29696
    v_and_b32 v248, s59, v248
    v_mfma_f32_16x16x32_bf16 v[224:227], a[16:19], v[28:31], v[224:227]
    v_rcp_f32 v14, v240
    v_mfma_f32_16x16x32_bf16 v[212:215], a[20:23], v[24:27], v[212:215]
    ds_read_b128 a[8:11], v7 offset:30720
    v_mfma_f32_16x16x32_bf16 v[228:231], a[20:23], v[28:31], v[228:231]
    buffer_load_dwordx4 v3, s[20:23], s29 offen offset:1024 lds
    v_rcp_f32 v15, v248
    s_waitcnt lgkmcnt(3)
    v_mfma_f32_16x16x32_bf16 v[216:219], a[24:27], v[24:27], v[216:219]
    ds_read_b128 a[12:15], v7 offset:31744
    v_mul_f32 v0, v240, v240
    v_mfma_f32_16x16x32_bf16 v[232:235], a[24:27], v[28:31], v[232:235]
    v_mul_f32 v1, v248, v248
    v_mul_f32 v14, 0xbfb8aa3b, v14
    v_mfma_f32_16x16x32_bf16 v[220:223], a[28:31], v[24:27], v[220:223]
    ds_read_b128 a[16:19], v7 offset:32768
    v_mul_f32 v15, 0xbfb8aa3b, v15
    v_mfma_f32_16x16x32_bf16 v[236:239], a[28:31], v[28:31], v[236:239]
    buffer_load_dwordx4 v3, s[20:23], s29 offen offset:2048 lds
    v_mul_f32 v178, v176, v178
    v_mul_f32 v179, v177, v179
    s_waitcnt lgkmcnt(3)
    v_mfma_f32_16x16x32_bf16 v[208:211], a[0:3], v[32:35], v[208:211]
    ds_read_b128 a[20:23], v7 offset:33792
    v_mul_f32 v176, v14, v176
    v_mfma_f32_16x16x32_bf16 v[224:227], a[0:3], v[36:39], v[224:227]
    v_mul_f32 v177, v14, v177
    v_mfma_f32_16x16x32_bf16 v[212:215], a[4:7], v[32:35], v[212:215]
    ds_read_b128 a[24:27], v7 offset:34816
    v_mfma_f32_16x16x32_bf16 v[228:231], a[4:7], v[36:39], v[228:231]
    buffer_load_dwordx4 v3, s[20:23], s29 offen offset:3072 lds
    v_exp_f32 v176, v176
    s_waitcnt lgkmcnt(3)
    v_mfma_f32_16x16x32_bf16 v[216:219], a[8:11], v[32:35], v[216:219]
    ds_read_b128 a[28:31], v7 offset:35840
    v_mfma_f32_16x16x32_bf16 v[232:235], a[8:11], v[36:39], v[232:235]
    v_exp_f32 v177, v177
    v_mfma_f32_16x16x32_bf16 v[220:223], a[12:15], v[32:35], v[220:223]
    ds_read_b128 a[0:3], v7 offset:36864
    v_fma_f32 v176, v176, v0, v0
    v_mfma_f32_16x16x32_bf16 v[236:239], a[12:15], v[36:39], v[236:239]
    s_add_u32 m0, s34, 86016
    s_nop 0
    buffer_load_dwordx4 v4, s[20:23], s29 offen offset:0 lds
    v_fma_f32 v177, v177, v0, v0
    s_waitcnt lgkmcnt(3)
    v_mfma_f32_16x16x32_bf16 v[208:211], a[16:19], v[40:43], v[208:211]
    ds_read_b128 a[4:7], v7 offset:37888
    v_mfma_f32_16x16x32_bf16 v[224:227], a[16:19], v[44:47], v[224:227]
    v_rcp_f32 v176, v176
    v_mfma_f32_16x16x32_bf16 v[212:215], a[20:23], v[40:43], v[212:215]
    ds_read_b128 a[8:11], v7 offset:38912
    v_mfma_f32_16x16x32_bf16 v[228:231], a[20:23], v[44:47], v[228:231]
    s_add_u32 m0, s34, 102400
    s_nop 0
    buffer_load_dwordx4 v3, s[20:23], s30 offen offset:0 lds
    v_rcp_f32 v177, v177
    s_waitcnt lgkmcnt(3)
    v_mfma_f32_16x16x32_bf16 v[216:219], a[24:27], v[40:43], v[216:219]
    ds_read_b128 a[12:15], v7 offset:39936
    v_mul_f32 v178, v178, v176
    v_mfma_f32_16x16x32_bf16 v[232:235], a[24:27], v[44:47], v[232:235]
    v_mul_f32 v179, v179, v177
    v_cvt_pk_bf16_f32 v176, v178, v179
    v_mfma_f32_16x16x32_bf16 v[220:223], a[28:31], v[40:43], v[220:223]
    ds_read_b128 a[16:19], v3 offset:0
    v_min_u32 v176, -2, v176
    v_mfma_f32_16x16x32_bf16 v[236:239], a[28:31], v[44:47], v[236:239]
    buffer_load_dwordx4 v3, s[20:23], s30 offen offset:1024 lds
    v_mul_f32 v182, v180, v182
    v_mul_f32 v183, v181, v183
    s_waitcnt lgkmcnt(3)
    v_mfma_f32_16x16x32_bf16 v[208:211], a[0:3], v[48:51], v[208:211]
    ds_read_b128 a[20:23], v3 offset:1024
    v_mul_f32 v180, v14, v180
    v_mfma_f32_16x16x32_bf16 v[224:227], a[0:3], v[52:55], v[224:227]
    v_mul_f32 v181, v14, v181
    v_mfma_f32_16x16x32_bf16 v[212:215], a[4:7], v[48:51], v[212:215]
    ds_read_b128 a[24:27], v3 offset:2048
    v_mfma_f32_16x16x32_bf16 v[228:231], a[4:7], v[52:55], v[228:231]
    buffer_load_dwordx4 v3, s[20:23], s30 offen offset:2048 lds
    v_exp_f32 v180, v180
    s_waitcnt lgkmcnt(3)
    v_mfma_f32_16x16x32_bf16 v[216:219], a[8:11], v[48:51], v[216:219]
    ds_read_b128 a[28:31], v3 offset:3072
    v_mfma_f32_16x16x32_bf16 v[232:235], a[8:11], v[52:55], v[232:235]
    v_exp_f32 v181, v181
    v_mfma_f32_16x16x32_bf16 v[220:223], a[12:15], v[48:51], v[220:223]
    ds_read_b128 a[0:3], v3 offset:4096
    v_fma_f32 v180, v180, v0, v0
    v_mfma_f32_16x16x32_bf16 v[236:239], a[12:15], v[52:55], v[236:239]
    buffer_load_dwordx4 v3, s[20:23], s30 offen offset:3072 lds
    v_fma_f32 v181, v181, v0, v0
    s_waitcnt lgkmcnt(3)
    v_mfma_f32_16x16x32_bf16 v[208:211], a[16:19], v[56:59], v[208:211]
    ds_read_b128 a[4:7], v3 offset:5120
    v_mfma_f32_16x16x32_bf16 v[224:227], a[16:19], v[60:63], v[224:227]
    v_rcp_f32 v180, v180
    v_mfma_f32_16x16x32_bf16 v[212:215], a[20:23], v[56:59], v[212:215]
    ds_read_b128 a[8:11], v3 offset:6144
    v_mfma_f32_16x16x32_bf16 v[228:231], a[20:23], v[60:63], v[228:231]
    s_add_u32 m0, s34, 106496
    s_nop 0
    buffer_load_dwordx4 v4, s[20:23], s30 offen offset:0 lds
    v_rcp_f32 v181, v181
    s_waitcnt lgkmcnt(3)
    v_mfma_f32_16x16x32_bf16 v[216:219], a[24:27], v[56:59], v[216:219]
    ds_read_b128 a[12:15], v3 offset:7168
    v_mul_f32 v182, v182, v180
    v_mfma_f32_16x16x32_bf16 v[232:235], a[24:27], v[60:63], v[232:235]
    v_mul_f32 v183, v183, v181
    v_cvt_pk_bf16_f32 v177, v182, v183
    v_mfma_f32_16x16x32_bf16 v[220:223], a[28:31], v[56:59], v[220:223]
    ds_read_b128 a[16:19], v3 offset:8192
    v_mul_f32 v186, v184, v186
    v_mfma_f32_16x16x32_bf16 v[236:239], a[28:31], v[60:63], v[236:239]
    buffer_load_dwordx4 a[40:43], v3, s[20:23], s51 offen offset:2048 sc1
    v_mul_f32 v187, v185, v187
    v_mul_f32 v184, v14, v184
    s_waitcnt lgkmcnt(3)
    v_mfma_f32_16x16x32_bf16 v[208:211], a[0:3], v[64:67], v[208:211]
    ds_read_b128 a[20:23], v3 offset:9216
    v_mul_f32 v185, v14, v185
    v_mfma_f32_16x16x32_bf16 v[224:227], a[0:3], v[68:71], v[224:227]
    v_exp_f32 v184, v184
    v_mfma_f32_16x16x32_bf16 v[212:215], a[4:7], v[64:67], v[212:215]
    ds_read_b128 a[24:27], v3 offset:10240
    v_mfma_f32_16x16x32_bf16 v[228:231], a[4:7], v[68:71], v[228:231]
    buffer_load_dwordx4 a[44:47], v3, s[20:23], s51 offen offset:3072 sc1
    v_exp_f32 v185, v185
    s_waitcnt lgkmcnt(3)
    v_mfma_f32_16x16x32_bf16 v[216:219], a[8:11], v[64:67], v[216:219]
    ds_read_b128 a[28:31], v3 offset:11264
    v_fma_f32 v184, v184, v0, v0
    v_mfma_f32_16x16x32_bf16 v[232:235], a[8:11], v[68:71], v[232:235]
    v_fma_f32 v185, v185, v0, v0
    v_mfma_f32_16x16x32_bf16 v[220:223], a[12:15], v[64:67], v[220:223]
    ds_read_b128 a[0:3], v3 offset:12288
    v_mfma_f32_16x16x32_bf16 v[236:239], a[12:15], v[68:71], v[236:239]
    buffer_load_dwordx4 a[60:63], v3, s[20:23], s44 offen offset:0
    v_rcp_f32 v184, v184
    s_waitcnt lgkmcnt(3)
    v_mfma_f32_16x16x32_bf16 v[208:211], a[16:19], v[72:75], v[208:211]
    ds_read_b128 a[4:7], v3 offset:13312
    v_mfma_f32_16x16x32_bf16 v[224:227], a[16:19], v[76:79], v[224:227]
    v_rcp_f32 v185, v185
    v_mfma_f32_16x16x32_bf16 v[212:215], a[20:23], v[72:75], v[212:215]
    ds_read_b128 a[8:11], v3 offset:14336
    v_mul_f32 v186, v186, v184
    v_mfma_f32_16x16x32_bf16 v[228:231], a[20:23], v[76:79], v[228:231]
    buffer_load_dwordx4 a[64:67], v3, s[20:23], s44 offen offset:1024
    v_mul_f32 v187, v187, v185
    v_cvt_pk_bf16_f32 v178, v186, v187
    s_waitcnt lgkmcnt(3)
    v_mfma_f32_16x16x32_bf16 v[216:219], a[24:27], v[72:75], v[216:219]
    ds_read_b128 a[12:15], v3 offset:15360
    v_mul_f32 v190, v188, v190
    v_mfma_f32_16x16x32_bf16 v[232:235], a[24:27], v[76:79], v[232:235]
    v_mul_f32 v191, v189, v191
    v_mul_f32 v188, v14, v188
    v_mfma_f32_16x16x32_bf16 v[220:223], a[28:31], v[72:75], v[220:223]
    ds_read_b128 a[16:19], v3 offset:16384
    v_mul_f32 v189, v14, v189
    v_mfma_f32_16x16x32_bf16 v[236:239], a[28:31], v[76:79], v[236:239]
    buffer_load_dwordx4 a[68:71], v3, s[20:23], s44 offen offset:2048
    v_exp_f32 v188, v188
    s_waitcnt lgkmcnt(3)
    v_mfma_f32_16x16x32_bf16 v[208:211], a[0:3], v[80:83], v[208:211]
    ds_read_b128 a[20:23], v3 offset:17408
    v_mfma_f32_16x16x32_bf16 v[224:227], a[0:3], v[84:87], v[224:227]
    v_exp_f32 v189, v189
    v_mfma_f32_16x16x32_bf16 v[212:215], a[4:7], v[80:83], v[212:215]
    ds_read_b128 a[24:27], v3 offset:18432
    v_fma_f32 v188, v188, v0, v0
    v_mfma_f32_16x16x32_bf16 v[228:231], a[4:7], v[84:87], v[228:231]
    buffer_load_dwordx4 a[72:75], v3, s[20:23], s44 offen offset:3072
    v_fma_f32 v189, v189, v0, v0
    s_waitcnt lgkmcnt(3)
    v_mfma_f32_16x16x32_bf16 v[216:219], a[8:11], v[80:83], v[216:219]
    ds_read_b128 a[28:31], v3 offset:19456
    v_mfma_f32_16x16x32_bf16 v[232:235], a[8:11], v[84:87], v[232:235]
    v_rcp_f32 v188, v188
    v_mfma_f32_16x16x32_bf16 v[220:223], a[12:15], v[80:83], v[220:223]
    s_waitcnt vmcnt(23)
    s_barrier
    ds_read_b128 a[0:3], v3 offset:20480
    v_mfma_f32_16x16x32_bf16 v[236:239], a[12:15], v[84:87], v[236:239]
    s_add_u32 m0, s34, 122880
    s_nop 0
    buffer_load_dwordx4 v3, s[20:23], s31 offen offset:0 lds
    v_rcp_f32 v189, v189
    s_waitcnt lgkmcnt(3)
    v_mfma_f32_16x16x32_bf16 v[208:211], a[16:19], v[88:91], v[208:211]
    ds_read_b128 a[4:7], v3 offset:21504
    v_mul_f32 v190, v190, v188
    v_mfma_f32_16x16x32_bf16 v[224:227], a[16:19], v[92:95], v[224:227]
    v_mul_f32 v191, v191, v189
    v_cvt_pk_bf16_f32 v179, v190, v191
    buffer_store_dwordx4 v[176:179], v3, s[20:23], s35 offen sc1
    s_add_u32 s35, s35, 4096
    v_mfma_f32_16x16x32_bf16 v[212:215], a[20:23], v[88:91], v[212:215]
    ds_read_b128 a[8:11], v3 offset:22528
    v_mul_f32 v194, v192, v194
    v_mfma_f32_16x16x32_bf16 v[228:231], a[20:23], v[92:95], v[228:231]
    buffer_load_dwordx4 v3, s[20:23], s31 offen offset:1024 lds
    v_mul_f32 v195, v193, v195
    v_mul_f32 v192, v15, v192
    s_waitcnt lgkmcnt(3)
    v_mfma_f32_16x16x32_bf16 v[216:219], a[24:27], v[88:91], v[216:219]
    ds_read_b128 a[12:15], v3 offset:23552
    v_mul_f32 v193, v15, v193
    v_mfma_f32_16x16x32_bf16 v[232:235], a[24:27], v[92:95], v[232:235]
    v_exp_f32 v192, v192
    v_mfma_f32_16x16x32_bf16 v[220:223], a[28:31], v[88:91], v[220:223]
    buffer_load_dwordx4 v3, s[20:23], s31 offen offset:2048 lds
    v_exp_f32 v193, v193
    v_mfma_f32_16x16x32_bf16 v[236:239], a[28:31], v[92:95], v[236:239]
    v_fma_f32 v192, v192, v1, v1
    v_fma_f32 v193, v193, v1, v1
    s_waitcnt lgkmcnt(2)
    v_mfma_f32_16x16x32_bf16 v[208:211], a[0:3], v[96:99], v[208:211]
    v_rcp_f32 v192, v192
    v_mfma_f32_16x16x32_bf16 v[224:227], a[0:3], v[100:103], v[224:227]
    v_rcp_f32 v193, v193
    v_mfma_f32_16x16x32_bf16 v[212:215], a[4:7], v[96:99], v[212:215]
    buffer_load_dwordx4 v3, s[20:23], s31 offen offset:3072 lds
    v_mul_f32 v194, v194, v192
    v_mul_f32 v195, v195, v193
    v_mfma_f32_16x16x32_bf16 v[228:231], a[4:7], v[100:103], v[228:231]
    v_cvt_pk_bf16_f32 v192, v194, v195
    v_min_u32 v192, -2, v192
    s_waitcnt lgkmcnt(0)
    v_mfma_f32_16x16x32_bf16 v[216:219], a[8:11], v[96:99], v[216:219]
    v_mul_f32 v198, v196, v198
    v_mul_f32 v199, v197, v199
    v_mfma_f32_16x16x32_bf16 v[232:235], a[8:11], v[100:103], v[232:235]
    v_mul_f32 v196, v15, v196
    v_mul_f32 v197, v15, v197
    v_mfma_f32_16x16x32_bf16 v[220:223], a[12:15], v[96:99], v[220:223]
    ds_read_b128 a[16:19], v3 offset:24576
    v_mfma_f32_16x16x32_bf16 v[236:239], a[12:15], v[100:103], v[236:239]
    s_add_u32 m0, s34, 126976
    s_nop 0
    buffer_load_dwordx4 v4, s[20:23], s31 offen offset:0 lds
    v_exp_f32 v196, v196
    s_waitcnt vmcnt(28)
    v_mfma_f32_16x16x16_bf16 v[208:211], a[36:37], a[48:49], v[208:211]
    ds_read_b128 a[20:23], v3 offset:25600
    v_mfma_f32_16x16x16_bf16 v[224:227], a[36:37], a[52:53], v[224:227]
    v_mfma_f32_16x16x16_bf16 v[212:215], a[36:37], a[50:51], v[212:215]
    ds_read_b128 a[24:27], v3 offset:26624
    v_mfma_f32_16x16x16_bf16 v[228:231], a[36:37], a[54:55], v[228:231]
    s_add_u32 m0, s34, 143360
    s_nop 0
    buffer_load_dwordx4 v3, s[20:23], s32 offen offset:0 lds
    v_mfma_f32_16x16x16_bf16 v[216:219], a[38:39], a[48:49], v[216:219]
    ds_read_b128 a[28:31], v3 offset:27648
    v_mfma_f32_16x16x16_bf16 v[232:235], a[38:39], a[52:53], v[232:235]
    v_mfma_f32_16x16x16_bf16 v[220:223], a[38:39], a[50:51], v[220:223]
    ds_read_b128 a[0:3], v3 offset:28672
    v_mfma_f32_16x16x16_bf16 v[236:239], a[38:39], a[54:55], v[236:239]
    buffer_load_dwordx4 v3, s[20:23], s32 offen offset:1024 lds
    s_waitcnt lgkmcnt(3)
    v_mfma_f32_16x16x32_bf16 v[208:211], a[16:19], v[104:107], v[208:211]
    ds_read_b128 a[4:7], v3 offset:29696
    v_mfma_f32_16x16x32_bf16 v[224:227], a[16:19], v[108:111], v[224:227]
    v_exp_f32 v197, v197
    v_mfma_f32_16x16x32_bf16 v[212:215], a[20:23], v[104:107], v[212:215]
    ds_read_b128 a[8:11], v3 offset:30720
    v_fma_f32 v196, v196, v1, v1
    v_mfma_f32_16x16x32_bf16 v[228:231], a[20:23], v[108:111], v[228:231]
    buffer_load_dwordx4 v3, s[20:23], s32 offen offset:2048 lds
    v_fma_f32 v197, v197, v1, v1
    s_waitcnt lgkmcnt(3)
    v_mfma_f32_16x16x32_bf16 v[216:219], a[24:27], v[104:107], v[216:219]
    ds_read_b128 a[12:15], v3 offset:31744
    v_mfma_f32_16x16x32_bf16 v[232:235], a[24:27], v[108:111], v[232:235]
    v_rcp_f32 v196, v196
    v_mfma_f32_16x16x32_bf16 v[220:223], a[28:31], v[104:107], v[220:223]
    ds_read_b128 a[16:19], v3 offset:32768
    v_mfma_f32_16x16x32_bf16 v[236:239], a[28:31], v[108:111], v[236:239]
    buffer_load_dwordx4 v3, s[20:23], s32 offen offset:3072 lds
    v_rcp_f32 v197, v197
    s_waitcnt lgkmcnt(3)
    v_mfma_f32_16x16x32_bf16 v[208:211], a[0:3], v[112:115], v[208:211]
    ds_read_b128 a[20:23], v3 offset:33792
    v_mul_f32 v198, v198, v196
    v_mfma_f32_16x16x32_bf16 v[224:227], a[0:3], v[116:119], v[224:227]
    v_mul_f32 v199, v199, v197
    v_cvt_pk_bf16_f32 v193, v198, v199
    v_mfma_f32_16x16x32_bf16 v[212:215], a[4:7], v[112:115], v[212:215]
    ds_read_b128 a[24:27], v3 offset:34816
    v_mul_f32 v202, v200, v202
    v_mfma_f32_16x16x32_bf16 v[228:231], a[4:7], v[116:119], v[228:231]
    s_add_u32 m0, s34, 147456
    s_nop 0
    buffer_load_dwordx4 v4, s[20:23], s32 offen offset:0 lds
    v_mul_f32 v203, v201, v203
    v_mul_f32 v200, v15, v200
    s_waitcnt lgkmcnt(3)
    v_mfma_f32_16x16x32_bf16 v[216:219], a[8:11], v[112:115], v[216:219]
    ds_read_b128 a[28:31], v3 offset:35840
    v_mul_f32 v201, v15, v201
    v_mfma_f32_16x16x32_bf16 v[232:235], a[8:11], v[116:119], v[232:235]
    v_exp_f32 v200, v200
    v_mfma_f32_16x16x32_bf16 v[220:223], a[12:15], v[112:115], v[220:223]
    ds_read_b128 a[0:3], v3 offset:36864
    v_mfma_f32_16x16x32_bf16 v[236:239], a[12:15], v[116:119], v[236:239]
    buffer_load_dwordx4 a[76:79], v4, s[20:23], s44 offen offset:0
    s_add_u32 s44, s44, 20480
    v_exp_f32 v201, v201
    s_waitcnt lgkmcnt(3)
    v_mfma_f32_16x16x32_bf16 v[208:211], a[16:19], v[120:123], v[208:211]
    ds_read_b128 a[4:7], v3 offset:37888
    v_fma_f32 v200, v200, v1, v1
    v_mfma_f32_16x16x32_bf16 v[224:227], a[16:19], v[124:127], v[224:227]
    v_fma_f32 v201, v201, v1, v1
    v_mfma_f32_16x16x32_bf16 v[212:215], a[20:23], v[120:123], v[212:215]
    ds_read_b128 a[8:11], v3 offset:38912
    v_mfma_f32_16x16x32_bf16 v[228:231], a[20:23], v[124:127], v[228:231]
    buffer_load_dwordx4 a[80:83], v3, s[20:23], s45 offen offset:0
    v_rcp_f32 v200, v200
    s_waitcnt lgkmcnt(3)
    v_mfma_f32_16x16x32_bf16 v[216:219], a[24:27], v[120:123], v[216:219]
    ds_read_b128 a[12:15], v3 offset:39936
    v_mfma_f32_16x16x32_bf16 v[232:235], a[24:27], v[124:127], v[232:235]
    v_rcp_f32 v201, v201
    v_mfma_f32_16x16x32_bf16 v[220:223], a[28:31], v[120:123], v[220:223]
    ds_read_b128 a[16:19], v3 offset:40960
    v_mul_f32 v202, v202, v200
    v_mfma_f32_16x16x32_bf16 v[236:239], a[28:31], v[124:127], v[236:239]
    buffer_load_dwordx4 a[84:87], v3, s[20:23], s45 offen offset:1024
    v_mul_f32 v203, v203, v201
    v_cvt_pk_bf16_f32 v194, v202, v203
    s_waitcnt lgkmcnt(3)
    v_mfma_f32_16x16x32_bf16 v[208:211], a[0:3], v[128:131], v[208:211]
    ds_read_b128 a[20:23], v3 offset:41984
    v_mul_f32 v206, v204, v206
    v_mfma_f32_16x16x32_bf16 v[224:227], a[0:3], v[132:135], v[224:227]
    v_mul_f32 v207, v205, v207
    v_mul_f32 v204, v15, v204
    v_mfma_f32_16x16x32_bf16 v[212:215], a[4:7], v[128:131], v[212:215]
    ds_read_b128 a[24:27], v3 offset:43008
    v_mul_f32 v205, v15, v205
    v_mfma_f32_16x16x32_bf16 v[228:231], a[4:7], v[132:135], v[228:231]
    buffer_load_dwordx4 a[88:91], v3, s[20:23], s45 offen offset:2048
    v_exp_f32 v204, v204
    s_waitcnt lgkmcnt(3)
    v_mfma_f32_16x16x32_bf16 v[216:219], a[8:11], v[128:131], v[216:219]
    ds_read_b128 a[28:31], v3 offset:44032
    v_mfma_f32_16x16x32_bf16 v[232:235], a[8:11], v[132:135], v[232:235]
    v_exp_f32 v205, v205
    v_mfma_f32_16x16x32_bf16 v[220:223], a[12:15], v[128:131], v[220:223]
    ds_read_b128 a[0:3], v3 offset:45056
    v_fma_f32 v204, v204, v1, v1
    v_mfma_f32_16x16x32_bf16 v[236:239], a[12:15], v[132:135], v[236:239]
    buffer_load_dwordx4 a[92:95], v3, s[20:23], s45 offen offset:3072
    v_fma_f32 v205, v205, v1, v1
    s_waitcnt lgkmcnt(3)
    v_mfma_f32_16x16x32_bf16 v[208:211], a[16:19], v[136:139], v[208:211]
    ds_read_b128 a[4:7], v3 offset:46080
    v_mfma_f32_16x16x32_bf16 v[224:227], a[16:19], v[140:143], v[224:227]
    v_rcp_f32 v204, v204
    v_mfma_f32_16x16x32_bf16 v[212:215], a[20:23], v[136:139], v[212:215]
    ds_read_b128 a[8:11], v3 offset:47104
    v_mfma_f32_16x16x32_bf16 v[228:231], a[20:23], v[140:143], v[228:231]
    buffer_load_dwordx4 a[96:99], v4, s[20:23], s45 offen offset:0
    s_add_u32 s45, s45, 20480
    v_rcp_f32 v205, v205
    s_waitcnt lgkmcnt(3)
    v_mfma_f32_16x16x32_bf16 v[216:219], a[24:27], v[136:139], v[216:219]
    ds_read_b128 a[12:15], v3 offset:48128
    v_mul_f32 v206, v206, v204
    v_mfma_f32_16x16x32_bf16 v[232:235], a[24:27], v[140:143], v[232:235]
    v_mul_f32 v207, v207, v205
    v_cvt_pk_bf16_f32 v195, v206, v207
    buffer_store_dwordx4 v[192:195], v3, s[20:23], s36 offen sc1
    s_add_u32 s36, s36, 4096
    v_mfma_f32_16x16x32_bf16 v[220:223], a[28:31], v[136:139], v[220:223]
    ds_read_b128 a[16:19], v3 offset:49152
    v_mfma_f32_16x16x32_bf16 v[236:239], a[28:31], v[140:143], v[236:239]
    buffer_load_dwordx4 a[100:103], v3, s[20:23], s46 offen offset:0
    s_waitcnt lgkmcnt(3)
    v_mfma_f32_16x16x32_bf16 v[208:211], a[0:3], v[144:147], v[208:211]
    ds_read_b128 a[20:23], v3 offset:50176
    v_mfma_f32_16x16x32_bf16 v[224:227], a[0:3], v[148:151], v[224:227]
    v_mfma_f32_16x16x32_bf16 v[212:215], a[4:7], v[144:147], v[212:215]
    ds_read_b128 a[24:27], v3 offset:51200
    v_mfma_f32_16x16x32_bf16 v[228:231], a[4:7], v[148:151], v[228:231]
    buffer_load_dwordx4 a[104:107], v3, s[20:23], s46 offen offset:1024
    s_waitcnt lgkmcnt(3)
    v_mfma_f32_16x16x32_bf16 v[216:219], a[8:11], v[144:147], v[216:219]
    ds_read_b128 a[28:31], v3 offset:52224
    v_mfma_f32_16x16x32_bf16 v[232:235], a[8:11], v[148:151], v[232:235]
    v_mfma_f32_16x16x32_bf16 v[220:223], a[12:15], v[144:147], v[220:223]
    ds_read_b128 a[0:3], v3 offset:53248
    v_mfma_f32_16x16x32_bf16 v[236:239], a[12:15], v[148:151], v[236:239]
    buffer_load_dwordx4 a[108:111], v3, s[20:23], s46 offen offset:2048
    s_waitcnt lgkmcnt(3)
    v_mfma_f32_16x16x32_bf16 v[208:211], a[16:19], v[152:155], v[208:211]
    ds_read_b128 a[4:7], v3 offset:54272
    v_mfma_f32_16x16x32_bf16 v[224:227], a[16:19], v[156:159], v[224:227]
    v_mfma_f32_16x16x32_bf16 v[212:215], a[20:23], v[152:155], v[212:215]
    ds_read_b128 a[8:11], v3 offset:55296
    v_mfma_f32_16x16x32_bf16 v[228:231], a[20:23], v[156:159], v[228:231]
    buffer_load_dwordx4 a[112:115], v3, s[20:23], s46 offen offset:3072
    s_waitcnt lgkmcnt(3)
    v_mfma_f32_16x16x32_bf16 v[216:219], a[24:27], v[152:155], v[216:219]
    ds_read_b128 a[12:15], v3 offset:56320
    v_mfma_f32_16x16x32_bf16 v[232:235], a[24:27], v[156:159], v[232:235]
    v_mfma_f32_16x16x32_bf16 v[220:223], a[28:31], v[152:155], v[220:223]
    ds_read_b128 a[16:19], v3 offset:57344
    v_mfma_f32_16x16x32_bf16 v[236:239], a[28:31], v[156:159], v[236:239]
    buffer_load_dwordx4 a[116:119], v4, s[20:23], s46 offen offset:0
    s_add_u32 s46, s46, 20480
    s_waitcnt lgkmcnt(3)
    v_mfma_f32_16x16x32_bf16 v[208:211], a[0:3], v[160:163], v[208:211]
    v_lshrrev_b32 v13, 2, v3
    v_and_b32 v13, 28, v13
    ds_read_b128 a[20:23], v3 offset:58368
    v_mfma_f32_16x16x32_bf16 v[224:227], a[0:3], v[164:167], v[224:227]
    v_mfma_f32_16x16x32_bf16 v[212:215], a[4:7], v[160:163], v[212:215]
    ds_read_b128 a[24:27], v3 offset:59392
    v_mfma_f32_16x16x32_bf16 v[228:231], a[4:7], v[164:167], v[228:231]
    buffer_load_dwordx4 a[120:123], v3, s[20:23], s47 offen offset:0
    s_waitcnt lgkmcnt(3)
    v_mfma_f32_16x16x32_bf16 v[216:219], a[8:11], v[160:163], v[216:219]
    ds_read_b128 a[28:31], v3 offset:60416
    v_mfma_f32_16x16x32_bf16 v[232:235], a[8:11], v[164:167], v[232:235]
    v_mfma_f32_16x16x32_bf16 v[220:223], a[12:15], v[160:163], v[220:223]
    s_waitcnt vmcnt(35)
    s_barrier
    ds_read_b128 a[0:3], v6 offset:0
    v_mfma_f32_16x16x32_bf16 v[236:239], a[12:15], v[164:167], v[236:239]
    s_add_u32 m0, s34, 0
    s_nop 0
    buffer_load_dwordx4 v3, s[20:23], s33 offen offset:0 lds
    s_waitcnt lgkmcnt(3)
    v_mfma_f32_16x16x32_bf16 v[208:211], a[16:19], v[168:171], v[208:211]
    ds_read_b128 a[4:7], v6 offset:1024
    v_mfma_f32_16x16x32_bf16 v[224:227], a[16:19], v[172:175], v[224:227]
    v_mfma_f32_16x16x32_bf16 v[212:215], a[20:23], v[168:171], v[212:215]
    ds_read_b128 a[8:11], v6 offset:2048
    v_mul_f32 v210, v208, v210
    v_mfma_f32_16x16x32_bf16 v[228:231], a[20:23], v[172:175], v[228:231]
    buffer_load_dwordx4 v3, s[20:23], s33 offen offset:1024 lds
    v_mul_f32 v211, v209, v211
    v_mul_f32 v208, v14, v208
    s_waitcnt lgkmcnt(3)
    v_mfma_f32_16x16x32_bf16 v[216:219], a[24:27], v[168:171], v[216:219]
    ds_read_b128 a[12:15], v6 offset:3072
    v_mul_f32 v209, v14, v209
    v_mfma_f32_16x16x32_bf16 v[232:235], a[24:27], v[172:175], v[232:235]
    v_exp_f32 v208, v208
    v_mfma_f32_16x16x32_bf16 v[220:223], a[28:31], v[168:171], v[220:223]
    ds_read_b128 a[16:19], v6 offset:4096
    v_mfma_f32_16x16x32_bf16 v[236:239], a[28:31], v[172:175], v[236:239]
    buffer_load_dwordx4 v3, s[20:23], s33 offen offset:2048 lds
    v_exp_f32 v209, v209
    s_waitcnt lgkmcnt(3)
    v_mfma_f32_16x16x32_bf16 v[176:179], a[0:3], v[16:19], 0
    ds_read_b128 a[20:23], v6 offset:5120
    v_fma_f32 v208, v208, v0, v0
    v_mfma_f32_16x16x32_bf16 v[192:195], a[0:3], v[20:23], 0
    v_fma_f32 v209, v209, v0, v0
    v_mfma_f32_16x16x32_bf16 v[180:183], a[4:7], v[16:19], 0
    ds_read_b128 a[24:27], v6 offset:6144
    v_mfma_f32_16x16x32_bf16 v[196:199], a[4:7], v[20:23], 0
    buffer_load_dwordx4 v3, s[20:23], s33 offen offset:3072 lds
    v_rcp_f32 v208, v208
    s_waitcnt lgkmcnt(3)
    v_mfma_f32_16x16x32_bf16 v[184:187], a[8:11], v[16:19], 0
    ds_read_b128 a[28:31], v6 offset:7168
    v_mfma_f32_16x16x32_bf16 v[200:203], a[8:11], v[20:23], 0
    v_rcp_f32 v209, v209
    v_mfma_f32_16x16x32_bf16 v[188:191], a[12:15], v[16:19], 0
    ds_read_b128 a[0:3], v6 offset:8192
    v_mul_f32 v210, v210, v208
    v_mfma_f32_16x16x32_bf16 v[204:207], a[12:15], v[20:23], 0
    s_add_u32 m0, s34, 4096
    s_nop 0
    buffer_load_dwordx4 v4, s[20:23], s33 offen offset:0 lds
    v_mul_f32 v211, v211, v209
    v_cvt_pk_bf16_f32 v208, v210, v211
    s_waitcnt lgkmcnt(3)
    v_mfma_f32_16x16x32_bf16 v[176:179], a[16:19], v[24:27], v[176:179]
    ds_read_b128 a[4:7], v6 offset:9216
    v_min_u32 v208, -2, v208
    v_mfma_f32_16x16x32_bf16 v[192:195], a[16:19], v[28:31], v[192:195]
    v_mul_f32 v214, v212, v214
    v_mul_f32 v215, v213, v215
    v_mfma_f32_16x16x32_bf16 v[180:183], a[20:23], v[24:27], v[180:183]
    ds_read_b128 a[8:11], v6 offset:10240
    v_mul_f32 v212, v14, v212
    v_mfma_f32_16x16x32_bf16 v[196:199], a[20:23], v[28:31], v[196:199]
    buffer_load_dwordx4 a[124:127], v3, s[20:23], s47 offen offset:1024
    v_mul_f32 v213, v14, v213
    s_waitcnt lgkmcnt(3)
    v_mfma_f32_16x16x32_bf16 v[184:187], a[24:27], v[24:27], v[184:187]
    ds_read_b128 a[12:15], v6 offset:11264
    v_mfma_f32_16x16x32_bf16 v[200:203], a[24:27], v[28:31], v[200:203]
    v_exp_f32 v212, v212
    v_mfma_f32_16x16x32_bf16 v[188:191], a[28:31], v[24:27], v[188:191]
    ds_read_b128 a[16:19], v6 offset:12288
    v_mfma_f32_16x16x32_bf16 v[204:207], a[28:31], v[28:31], v[204:207]
    buffer_load_dwordx4 a[128:131], v3, s[20:23], s47 offen offset:2048
    v_exp_f32 v213, v213
    s_waitcnt lgkmcnt(3)
    v_mfma_f32_16x16x32_bf16 v[176:179], a[0:3], v[32:35], v[176:179]
    ds_read_b128 a[20:23], v6 offset:13312
    v_fma_f32 v212, v212, v0, v0
    v_mfma_f32_16x16x32_bf16 v[192:195], a[0:3], v[36:39], v[192:195]
    v_fma_f32 v213, v213, v0, v0
    v_mfma_f32_16x16x32_bf16 v[180:183], a[4:7], v[32:35], v[180:183]
    ds_read_b128 a[24:27], v6 offset:14336
    v_mfma_f32_16x16x32_bf16 v[196:199], a[4:7], v[36:39], v[196:199]
    buffer_load_dwordx4 a[132:135], v3, s[20:23], s47 offen offset:3072
    v_rcp_f32 v212, v212
    s_waitcnt lgkmcnt(3)
    v_mfma_f32_16x16x32_bf16 v[184:187], a[8:11], v[32:35], v[184:187]
    ds_read_b128 a[28:31], v6 offset:15360
    v_mfma_f32_16x16x32_bf16 v[200:203], a[8:11], v[36:39], v[200:203]
    v_rcp_f32 v213, v213
    v_mfma_f32_16x16x32_bf16 v[188:191], a[12:15], v[32:35], v[188:191]
    ds_read_b128 a[0:3], v6 offset:16384
    v_mul_f32 v214, v214, v212
    v_mfma_f32_16x16x32_bf16 v[204:207], a[12:15], v[36:39], v[204:207]
    buffer_load_dwordx4 a[136:139], v4, s[20:23], s47 offen offset:0
    s_add_u32 s47, s47, 20480
    v_mul_f32 v215, v215, v213
    v_cvt_pk_bf16_f32 v209, v214, v215
    s_waitcnt lgkmcnt(3)
    v_mfma_f32_16x16x32_bf16 v[176:179], a[16:19], v[40:43], v[176:179]
    ds_read_b128 a[4:7], v6 offset:17408
    v_mul_f32 v218, v216, v218
    v_mfma_f32_16x16x32_bf16 v[192:195], a[16:19], v[44:47], v[192:195]
    v_mul_f32 v219, v217, v219
    v_mul_f32 v216, v14, v216
    v_mfma_f32_16x16x32_bf16 v[180:183], a[20:23], v[40:43], v[180:183]
    ds_read_b128 a[8:11], v6 offset:18432
    v_mul_f32 v217, v14, v217
    v_mfma_f32_16x16x32_bf16 v[196:199], a[20:23], v[44:47], v[196:199]
    buffer_load_dwordx4 a[140:143], v3, s[20:23], s44 offen offset:0
    v_exp_f32 v216, v216
    s_waitcnt lgkmcnt(3)
    v_mfma_f32_16x16x32_bf16 v[184:187], a[24:27], v[40:43], v[184:187]
    ds_read_b128 a[12:15], v6 offset:19456
    v_mfma_f32_16x16x32_bf16 v[200:203], a[24:27], v[44:47], v[200:203]
    v_exp_f32 v217, v217
    v_mfma_f32_16x16x32_bf16 v[188:191], a[28:31], v[40:43], v[188:191]
    ds_read_b128 a[16:19], v6 offset:20480
    v_fma_f32 v216, v216, v0, v0
    v_mfma_f32_16x16x32_bf16 v[204:207], a[28:31], v[44:47], v[204:207]
    buffer_load_dwordx4 a[144:147], v3, s[20:23], s44 offen offset:1024
    v_fma_f32 v217, v217, v0, v0
    s_waitcnt lgkmcnt(3)
    v_mfma_f32_16x16x32_bf16 v[176:179], a[0:3], v[48:51], v[176:179]
    ds_read_b128 a[20:23], v6 offset:21504
    v_mfma_f32_16x16x32_bf16 v[192:195], a[0:3], v[52:55], v[192:195]
    v_rcp_f32 v216, v216
    v_mfma_f32_16x16x32_bf16 v[180:183], a[4:7], v[48:51], v[180:183]
    ds_read_b128 a[24:27], v6 offset:22528
    v_mfma_f32_16x16x32_bf16 v[196:199], a[4:7], v[52:55], v[196:199]
    buffer_load_dwordx4 a[148:151], v3, s[20:23], s44 offen offset:2048
    v_rcp_f32 v217, v217
    s_waitcnt lgkmcnt(3)
    v_mfma_f32_16x16x32_bf16 v[184:187], a[8:11], v[48:51], v[184:187]
    ds_read_b128 a[28:31], v6 offset:23552
    v_mul_f32 v218, v218, v216
    v_mfma_f32_16x16x32_bf16 v[200:203], a[8:11], v[52:55], v[200:203]
    v_mul_f32 v219, v219, v217
    v_cvt_pk_bf16_f32 v210, v218, v219
    v_mfma_f32_16x16x32_bf16 v[188:191], a[12:15], v[48:51], v[188:191]
    ds_read_b128 a[0:3], v6 offset:24576
    v_mul_f32 v222, v220, v222
    v_mfma_f32_16x16x32_bf16 v[204:207], a[12:15], v[52:55], v[204:207]
    buffer_load_dwordx4 a[152:155], v3, s[20:23], s44 offen offset:3072
    v_mul_f32 v223, v221, v223
    v_mul_f32 v220, v14, v220
    s_waitcnt lgkmcnt(3)
    v_mfma_f32_16x16x32_bf16 v[176:179], a[16:19], v[56:59], v[176:179]
    ds_read_b128 a[4:7], v6 offset:25600
    v_mul_f32 v221, v14, v221
    v_mfma_f32_16x16x32_bf16 v[192:195], a[16:19], v[60:63], v[192:195]
    v_exp_f32 v220, v220
    v_mfma_f32_16x16x32_bf16 v[180:183], a[20:23], v[56:59], v[180:183]
    ds_read_b128 a[8:11], v6 offset:26624
    v_mfma_f32_16x16x32_bf16 v[196:199], a[20:23], v[60:63], v[196:199]
    buffer_load_dwordx4 a[156:159], v4, s[20:23], s44 offen offset:0
    s_add_u32 s44, s44, 20480
    v_exp_f32 v221, v221
    s_waitcnt lgkmcnt(3)
    v_mfma_f32_16x16x32_bf16 v[184:187], a[24:27], v[56:59], v[184:187]
    ds_read_b128 a[12:15], v6 offset:27648
    v_fma_f32 v220, v220, v0, v0
    v_mfma_f32_16x16x32_bf16 v[200:203], a[24:27], v[60:63], v[200:203]
    v_fma_f32 v221, v221, v0, v0
    v_mfma_f32_16x16x32_bf16 v[188:191], a[28:31], v[56:59], v[188:191]
    ds_read_b128 a[16:19], v6 offset:28672
    v_mfma_f32_16x16x32_bf16 v[204:207], a[28:31], v[60:63], v[204:207]
    buffer_load_dwordx4 a[160:163], v3, s[20:23], s45 offen offset:0
    v_rcp_f32 v220, v220
    s_waitcnt lgkmcnt(3)
    v_mfma_f32_16x16x32_bf16 v[176:179], a[0:3], v[64:67], v[176:179]
    ds_read_b128 a[20:23], v6 offset:29696
    v_mfma_f32_16x16x32_bf16 v[192:195], a[0:3], v[68:71], v[192:195]
    v_rcp_f32 v221, v221
    v_mfma_f32_16x16x32_bf16 v[180:183], a[4:7], v[64:67], v[180:183]
    ds_read_b128 a[24:27], v6 offset:30720
    v_mul_f32 v222, v222, v220
    v_mfma_f32_16x16x32_bf16 v[196:199], a[4:7], v[68:71], v[196:199]
    buffer_load_dwordx4 a[164:167], v3, s[20:23], s45 offen offset:1024
    v_mul_f32 v223, v223, v221
    v_cvt_pk_bf16_f32 v211, v222, v223
    buffer_store_dwordx4 v[208:211], v3, s[20:23], s35 offen sc1
    s_add_u32 s35, s35, 4096
    s_waitcnt lgkmcnt(3)
    v_mfma_f32_16x16x32_bf16 v[184:187], a[8:11], v[64:67], v[184:187]
    ds_read_b128 a[28:31], v6 offset:31744
    v_mul_f32 v226, v224, v226
    v_mfma_f32_16x16x32_bf16 v[200:203], a[8:11], v[68:71], v[200:203]
    v_mul_f32 v227, v225, v227
    v_mul_f32 v224, v15, v224
    v_mfma_f32_16x16x32_bf16 v[188:191], a[12:15], v[64:67], v[188:191]
    ds_read_b128 a[0:3], v6 offset:32768
    v_mul_f32 v225, v15, v225
    v_mfma_f32_16x16x32_bf16 v[204:207], a[12:15], v[68:71], v[204:207]
    buffer_load_dwordx4 a[168:171], v3, s[20:23], s45 offen offset:2048
    v_exp_f32 v224, v224
    s_waitcnt lgkmcnt(3)
    v_mfma_f32_16x16x32_bf16 v[176:179], a[16:19], v[72:75], v[176:179]
    ds_read_b128 a[4:7], v6 offset:33792
    v_mfma_f32_16x16x32_bf16 v[192:195], a[16:19], v[76:79], v[192:195]
    v_exp_f32 v225, v225
    v_mfma_f32_16x16x32_bf16 v[180:183], a[20:23], v[72:75], v[180:183]
    ds_read_b128 a[8:11], v6 offset:34816
    v_fma_f32 v224, v224, v1, v1
    v_mfma_f32_16x16x32_bf16 v[196:199], a[20:23], v[76:79], v[196:199]
    buffer_load_dwordx4 a[172:175], v3, s[20:23], s45 offen offset:3072
    v_fma_f32 v225, v225, v1, v1
    s_waitcnt lgkmcnt(3)
    v_mfma_f32_16x16x32_bf16 v[184:187], a[24:27], v[72:75], v[184:187]
    ds_read_b128 a[12:15], v6 offset:35840
    v_mfma_f32_16x16x32_bf16 v[200:203], a[24:27], v[76:79], v[200:203]
    v_rcp_f32 v224, v224
    v_mfma_f32_16x16x32_bf16 v[188:191], a[28:31], v[72:75], v[188:191]
    ds_read_b128 a[16:19], v6 offset:36864
    v_mfma_f32_16x16x32_bf16 v[204:207], a[28:31], v[76:79], v[204:207]
    buffer_load_dwordx4 a[176:179], v4, s[20:23], s45 offen offset:0
    s_add_u32 s45, s45, 20480
    v_rcp_f32 v225, v225
    s_waitcnt lgkmcnt(3)
    v_mfma_f32_16x16x32_bf16 v[176:179], a[0:3], v[80:83], v[176:179]
    ds_read_b128 a[20:23], v6 offset:37888
    v_mul_f32 v226, v226, v224
    v_mfma_f32_16x16x32_bf16 v[192:195], a[0:3], v[84:87], v[192:195]
    v_mul_f32 v227, v227, v225
    v_cvt_pk_bf16_f32 v224, v226, v227
    v_mfma_f32_16x16x32_bf16 v[180:183], a[4:7], v[80:83], v[180:183]
    ds_read_b128 a[24:27], v6 offset:38912
    v_min_u32 v224, -2, v224
    v_mfma_f32_16x16x32_bf16 v[196:199], a[4:7], v[84:87], v[196:199]
    buffer_load_dwordx4 a[180:183], v3, s[20:23], s46 offen offset:0
    v_mul_f32 v230, v228, v230
    v_mul_f32 v231, v229, v231
    s_waitcnt lgkmcnt(3)
    v_mfma_f32_16x16x32_bf16 v[184:187], a[8:11], v[80:83], v[184:187]
    ds_read_b128 a[28:31], v6 offset:39936
    v_mul_f32 v228, v15, v228
    v_mfma_f32_16x16x32_bf16 v[200:203], a[8:11], v[84:87], v[200:203]
    v_mul_f32 v229, v15, v229
    v_mfma_f32_16x16x32_bf16 v[188:191], a[12:15], v[80:83], v[188:191]
    s_waitcnt vmcnt(39)
    s_barrier
    ds_read_b128 a[0:3], v6 offset:40960
    v_mfma_f32_16x16x32_bf16 v[204:207], a[12:15], v[84:87], v[204:207]
    buffer_load_dwordx4 a[184:187], v3, s[20:23], s46 offen offset:1024
    v_exp_f32 v228, v228
    s_waitcnt lgkmcnt(3)
    v_mfma_f32_16x16x32_bf16 v[176:179], a[16:19], v[88:91], v[176:179]
    ds_read_b128 a[4:7], v6 offset:41984
    v_mfma_f32_16x16x32_bf16 v[192:195], a[16:19], v[92:95], v[192:195]
    v_exp_f32 v229, v229
    v_mfma_f32_16x16x32_bf16 v[180:183], a[20:23], v[88:91], v[180:183]
    ds_read_b128 a[8:11], v6 offset:43008
    v_fma_f32 v228, v228, v1, v1
    v_mfma_f32_16x16x32_bf16 v[196:199], a[20:23], v[92:95], v[196:199]
    buffer_load_dwordx4 a[188:191], v3, s[20:23], s46 offen offset:2048
    v_fma_f32 v229, v229, v1, v1
    s_waitcnt lgkmcnt(3)
    v_mfma_f32_16x16x32_bf16 v[184:187], a[24:27], v[88:91], v[184:187]
    ds_read_b128 a[12:15], v6 offset:44032
    v_mfma_f32_16x16x32_bf16 v[200:203], a[24:27], v[92:95], v[200:203]
    v_rcp_f32 v228, v228
    v_mfma_f32_16x16x32_bf16 v[188:191], a[28:31], v[88:91], v[188:191]
    buffer_load_dwordx4 a[192:195], v3, s[20:23], s46 offen offset:3072
    v_rcp_f32 v229, v229
    v_mfma_f32_16x16x32_bf16 v[204:207], a[28:31], v[92:95], v[204:207]
    v_mul_f32 v230, v230, v228
    v_mul_f32 v231, v231, v229
    s_waitcnt lgkmcnt(2)
    v_mfma_f32_16x16x32_bf16 v[176:179], a[0:3], v[96:99], v[176:179]
    v_cvt_pk_bf16_f32 v225, v230, v231
    v_mul_f32 v234, v232, v234
    v_mfma_f32_16x16x32_bf16 v[192:195], a[0:3], v[100:103], v[192:195]
    v_mul_f32 v235, v233, v235
    v_mul_f32 v232, v15, v232
    v_mfma_f32_16x16x32_bf16 v[180:183], a[4:7], v[96:99], v[180:183]
    buffer_load_dwordx4 a[196:199], v4, s[20:23], s46 offen offset:0
    s_add_u32 s46, s46, 20480
    v_mul_f32 v233, v15, v233
    v_mfma_f32_16x16x32_bf16 v[196:199], a[4:7], v[100:103], v[196:199]
    v_exp_f32 v232, v232
    s_waitcnt lgkmcnt(0)
    v_mfma_f32_16x16x32_bf16 v[184:187], a[8:11], v[96:99], v[184:187]
    v_exp_f32 v233, v233
    v_mfma_f32_16x16x32_bf16 v[200:203], a[8:11], v[100:103], v[200:203]
    v_fma_f32 v232, v232, v1, v1
    v_fma_f32 v233, v233, v1, v1
    v_mfma_f32_16x16x32_bf16 v[188:191], a[12:15], v[96:99], v[188:191]
    ds_read_b128 a[16:19], v6 offset:45056
    v_mfma_f32_16x16x32_bf16 v[204:207], a[12:15], v[100:103], v[204:207]
    buffer_load_dwordx4 a[200:203], v3, s[20:23], s47 offen offset:0
    v_rcp_f32 v232, v232
    v_mfma_f32_16x16x16_bf16 v[176:179], a[40:41], a[48:49], v[176:179]
    ds_read_b128 a[20:23], v6 offset:46080
    v_mfma_f32_16x16x16_bf16 v[192:195], a[40:41], a[52:53], v[192:195]
    v_mfma_f32_16x16x16_bf16 v[180:183], a[40:41], a[50:51], v[180:183]
    ds_read_b128 a[24:27], v6 offset:47104
    v_mfma_f32_16x16x16_bf16 v[196:199], a[40:41], a[54:55], v[196:199]
    buffer_load_dwordx4 a[204:207], v3, s[20:23], s47 offen offset:1024
    v_mfma_f32_16x16x16_bf16 v[184:187], a[42:43], a[48:49], v[184:187]
    buffer_load_dword v2, v13, s[20:23], s11 offen offset:0 sc1
    ds_read_b128 a[28:31], v6 offset:48128
    v_mfma_f32_16x16x16_bf16 v[200:203], a[42:43], a[52:53], v[200:203]
    v_mfma_f32_16x16x16_bf16 v[188:191], a[42:43], a[50:51], v[188:191]
    ds_read_b128 a[0:3], v6 offset:49152
    v_mfma_f32_16x16x16_bf16 v[204:207], a[42:43], a[54:55], v[204:207]
    buffer_load_dwordx4 a[208:211], v3, s[20:23], s47 offen offset:2048
    s_waitcnt lgkmcnt(3)
    v_mfma_f32_16x16x32_bf16 v[176:179], a[16:19], v[104:107], v[176:179]
    ds_read_b128 a[4:7], v6 offset:50176
    v_mfma_f32_16x16x32_bf16 v[192:195], a[16:19], v[108:111], v[192:195]
    v_rcp_f32 v233, v233
    v_mfma_f32_16x16x32_bf16 v[180:183], a[20:23], v[104:107], v[180:183]
    ds_read_b128 a[8:11], v6 offset:51200
    v_mul_f32 v234, v234, v232
    v_mfma_f32_16x16x32_bf16 v[196:199], a[20:23], v[108:111], v[196:199]
    buffer_load_dwordx4 a[212:215], v3, s[20:23], s47 offen offset:3072
    v_mul_f32 v235, v235, v233
    v_cvt_pk_bf16_f32 v226, v234, v235
    s_waitcnt lgkmcnt(3)
    v_mfma_f32_16x16x32_bf16 v[184:187], a[24:27], v[104:107], v[184:187]
    ds_read_b128 a[12:15], v6 offset:52224
    v_mul_f32 v238, v236, v238
    v_mfma_f32_16x16x32_bf16 v[200:203], a[24:27], v[108:111], v[200:203]
    v_mul_f32 v239, v237, v239
    v_mul_f32 v236, v15, v236
    v_mfma_f32_16x16x32_bf16 v[188:191], a[28:31], v[104:107], v[188:191]
    ds_read_b128 a[16:19], v6 offset:53248
    v_mul_f32 v237, v15, v237
    v_mfma_f32_16x16x32_bf16 v[204:207], a[28:31], v[108:111], v[204:207]
    buffer_load_dwordx4 a[216:219], v4, s[20:23], s47 offen offset:0
    s_add_u32 s47, s47, 20480
    v_exp_f32 v236, v236
    s_waitcnt lgkmcnt(3)
    v_mfma_f32_16x16x32_bf16 v[176:179], a[0:3], v[112:115], v[176:179]
    ds_read_b128 a[20:23], v6 offset:54272
    v_mfma_f32_16x16x32_bf16 v[192:195], a[0:3], v[116:119], v[192:195]
    v_exp_f32 v237, v237
    v_mfma_f32_16x16x32_bf16 v[180:183], a[4:7], v[112:115], v[180:183]
    ds_read_b128 a[24:27], v6 offset:55296
    v_fma_f32 v236, v236, v1, v1
    v_mfma_f32_16x16x32_bf16 v[196:199], a[4:7], v[116:119], v[196:199]
    buffer_load_dwordx4 a[220:223], v3, s[20:23], s44 offen offset:0
    v_fma_f32 v237, v237, v1, v1
    s_waitcnt lgkmcnt(3)
    v_mfma_f32_16x16x32_bf16 v[184:187], a[8:11], v[112:115], v[184:187]
    ds_read_b128 a[28:31], v6 offset:56320
    v_mfma_f32_16x16x32_bf16 v[200:203], a[8:11], v[116:119], v[200:203]
    v_rcp_f32 v236, v236
    v_mfma_f32_16x16x32_bf16 v[188:191], a[12:15], v[112:115], v[188:191]
    ds_read_b128 a[0:3], v6 offset:57344
    v_mfma_f32_16x16x32_bf16 v[204:207], a[12:15], v[116:119], v[204:207]
    buffer_load_dwordx4 a[224:227], v3, s[20:23], s44 offen offset:1024
    v_rcp_f32 v237, v237
    s_waitcnt lgkmcnt(3)
    v_mfma_f32_16x16x32_bf16 v[176:179], a[16:19], v[120:123], v[176:179]
    ds_read_b128 a[4:7], v6 offset:58368
    v_mul_f32 v238, v238, v236
    v_mfma_f32_16x16x32_bf16 v[192:195], a[16:19], v[124:127], v[192:195]
    v_mul_f32 v239, v239, v237
    v_cvt_pk_bf16_f32 v227, v238, v239
    buffer_store_dwordx4 v[224:227], v3, s[20:23], s36 offen sc1
    s_add_u32 s36, s36, 4096
    v_mfma_f32_16x16x32_bf16 v[180:183], a[20:23], v[120:123], v[180:183]
    ds_read_b128 a[8:11], v6 offset:59392
    v_mfma_f32_16x16x32_bf16 v[196:199], a[20:23], v[124:127], v[196:199]
    s_waitcnt lgkmcnt(3)
    v_mfma_f32_16x16x32_bf16 v[184:187], a[24:27], v[120:123], v[184:187]
    ds_read_b128 a[12:15], v6 offset:60416
    v_mfma_f32_16x16x32_bf16 v[200:203], a[24:27], v[124:127], v[200:203]
    v_mfma_f32_16x16x32_bf16 v[188:191], a[28:31], v[120:123], v[188:191]
    ds_read_b128 a[16:19], v7 offset:0
    v_mfma_f32_16x16x32_bf16 v[204:207], a[28:31], v[124:127], v[204:207]
    s_waitcnt lgkmcnt(3)
    v_mfma_f32_16x16x32_bf16 v[176:179], a[0:3], v[128:131], v[176:179]
    ds_read_b128 a[20:23], v7 offset:1024
    v_mfma_f32_16x16x32_bf16 v[192:195], a[0:3], v[132:135], v[192:195]
    v_mfma_f32_16x16x32_bf16 v[180:183], a[4:7], v[128:131], v[180:183]
    ds_read_b128 a[24:27], v7 offset:2048
    v_mfma_f32_16x16x32_bf16 v[196:199], a[4:7], v[132:135], v[196:199]
    s_waitcnt lgkmcnt(3)
    v_mfma_f32_16x16x32_bf16 v[184:187], a[8:11], v[128:131], v[184:187]
    ds_read_b128 a[28:31], v7 offset:3072
    v_mfma_f32_16x16x32_bf16 v[200:203], a[8:11], v[132:135], v[200:203]
    v_mfma_f32_16x16x32_bf16 v[188:191], a[12:15], v[128:131], v[188:191]
    ds_read_b128 a[0:3], v7 offset:4096
    v_mfma_f32_16x16x32_bf16 v[204:207], a[12:15], v[132:135], v[204:207]
    s_waitcnt lgkmcnt(3)
    v_mfma_f32_16x16x32_bf16 v[176:179], a[16:19], v[136:139], v[176:179]
    ds_read_b128 a[4:7], v7 offset:5120
    v_mfma_f32_16x16x32_bf16 v[192:195], a[16:19], v[140:143], v[192:195]
    v_mfma_f32_16x16x32_bf16 v[180:183], a[20:23], v[136:139], v[180:183]
    ds_read_b128 a[8:11], v7 offset:6144
    v_mfma_f32_16x16x32_bf16 v[196:199], a[20:23], v[140:143], v[196:199]
    s_waitcnt lgkmcnt(3)
    v_mfma_f32_16x16x32_bf16 v[184:187], a[24:27], v[136:139], v[184:187]
    ds_read_b128 a[12:15], v7 offset:7168
    v_mfma_f32_16x16x32_bf16 v[200:203], a[24:27], v[140:143], v[200:203]
    v_mfma_f32_16x16x32_bf16 v[188:191], a[28:31], v[136:139], v[188:191]
    ds_read_b128 a[16:19], v7 offset:8192
    v_mfma_f32_16x16x32_bf16 v[204:207], a[28:31], v[140:143], v[204:207]
    s_waitcnt lgkmcnt(3)
    v_mfma_f32_16x16x32_bf16 v[176:179], a[0:3], v[144:147], v[176:179]
    ds_read_b128 a[20:23], v7 offset:9216
    v_mfma_f32_16x16x32_bf16 v[192:195], a[0:3], v[148:151], v[192:195]
    v_mfma_f32_16x16x32_bf16 v[180:183], a[4:7], v[144:147], v[180:183]
    ds_read_b128 a[24:27], v7 offset:10240
    v_mfma_f32_16x16x32_bf16 v[196:199], a[4:7], v[148:151], v[196:199]
    s_waitcnt lgkmcnt(3)
    v_mfma_f32_16x16x32_bf16 v[184:187], a[8:11], v[144:147], v[184:187]
    ds_read_b128 a[28:31], v7 offset:11264
    v_mfma_f32_16x16x32_bf16 v[200:203], a[8:11], v[148:151], v[200:203]
    v_mfma_f32_16x16x32_bf16 v[188:191], a[12:15], v[144:147], v[188:191]
    s_waitcnt vmcnt(6)
    v_cmp_eq_u32 vcc, -1, v2
    s_cbranch_vccnz .rl25
.rl25b:
    ds_read_b128 a[0:3], v7 offset:12288
    v_mfma_f32_16x16x32_bf16 v[204:207], a[12:15], v[148:151], v[204:207]
    buffer_load_dwordx4 a[228:231], v8, s[20:23], s40 offen
    s_waitcnt lgkmcnt(3)
    v_mfma_f32_16x16x32_bf16 v[176:179], a[16:19], v[152:155], v[176:179]
    ds_read_b128 a[4:7], v7 offset:13312
    v_mfma_f32_16x16x32_bf16 v[192:195], a[16:19], v[156:159], v[192:195]
    buffer_load_dwordx4 a[232:235], v8, s[20:23], s41 offen
    v_mfma_f32_16x16x32_bf16 v[180:183], a[20:23], v[152:155], v[180:183]
    ds_read_b128 a[8:11], v7 offset:14336
    v_mfma_f32_16x16x32_bf16 v[196:199], a[20:23], v[156:159], v[196:199]
    buffer_load_dwordx4 a[236:239], v8, s[20:23], s42 offen
    s_waitcnt lgkmcnt(3)
    v_mfma_f32_16x16x32_bf16 v[184:187], a[24:27], v[152:155], v[184:187]
    ds_read_b128 a[12:15], v7 offset:15360
    v_mfma_f32_16x16x32_bf16 v[200:203], a[24:27], v[156:159], v[200:203]
    buffer_load_dwordx4 a[240:243], v8, s[20:23], s43 offen
    v_mfma_f32_16x16x32_bf16 v[188:191], a[28:31], v[152:155], v[188:191]
    ds_read_b128 a[16:19], v7 offset:16384
    v_mfma_f32_16x16x32_bf16 v[204:207], a[28:31], v[156:159], v[204:207]
    s_waitcnt lgkmcnt(3)
    v_mfma_f32_16x16x32_bf16 v[176:179], a[0:3], v[160:163], v[176:179]
    ds_read_b128 a[20:23], v7 offset:17408
    v_mfma_f32_16x16x32_bf16 v[192:195], a[0:3], v[164:167], v[192:195]
    v_mfma_f32_16x16x32_bf16 v[180:183], a[4:7], v[160:163], v[180:183]
    ds_read_b128 a[24:27], v7 offset:18432
    v_mfma_f32_16x16x32_bf16 v[196:199], a[4:7], v[164:167], v[196:199]
    s_waitcnt lgkmcnt(3)
    v_mfma_f32_16x16x32_bf16 v[184:187], a[8:11], v[160:163], v[184:187]
    ds_read_b128 a[28:31], v7 offset:19456
    v_mfma_f32_16x16x32_bf16 v[200:203], a[8:11], v[164:167], v[200:203]
    v_mfma_f32_16x16x32_bf16 v[188:191], a[12:15], v[160:163], v[188:191]
    s_barrier
    ds_read_b128 a[0:3], v7 offset:20480
    v_mfma_f32_16x16x32_bf16 v[204:207], a[12:15], v[164:167], v[204:207]
    s_waitcnt lgkmcnt(3)
    v_mfma_f32_16x16x32_bf16 v[176:179], a[16:19], v[168:171], v[176:179]
    ds_read_b128 a[4:7], v7 offset:21504
    v_mfma_f32_16x16x32_bf16 v[192:195], a[16:19], v[172:175], v[192:195]
    v_mfma_f32_16x16x32_bf16 v[180:183], a[20:23], v[168:171], v[180:183]
    ds_read_b128 a[8:11], v7 offset:22528
    v_mul_f32 v178, v176, v178
    v_mfma_f32_16x16x32_bf16 v[196:199], a[20:23], v[172:175], v[196:199]
    buffer_load_dwordx4 a[244:247], v9, s[20:23], s40 offen
    v_mul_f32 v179, v177, v179
    v_mul_f32 v176, v14, v176
    s_waitcnt lgkmcnt(3)
    v_mfma_f32_16x16x32_bf16 v[184:187], a[24:27], v[168:171], v[184:187]
    ds_read_b128 a[12:15], v7 offset:23552
    v_mul_f32 v177, v14, v177
    v_mfma_f32_16x16x32_bf16 v[200:203], a[24:27], v[172:175], v[200:203]
    buffer_load_dwordx4 a[248:251], v9, s[20:23], s41 offen
    v_exp_f32 v176, v176
    v_mfma_f32_16x16x32_bf16 v[188:191], a[28:31], v[168:171], v[188:191]
    ds_read_b128 a[16:19], v7 offset:24576
    v_mfma_f32_16x16x32_bf16 v[204:207], a[28:31], v[172:175], v[204:207]
    buffer_load_dwordx4 a[252:255], v9, s[20:23], s42 offen
    v_exp_f32 v177, v177
    s_waitcnt lgkmcnt(3)
    v_mfma_f32_16x16x32_bf16 v[208:211], a[0:3], v[16:19], 0
    ds_read_b128 a[20:23], v7 offset:25600
    v_fma_f32 v176, v176, v0, v0
    v_mfma_f32_16x16x32_bf16 v[216:219], a[0:3], v[20:23], 0
    buffer_load_dwordx4 v[232:235], v9, s[20:23], s43 offen
    v_fma_f32 v177, v177, v0, v0
    v_mfma_f32_16x16x32_bf16 v[212:215], a[4:7], v[16:19], 0
    ds_read_b128 a[24:27], v7 offset:26624
    v_mfma_f32_16x16x32_bf16 v[220:223], a[4:7], v[20:23], 0
    buffer_load_dwordx4 a[56:59], v3, s[20:23], s44 offen offset:2048
    v_rcp_f32 v176, v176
    s_waitcnt lgkmcnt(3)
    v_mfma_f32_16x16x32_bf16 v[208:211], a[8:11], v[24:27], v[208:211]
    ds_read_b128 a[28:31], v7 offset:27648
    v_mfma_f32_16x16x32_bf16 v[216:219], a[8:11], v[28:31], v[216:219]
    v_rcp_f32 v177, v177
    v_mfma_f32_16x16x32_bf16 v[212:215], a[12:15], v[24:27], v[212:215]
    ds_read_b128 a[0:3], v7 offset:28672
    v_mul_f32 v178, v178, v176
    v_mfma_f32_16x16x32_bf16 v[220:223], a[12:15], v[28:31], v[220:223]
    buffer_load_dwordx4 v[236:239], v3, s[20:23], s44 offen offset:3072
    v_mul_f32 v179, v179, v177
    v_cvt_pk_bf16_f32 v176, v178, v179
    s_waitcnt lgkmcnt(3)
    v_mfma_f32_16x16x32_bf16 v[208:211], a[16:19], v[32:35], v[208:211]
    ds_read_b128 a[4:7], v7 offset:29696
    v_min_u32 v176, -2, v176
    v_mfma_f32_16x16x32_bf16 v[216:219], a[16:19], v[36:39], v[216:219]
    v_mul_f32 v182, v180, v182
    v_mul_f32 v183, v181, v183
    v_mfma_f32_16x16x32_bf16 v[212:215], a[20:23], v[32:35], v[212:215]
    ds_read_b128 a[8:11], v7 offset:30720
    v_mul_f32 v180, v14, v180
    v_mfma_f32_16x16x32_bf16 v[220:223], a[20:23], v[36:39], v[220:223]
    buffer_load_dwordx4 v[16:19], v4, s[20:23], s44 offen offset:0
    v_mul_f32 v181, v14, v181
    s_waitcnt lgkmcnt(3)
    v_mfma_f32_16x16x32_bf16 v[208:211], a[24:27], v[40:43], v[208:211]
    ds_read_b128 a[12:15], v7 offset:31744
    v_mfma_f32_16x16x32_bf16 v[216:219], a[24:27], v[44:47], v[216:219]
    v_exp_f32 v180, v180
    v_mfma_f32_16x16x32_bf16 v[212:215], a[28:31], v[40:43], v[212:215]
    ds_read_b128 a[16:19], v7 offset:32768
    v_mfma_f32_16x16x32_bf16 v[220:223], a[28:31], v[44:47], v[220:223]
    buffer_load_dwordx4 v[20:23], v10, s[20:23], s40 offen
    v_exp_f32 v181, v181
    s_waitcnt lgkmcnt(3)
    v_mfma_f32_16x16x32_bf16 v[208:211], a[0:3], v[48:51], v[208:211]
    ds_read_b128 a[20:23], v7 offset:33792
    v_fma_f32 v180, v180, v0, v0
    v_mfma_f32_16x16x32_bf16 v[216:219], a[0:3], v[52:55], v[216:219]
    v_fma_f32 v181, v181, v0, v0
    v_mfma_f32_16x16x32_bf16 v[212:215], a[4:7], v[48:51], v[212:215]
    ds_read_b128 a[24:27], v7 offset:34816
    v_mfma_f32_16x16x32_bf16 v[220:223], a[4:7], v[52:55], v[220:223]
    buffer_load_dwordx4 v[24:27], v10, s[20:23], s41 offen
    v_rcp_f32 v180, v180
    s_waitcnt lgkmcnt(3)
    v_mfma_f32_16x16x32_bf16 v[208:211], a[8:11], v[56:59], v[208:211]
    ds_read_b128 a[28:31], v7 offset:35840
    v_mfma_f32_16x16x32_bf16 v[216:219], a[8:11], v[60:63], v[216:219]
    v_rcp_f32 v181, v181
    v_mfma_f32_16x16x32_bf16 v[212:215], a[12:15], v[56:59], v[212:215]
    ds_read_b128 a[0:3], v7 offset:36864
    v_mul_f32 v182, v182, v180
    v_mfma_f32_16x16x32_bf16 v[220:223], a[12:15], v[60:63], v[220:223]
    buffer_load_dwordx4 v[28:31], v10, s[20:23], s42 offen
    v_mul_f32 v183, v183, v181
    v_cvt_pk_bf16_f32 v177, v182, v183
    s_waitcnt lgkmcnt(3)
    v_mfma_f32_16x16x32_bf16 v[208:211], a[16:19], v[64:67], v[208:211]
    ds_read_b128 a[4:7], v7 offset:37888
    v_mul_f32 v186, v184, v186
    v_mfma_f32_16x16x32_bf16 v[216:219], a[16:19], v[68:71], v[216:219]
    v_mul_f32 v187, v185, v187
    v_mul_f32 v184, v14, v184
    v_mfma_f32_16x16x32_bf16 v[212:215], a[20:23], v[64:67], v[212:215]
    ds_read_b128 a[8:11], v7 offset:38912
    v_mul_f32 v185, v14, v185
    v_mfma_f32_16x16x32_bf16 v[220:223], a[20:23], v[68:71], v[220:223]
    buffer_load_dwordx4 v[32:35], v10, s[20:23], s43 offen
    v_exp_f32 v184, v184
    s_waitcnt lgkmcnt(3)
    v_mfma_f32_16x16x32_bf16 v[208:211], a[24:27], v[72:75], v[208:211]
    ds_read_b128 a[12:15], v7 offset:39936
    v_mfma_f32_16x16x32_bf16 v[216:219], a[24:27], v[76:79], v[216:219]
    v_exp_f32 v185, v185
    v_mfma_f32_16x16x32_bf16 v[212:215], a[28:31], v[72:75], v[212:215]
    ds_read_b128 a[16:19], v3 offset:0
    v_fma_f32 v184, v184, v0, v0
    v_mfma_f32_16x16x32_bf16 v[220:223], a[28:31], v[76:79], v[220:223]
    buffer_load_dwordx4 v[36:39], v3, s[20:23], s45 offen offset:0
    v_fma_f32 v185, v185, v0, v0
    s_waitcnt lgkmcnt(3)
    v_mfma_f32_16x16x32_bf16 v[208:211], a[0:3], v[80:83], v[208:211]
    ds_read_b128 a[20:23], v3 offset:1024
    v_mfma_f32_16x16x32_bf16 v[216:219], a[0:3], v[84:87], v[216:219]
    v_rcp_f32 v184, v184
    v_mfma_f32_16x16x32_bf16 v[212:215], a[4:7], v[80:83], v[212:215]
    v_rcp_f32 v185, v185
    v_mfma_f32_16x16x32_bf16 v[220:223], a[4:7], v[84:87], v[220:223]
    buffer_load_dwordx4 v[40:43], v11, s[20:23], s40 offen
    s_add_u32 s40, s40, 4096
    v_mul_f32 v186, v186, v184
    v_mul_f32 v187, v187, v185
    s_waitcnt lgkmcnt(2)
    v_mfma_f32_16x16x32_bf16 v[208:211], a[8:11], v[88:91], v[208:211]
    v_cvt_pk_bf16_f32 v178, v186, v187
    v_mul_f32 v190, v188, v190
    v_mfma_f32_16x16x32_bf16 v[216:219], a[8:11], v[92:95], v[216:219]
    v_mul_f32 v191, v189, v191
    v_mul_f32 v188, v14, v188
    v_mfma_f32_16x16x32_bf16 v[212:215], a[12:15], v[88:91], v[212:215]
    ds_read_b128 a[24:27], v3 offset:2048
    v_mul_f32 v189, v14, v189
    v_mfma_f32_16x16x32_bf16 v[220:223], a[12:15], v[92:95], v[220:223]
    buffer_load_dwordx4 v[44:47], v11, s[20:23], s41 offen
    s_add_u32 s41, s41, 4096
    v_exp_f32 v188, v188
    s_waitcnt lgkmcnt(1)
    v_mfma_f32_16x16x32_bf16 v[208:211], a[16:19], v[96:99], v[208:211]
    ds_read_b128 a[28:31], v3 offset:3072
    v_mfma_f32_16x16x32_bf16 v[216:219], a[16:19], v[100:103], v[216:219]
    v_exp_f32 v189, v189
    v_mfma_f32_16x16x32_bf16 v[212:215], a[20:23], v[96:99], v[212:215]
    ds_read_b128 a[0:3], v3 offset:4096
    v_fma_f32 v188, v188, v0, v0
    v_mfma_f32_16x16x32_bf16 v[220:223], a[20:23], v[100:103], v[220:223]
    buffer_load_dwordx4 v[48:51], v11, s[20:23], s42 offen
    s_add_u32 s42, s42, 4096
    v_fma_f32 v189, v189, v0, v0
    v_mfma_f32_16x16x16_bf16 v[208:211], a[44:45], a[48:49], v[208:211]
    ds_read_b128 a[4:7], v3 offset:5120
    v_mfma_f32_16x16x16_bf16 v[216:219], a[44:45], a[52:53], v[216:219]
    v_mfma_f32_16x16x16_bf16 v[212:215], a[44:45], a[50:51], v[212:215]
    ds_read_b128 a[8:11], v3 offset:6144
    v_mfma_f32_16x16x16_bf16 v[220:223], a[44:45], a[54:55], v[220:223]
    buffer_load_dwordx4 v[52:55], v11, s[20:23], s43 offen
    s_add_u32 s43, s43, 4096
    s_waitcnt lgkmcnt(3)
    v_mfma_f32_16x16x32_bf16 v[208:211], a[24:27], v[104:107], v[208:211]
    ds_read_b128 a[12:15], v3 offset:7168
    v_mfma_f32_16x16x32_bf16 v[216:219], a[24:27], v[108:111], v[216:219]
    v_rcp_f32 v188, v188
    v_mfma_f32_16x16x32_bf16 v[212:215], a[28:31], v[104:107], v[212:215]
    ds_read_b128 a[16:19], v3 offset:8192
    v_mfma_f32_16x16x32_bf16 v[220:223], a[28:31], v[108:111], v[220:223]
    buffer_load_dwordx4 v[56:59], v3, s[20:23], s45 offen offset:1024
    v_rcp_f32 v189, v189
    s_waitcnt lgkmcnt(3)
    v_mfma_f32_16x16x32_bf16 v[208:211], a[0:3], v[112:115], v[208:211]
    ds_read_b128 a[20:23], v3 offset:9216
    v_mul_f32 v190, v190, v188
    v_mfma_f32_16x16x32_bf16 v[216:219], a[0:3], v[116:119], v[216:219]
    v_mul_f32 v191, v191, v189
    v_cvt_pk_bf16_f32 v179, v190, v191
    buffer_store_dwordx4 v[176:179], v3, s[20:23], s35 offen sc1
    v_mfma_f32_16x16x32_bf16 v[212:215], a[4:7], v[112:115], v[212:215]
    ds_read_b128 a[24:27], v3 offset:10240
    v_mul_f32 v194, v192, v194
    v_mfma_f32_16x16x32_bf16 v[220:223], a[4:7], v[116:119], v[220:223]
    buffer_load_dwordx4 v[60:63], v8, s[20:23], s40 offen
    v_mul_f32 v195, v193, v195
    v_mul_f32 v192, v15, v192
    s_waitcnt lgkmcnt(3)
    v_mfma_f32_16x16x32_bf16 v[208:211], a[8:11], v[120:123], v[208:211]
    ds_read_b128 a[28:31], v3 offset:11264
    v_mul_f32 v193, v15, v193
    v_mfma_f32_16x16x32_bf16 v[216:219], a[8:11], v[124:127], v[216:219]
    v_exp_f32 v192, v192
    v_mfma_f32_16x16x32_bf16 v[212:215], a[12:15], v[120:123], v[212:215]
    ds_read_b128 a[0:3], v3 offset:12288
    v_mfma_f32_16x16x32_bf16 v[220:223], a[12:15], v[124:127], v[220:223]
    buffer_load_dwordx4 v[64:67], v8, s[20:23], s41 offen
    v_exp_f32 v193, v193
    s_waitcnt lgkmcnt(3)
    v_mfma_f32_16x16x32_bf16 v[208:211], a[16:19], v[128:131], v[208:211]
    ds_read_b128 a[4:7], v3 offset:13312
    v_fma_f32 v192, v192, v1, v1
    v_mfma_f32_16x16x32_bf16 v[216:219], a[16:19], v[132:135], v[216:219]
    v_fma_f32 v193, v193, v1, v1
    v_mfma_f32_16x16x32_bf16 v[212:215], a[20:23], v[128:131], v[212:215]
    ds_read_b128 a[8:11], v3 offset:14336
    v_mfma_f32_16x16x32_bf16 v[220:223], a[20:23], v[132:135], v[220:223]
    buffer_load_dwordx4 v[68:71], v8, s[20:23], s42 offen
    v_rcp_f32 v192, v192
    s_waitcnt lgkmcnt(3)
    v_mfma_f32_16x16x32_bf16 v[208:211], a[24:27], v[136:139], v[208:211]
    ds_read_b128 a[12:15], v3 offset:15360
    v_mfma_f32_16x16x32_bf16 v[216:219], a[24:27], v[140:143], v[216:219]
    v_rcp_f32 v193, v193
    v_mfma_f32_16x16x32_bf16 v[212:215], a[28:31], v[136:139], v[212:215]
    ds_read_b128 a[16:19], v3 offset:16384
    v_mul_f32 v194, v194, v192
    v_mfma_f32_16x16x32_bf16 v[220:223], a[28:31], v[140:143], v[220:223]
    buffer_load_dwordx4 v[72:75], v8, s[20:23], s43 offen
    v_mul_f32 v195, v195, v193
    v_cvt_pk_bf16_f32 v192, v194, v195
    s_waitcnt lgkmcnt(3)
    v_mfma_f32_16x16x32_bf16 v[208:211], a[0:3], v[144:147], v[208:211]
    ds_read_b128 a[20:23], v3 offset:17408
    v_min_u32 v192, -2, v192
    v_mfma_f32_16x16x32_bf16 v[216:219], a[0:3], v[148:151], v[216:219]
    v_mul_f32 v198, v196, v198
    v_mul_f32 v199, v197, v199
    v_mfma_f32_16x16x32_bf16 v[212:215], a[4:7], v[144:147], v[212:215]
    ds_read_b128 a[24:27], v3 offset:18432
    v_mul_f32 v196, v15, v196
    v_mfma_f32_16x16x32_bf16 v[220:223], a[4:7], v[148:151], v[220:223]
    buffer_load_dwordx4 v[76:79], v3, s[20:23], s45 offen offset:2048
    v_mul_f32 v197, v15, v197
    s_waitcnt lgkmcnt(3)
    v_mfma_f32_16x16x32_bf16 v[208:211], a[8:11], v[152:155], v[208:211]
    ds_read_b128 a[28:31], v3 offset:19456
    v_mfma_f32_16x16x32_bf16 v[216:219], a[8:11], v[156:159], v[216:219]
    v_exp_f32 v196, v196
    v_mfma_f32_16x16x32_bf16 v[212:215], a[12:15], v[152:155], v[212:215]
    v_exp_f32 v197, v197
    v_mfma_f32_16x16x32_bf16 v[220:223], a[12:15], v[156:159], v[220:223]
    buffer_load_dwordx4 v[80:83], v9, s[20:23], s40 offen
    v_fma_f32 v196, v196, v1, v1
    v_fma_f32 v197, v197, v1, v1
    s_waitcnt lgkmcnt(2)
    v_mfma_f32_16x16x32_bf16 v[208:211], a[16:19], v[160:163], v[208:211]
    s_waitcnt vmcnt(24)
    v_accvgpr_read_b32 v5, a228
    v_accvgpr_read_b32 v2, a232
    v_mfma_f32_16x16x32_bf16 v[216:219], a[16:19], v[164:167], v[216:219]
    v_max_u32 v5, v5, v2
    v_accvgpr_read_b32 v2, a236
    v_mfma_f32_16x16x32_bf16 v[212:215], a[20:23], v[160:163], v[212:215]
    v_max_u32 v5, v5, v2
    v_accvgpr_read_b32 v2, a240
    v_mfma_f32_16x16x32_bf16 v[220:223], a[20:23], v[164:167], v[220:223]
    buffer_load_dwordx4 v[84:87], v9, s[20:23], s41 offen
    v_max_u32 v5, v5, v2
    v_cmp_eq_u32 vcc, -1, v5
    s_waitcnt lgkmcnt(0)
    v_mfma_f32_16x16x32_bf16 v[208:211], a[24:27], v[168:171], v[208:211]
    s_cbranch_vccnz .g3r26
.g3r26b:
    v_rcp_f32 v196, v196
    v_mfma_f32_16x16x32_bf16 v[216:219], a[24:27], v[172:175], v[216:219]
    v_rcp_f32 v197, v197
    v_mfma_f32_16x16x32_bf16 v[212:215], a[28:31], v[168:171], v[212:215]
    v_mul_f32 v198, v198, v196
    v_mul_f32 v199, v199, v197
    v_mfma_f32_16x16x32_bf16 v[220:223], a[28:31], v[172:175], v[220:223]
    buffer_load_dwordx4 v[88:91], v9, s[20:23], s42 offen
    v_cvt_pk_bf16_f32 v193, v198, v199
    v_mul_f32 v202, v200, v202
    v_mfma_f32_16x16x32_bf16 a[0:3], a[60:63], a[228:231], 0
    v_mul_f32 v203, v201, v203
    v_mul_f32 v200, v15, v200
    v_mfma_f32_16x16x32_bf16 a[4:7], a[64:67], a[228:231], 0
    v_mul_f32 v201, v15, v201
    v_mfma_f32_16x16x32_bf16 a[8:11], a[68:71], a[228:231], 0
    v_exp_f32 v200, v200
    v_mfma_f32_16x16x32_bf16 a[12:15], a[72:75], a[228:231], 0
    buffer_load_dwordx4 v[92:95], v9, s[20:23], s43 offen
    v_exp_f32 v201, v201
    v_mfma_f32_16x16x32_bf16 a[16:19], a[76:79], a[228:231], 0
    v_fma_f32 v200, v200, v1, v1
    v_fma_f32 v201, v201, v1, v1
    v_mfma_f32_16x16x32_bf16 a[20:23], a[60:63], a[232:235], 0
    v_rcp_f32 v200, v200
    v_mfma_f32_16x16x32_bf16 a[24:27], a[64:67], a[232:235], 0
    v_rcp_f32 v201, v201
    v_mfma_f32_16x16x32_bf16 a[28:31], a[68:71], a[232:235], 0
    buffer_load_dwordx4 a[228:231], v3, s[20:23], s45 offen offset:3072
    v_mul_f32 v202, v202, v200
    v_mul_f32 v203, v203, v201
    v_mfma_f32_16x16x32_bf16 a[32:35], a[72:75], a[232:235], 0
    v_cvt_pk_bf16_f32 v194, v202, v203
    v_mul_f32 v206, v204, v206
    v_mfma_f32_16x16x32_bf16 a[36:39], a[76:79], a[232:235], 0
    v_mul_f32 v207, v205, v207
    v_mul_f32 v204, v15, v204
    v_mfma_f32_16x16x32_bf16 a[40:43], a[60:63], a[236:239], 0
    buffer_load_dwordx4 v[96:99], v10, s[20:23], s40 offen
    v_mul_f32 v205, v15, v205
    v_mfma_f32_16x16x32_bf16 a[44:47], a[64:67], a[236:239], 0
    v_exp_f32 v204, v204
    v_mfma_f32_16x16x32_bf16 a[48:51], a[68:71], a[236:239], 0
    s_waitcnt vmcnt(25)
    v_accvgpr_read_b32 v5, a244
    v_accvgpr_read_b32 v2, a248
    v_mfma_f32_16x16x32_bf16 a[52:55], a[72:75], a[236:239], 0
    v_max3_u32 v5, v5, v2, v232
    v_accvgpr_read_b32 v2, a252
    v_mfma_f32_16x16x32_bf16 v[228:231], a[76:79], a[236:239], 0
    buffer_load_dwordx4 v[100:103], v10, s[20:23], s41 offen
    v_max_u32 v5, v5, v2
    v_cmp_eq_u32 vcc, -1, v5
    v_mfma_f32_16x16x32_bf16 v[240:243], a[60:63], a[240:243], 0
    s_cbranch_vccnz .g3r27
.g3r27b:
    v_exp_f32 v205, v205
    v_mfma_f32_16x16x32_bf16 v[244:247], a[64:67], a[240:243], 0
    v_fma_f32 v204, v204, v1, v1
    v_fma_f32 v205, v205, v1, v1
    v_mfma_f32_16x16x32_bf16 v[248:251], a[68:71], a[240:243], 0
    buffer_load_dwordx4 v[104:107], v10, s[20:23], s42 offen
    v_rcp_f32 v204, v204
    v_mfma_f32_16x16x32_bf16 v[252:255], a[72:75], a[240:243], 0
    v_rcp_f32 v205, v205
    v_mfma_f32_16x16x32_bf16 v[224:227], a[76:79], a[240:243], 0
    v_mul_f32 v206, v206, v204
    v_mul_f32 v207, v207, v205
    v_mfma_f32_16x16x32_bf16 a[0:3], a[80:83], a[244:247], a[0:3]
    v_cvt_pk_bf16_f32 v195, v206, v207
    buffer_store_dwordx4 v[192:195], v3, s[20:23], s36 offen sc1
    v_mul_f32 v210, v208, v210
    v_mfma_f32_16x16x32_bf16 a[4:7], a[84:87], a[244:247], a[4:7]
    buffer_load_dwordx4 v[108:111], v10, s[20:23], s43 offen
    v_mul_f32 v211, v209, v211
    v_mul_f32 v208, v14, v208
    v_mfma_f32_16x16x32_bf16 a[8:11], a[88:91], a[244:247], a[8:11]
    v_mul_f32 v209, v14, v209
    v_mfma_f32_16x16x32_bf16 a[12:15], a[92:95], a[244:247], a[12:15]
    v_exp_f32 v208, v208
    v_mfma_f32_16x16x32_bf16 a[16:19], a[96:99], a[244:247], a[16:19]
    buffer_load_dwordx4 a[232:235], v4, s[20:23], s45 offen offset:0
    v_exp_f32 v209, v209
    v_mfma_f32_16x16x32_bf16 a[20:23], a[80:83], a[248:251], a[20:23]
    v_fma_f32 v208, v208, v0, v0
    v_fma_f32 v209, v209, v0, v0
    v_mfma_f32_16x16x32_bf16 a[24:27], a[84:87], a[248:251], a[24:27]
    v_rcp_f32 v208, v208
    v_mfma_f32_16x16x32_bf16 a[28:31], a[88:91], a[248:251], a[28:31]
    v_rcp_f32 v209, v209
    v_mfma_f32_16x16x32_bf16 a[32:35], a[92:95], a[248:251], a[32:35]
    buffer_load_dwordx4 a[236:239], v3, s[20:23], s46 offen offset:0
    v_mul_f32 v210, v210, v208
    v_mul_f32 v211, v211, v209
    v_mfma_f32_16x16x32_bf16 a[36:39], a[96:99], a[248:251], a[36:39]
    v_cvt_pk_bf16_f32 v208, v210, v211
    v_min_u32 v208, -2, v208
    v_mfma_f32_16x16x32_bf16 a[40:43], a[80:83], a[252:255], a[40:43]
    v_mul_f32 v214, v212, v214
    v_mul_f32 v215, v213, v215
    v_mfma_f32_16x16x32_bf16 a[44:47], a[84:87], a[252:255], a[44:47]
    buffer_load_dwordx4 v[112:115], v11, s[20:23], s40 offen
    s_add_u32 s40, s40, 4096
    v_mul_f32 v212, v14, v212
    v_mul_f32 v213, v14, v213
    v_mfma_f32_16x16x32_bf16 a[48:51], a[88:91], a[252:255], a[48:51]
    s_waitcnt vmcnt(25)
    v_max3_u32 v5, v32, v28, v24
    v_max_u32 v5, v5, v20
    v_mfma_f32_16x16x32_bf16 a[52:55], a[92:95], a[252:255], a[52:55]
    v_cmp_eq_u32 vcc, -1, v5
    s_cbranch_vccnz .g3r28
.g3r28b:
    v_mfma_f32_16x16x32_bf16 v[228:231], a[96:99], a[252:255], v[228:231]
    v_exp_f32 v212, v212
    v_mfma_f32_16x16x32_bf16 v[240:243], a[80:83], v[232:235], v[240:243]
    buffer_load_dwordx4 v[176:179], v11, s[20:23], s41 offen
    s_add_u32 s41, s41, 4096
    v_exp_f32 v213, v213
    v_mfma_f32_16x16x32_bf16 v[244:247], a[84:87], v[232:235], v[244:247]
    v_fma_f32 v212, v212, v0, v0
    v_fma_f32 v213, v213, v0, v0
    v_mfma_f32_16x16x32_bf16 v[248:251], a[88:91], v[232:235], v[248:251]
    v_rcp_f32 v212, v212
    v_mfma_f32_16x16x32_bf16 v[252:255], a[92:95], v[232:235], v[252:255]
    buffer_load_dwordx4 v[180:183], v11, s[20:23], s42 offen
    s_add_u32 s42, s42, 4096
    v_rcp_f32 v213, v213
    v_mfma_f32_16x16x32_bf16 v[224:227], a[96:99], v[232:235], v[224:227]
    v_mul_f32 v214, v214, v212
    v_mul_f32 v215, v215, v213
    v_mfma_f32_16x16x32_bf16 a[0:3], a[100:103], v[20:23], a[0:3]
    v_cvt_pk_bf16_f32 v209, v214, v215
    buffer_store_dwordx2 v[208:209], v12, s[20:23], s37 offen sc1
    v_mul_f32 v218, v216, v218
    v_mfma_f32_16x16x32_bf16 a[4:7], a[104:107], v[20:23], a[4:7]
    v_mul_f32 v219, v217, v219
    v_mul_f32 v216, v15, v216
    v_mfma_f32_16x16x32_bf16 a[8:11], a[108:111], v[20:23], a[8:11]
    buffer_load_dwordx4 v[184:187], v11, s[20:23], s43 offen
    s_add_u32 s43, s43, 4096
    v_mul_f32 v217, v15, v217
    v_mfma_f32_16x16x32_bf16 a[12:15], a[112:115], v[20:23], a[12:15]
    v_exp_f32 v216, v216
    v_mfma_f32_16x16x32_bf16 a[16:19], a[116:119], v[20:23], a[16:19]
    v_exp_f32 v217, v217
    v_mfma_f32_16x16x32_bf16 a[20:23], a[100:103], v[24:27], a[20:23]
    buffer_load_dwordx4 a[60:63], v3, s[20:23], s46 offen offset:1024
    v_fma_f32 v216, v216, v1, v1
    v_fma_f32 v217, v217, v1, v1
    v_mfma_f32_16x16x32_bf16 a[24:27], a[104:107], v[24:27], a[24:27]
    v_rcp_f32 v216, v216
    v_mfma_f32_16x16x32_bf16 a[28:31], a[108:111], v[24:27], a[28:31]
    v_rcp_f32 v217, v217
    v_mfma_f32_16x16x32_bf16 a[32:35], a[112:115], v[24:27], a[32:35]
    v_mul_f32 v218, v218, v216
    v_mul_f32 v219, v219, v217
    v_mfma_f32_16x16x32_bf16 a[36:39], a[116:119], v[24:27], a[36:39]
    buffer_load_dwordx4 a[64:67], v3, s[20:23], s46 offen offset:2048
    v_cvt_pk_bf16_f32 v216, v218, v219
    v_min_u32 v216, -2, v216
    v_mfma_f32_16x16x32_bf16 a[40:43], a[100:103], v[28:31], a[40:43]
    v_mul_f32 v222, v220, v222
    v_mul_f32 v223, v221, v223
    v_mfma_f32_16x16x32_bf16 a[44:47], a[104:107], v[28:31], a[44:47]
    v_mul_f32 v220, v15, v220
    v_mul_f32 v221, v15, v221
    v_mfma_f32_16x16x32_bf16 a[48:51], a[108:111], v[28:31], a[48:51]
    buffer_load_dwordx4 v[188:191], v8, s[20:23], s40 offen
    s_waitcnt vmcnt(27)
    v_max3_u32 v5, v52, v48, v44
    v_max_u32 v5, v5, v40
    v_mfma_f32_16x16x32_bf16 a[52:55], a[112:115], v[28:31], a[52:55]
    v_cmp_eq_u32 vcc, -1, v5
    s_cbranch_vccnz .g3r29
.g3r29b:
    v_mfma_f32_16x16x32_bf16 v[228:231], a[116:119], v[28:31], v[228:231]
    v_exp_f32 v220, v220
    v_mfma_f32_16x16x32_bf16 v[240:243], a[100:103], v[32:35], v[240:243]
    v_exp_f32 v221, v221
    v_mfma_f32_16x16x32_bf16 v[244:247], a[104:107], v[32:35], v[244:247]
    buffer_load_dwordx4 v[116:119], v8, s[20:23], s41 offen
    v_fma_f32 v220, v220, v1, v1
    v_fma_f32 v221, v221, v1, v1
    v_mfma_f32_16x16x32_bf16 v[248:251], a[108:111], v[32:35], v[248:251]
    v_rcp_f32 v220, v220
    v_mfma_f32_16x16x32_bf16 v[252:255], a[112:115], v[32:35], v[252:255]
    v_rcp_f32 v221, v221
    v_mfma_f32_16x16x32_bf16 v[224:227], a[116:119], v[32:35], v[224:227]
    buffer_load_dwordx4 v[120:123], v8, s[20:23], s42 offen
    v_mul_f32 v222, v222, v220
    v_mul_f32 v223, v223, v221
    v_mfma_f32_16x16x32_bf16 a[0:3], a[120:123], v[40:43], a[0:3]
    v_cvt_pk_bf16_f32 v217, v222, v223
    buffer_store_dwordx2 v[216:217], v12, s[20:23], s38 offen sc1
    v_mfma_f32_16x16x32_bf16 a[4:7], a[124:127], v[40:43], a[4:7]
    v_mfma_f32_16x16x32_bf16 a[8:11], a[128:131], v[40:43], a[8:11]
    v_mfma_f32_16x16x32_bf16 a[12:15], a[132:135], v[40:43], a[12:15]
    buffer_load_dwordx4 v[124:127], v8, s[20:23], s43 offen
    v_mfma_f32_16x16x32_bf16 a[16:19], a[136:139], v[40:43], a[16:19]
    v_mfma_f32_16x16x32_bf16 a[20:23], a[120:123], v[44:47], a[20:23]
    v_mfma_f32_16x16x32_bf16 a[24:27], a[124:127], v[44:47], a[24:27]
    buffer_load_dwordx4 a[68:71], v3, s[20:23], s46 offen offset:3072
    v_mfma_f32_16x16x32_bf16 a[28:31], a[128:131], v[44:47], a[28:31]
    v_mfma_f32_16x16x32_bf16 a[32:35], a[132:135], v[44:47], a[32:35]
    v_mfma_f32_16x16x32_bf16 a[36:39], a[136:139], v[44:47], a[36:39]
    v_mfma_f32_16x16x32_bf16 a[40:43], a[120:123], v[48:51], a[40:43]
    buffer_load_dwordx4 v[128:131], v9, s[20:23], s40 offen
    v_mfma_f32_16x16x32_bf16 a[44:47], a[124:127], v[48:51], a[44:47]
    v_mfma_f32_16x16x32_bf16 a[48:51], a[128:131], v[48:51], a[48:51]
    s_waitcnt vmcnt(27)
    v_max3_u32 v5, v72, v68, v64
    v_max_u32 v5, v5, v60
    v_mfma_f32_16x16x32_bf16 a[52:55], a[132:135], v[48:51], a[52:55]
    buffer_load_dwordx4 v[132:135], v9, s[20:23], s41 offen
    v_cmp_eq_u32 vcc, -1, v5
    s_cbranch_vccnz .g3r30
.g3r30b:
    v_mfma_f32_16x16x32_bf16 v[228:231], a[136:139], v[48:51], v[228:231]
    v_mfma_f32_16x16x32_bf16 v[240:243], a[120:123], v[52:55], v[240:243]
    v_mfma_f32_16x16x32_bf16 v[244:247], a[124:127], v[52:55], v[244:247]
    v_mfma_f32_16x16x32_bf16 v[248:251], a[128:131], v[52:55], v[248:251]
    buffer_load_dwordx4 v[136:139], v9, s[20:23], s42 offen
    v_mfma_f32_16x16x32_bf16 v[252:255], a[132:135], v[52:55], v[252:255]
    v_mfma_f32_16x16x32_bf16 v[224:227], a[136:139], v[52:55], v[224:227]
    v_mfma_f32_16x16x32_bf16 a[0:3], a[140:143], v[60:63], a[0:3]
    buffer_load_dwordx4 v[140:143], v9, s[20:23], s43 offen
    v_mfma_f32_16x16x32_bf16 a[4:7], a[144:147], v[60:63], a[4:7]
    v_mfma_f32_16x16x32_bf16 a[8:11], a[148:151], v[60:63], a[8:11]
    v_mfma_f32_16x16x32_bf16 a[12:15], a[152:155], v[60:63], a[12:15]
    v_mfma_f32_16x16x32_bf16 a[16:19], a[156:159], v[60:63], a[16:19]
    buffer_load_dwordx4 a[72:75], v4, s[20:23], s46 offen offset:0
    v_mfma_f32_16x16x32_bf16 a[20:23], a[140:143], v[64:67], a[20:23]
    v_mfma_f32_16x16x32_bf16 a[24:27], a[144:147], v[64:67], a[24:27]
    v_mfma_f32_16x16x32_bf16 a[28:31], a[148:151], v[64:67], a[28:31]
    buffer_load_dwordx4 a[240:243], v3, s[20:23], s47 offen offset:0
    v_mfma_f32_16x16x32_bf16 a[32:35], a[152:155], v[64:67], a[32:35]
    v_mfma_f32_16x16x32_bf16 a[36:39], a[156:159], v[64:67], a[36:39]
    v_mfma_f32_16x16x32_bf16 a[40:43], a[140:143], v[68:71], a[40:43]
    v_mfma_f32_16x16x32_bf16 a[44:47], a[144:147], v[68:71], a[44:47]
    buffer_load_dwordx4 v[144:147], v10, s[20:23], s40 offen
    v_mfma_f32_16x16x32_bf16 a[48:51], a[148:151], v[68:71], a[48:51]
    s_waitcnt vmcnt(28)
    v_max3_u32 v5, v92, v88, v84
    v_max_u32 v5, v5, v80
    v_mfma_f32_16x16x32_bf16 a[52:55], a[152:155], v[68:71], a[52:55]
    v_cmp_eq_u32 vcc, -1, v5
    s_cbranch_vccnz .g3r31
.g3r31b:
    v_mfma_f32_16x16x32_bf16 v[228:231], a[156:159], v[68:71], v[228:231]
    buffer_load_dwordx4 v[148:151], v10, s[20:23], s41 offen
    v_mfma_f32_16x16x32_bf16 v[240:243], a[140:143], v[72:75], v[240:243]
    v_mfma_f32_16x16x32_bf16 v[244:247], a[144:147], v[72:75], v[244:247]
    v_mfma_f32_16x16x32_bf16 v[248:251], a[148:151], v[72:75], v[248:251]
    v_mfma_f32_16x16x32_bf16 v[252:255], a[152:155], v[72:75], v[252:255]
    buffer_load_dwordx4 v[152:155], v10, s[20:23], s42 offen
    v_mfma_f32_16x16x32_bf16 v[224:227], a[156:159], v[72:75], v[224:227]
    v_mfma_f32_16x16x32_bf16 a[0:3], a[160:163], v[80:83], a[0:3]
    v_mfma_f32_16x16x32_bf16 a[4:7], a[164:167], v[80:83], a[4:7]
    buffer_load_dwordx4 v[156:159], v10, s[20:23], s43 offen
    v_mfma_f32_16x16x32_bf16 a[8:11], a[168:171], v[80:83], a[8:11]
    v_mfma_f32_16x16x32_bf16 a[12:15], a[172:175], v[80:83], a[12:15]
    v_mfma_f32_16x16x32_bf16 a[16:19], a[176:179], v[80:83], a[16:19]
    v_mfma_f32_16x16x32_bf16 a[20:23], a[160:163], v[84:87], a[20:23]
    buffer_load_dwordx4 a[76:79], v3, s[20:23], s47 offen offset:1024
    v_mfma_f32_16x16x32_bf16 a[24:27], a[164:167], v[84:87], a[24:27]
    v_mfma_f32_16x16x32_bf16 a[28:31], a[168:171], v[84:87], a[28:31]
    v_mfma_f32_16x16x32_bf16 a[32:35], a[172:175], v[84:87], a[32:35]
    buffer_load_dwordx4 a[244:247], v3, s[20:23], s47 offen offset:2048
    v_mfma_f32_16x16x32_bf16 a[36:39], a[176:179], v[84:87], a[36:39]
    v_mfma_f32_16x16x32_bf16 a[40:43], a[160:163], v[88:91], a[40:43]
    v_mfma_f32_16x16x32_bf16 a[44:47], a[164:167], v[88:91], a[44:47]
    v_mfma_f32_16x16x32_bf16 a[48:51], a[168:171], v[88:91], a[48:51]
    buffer_load_dwordx4 v[160:163], v11, s[20:23], s40 offen
    s_add_u32 s40, s40, 4096
    s_waitcnt vmcnt(28)
    v_max3_u32 v5, v108, v104, v100
    v_max_u32 v5, v5, v96
    v_mfma_f32_16x16x32_bf16 a[52:55], a[172:175], v[88:91], a[52:55]
    v_cmp_eq_u32 vcc, -1, v5
    s_cbranch_vccnz .g3r32
.g3r32b:
    v_mfma_f32_16x16x32_bf16 v[228:231], a[176:179], v[88:91], v[228:231]
    v_mfma_f32_16x16x32_bf16 v[240:243], a[160:163], v[92:95], v[240:243]
    buffer_load_dwordx4 v[164:167], v11, s[20:23], s41 offen
    s_add_u32 s41, s41, 4096
    v_mfma_f32_16x16x32_bf16 v[244:247], a[164:167], v[92:95], v[244:247]
    v_mfma_f32_16x16x32_bf16 v[248:251], a[168:171], v[92:95], v[248:251]
    v_mfma_f32_16x16x32_bf16 v[252:255], a[172:175], v[92:95], v[252:255]
    v_mfma_f32_16x16x32_bf16 v[224:227], a[176:179], v[92:95], v[224:227]
    buffer_load_dwordx4 v[168:171], v11, s[20:23], s42 offen
    s_add_u32 s42, s42, 4096
    v_mfma_f32_16x16x32_bf16 a[0:3], a[180:183], v[96:99], a[0:3]
    v_mfma_f32_16x16x32_bf16 a[4:7], a[184:187], v[96:99], a[4:7]
    v_mfma_f32_16x16x32_bf16 a[8:11], a[188:191], v[96:99], a[8:11]
    buffer_load_dwordx4 v[172:175], v11, s[20:23], s43 offen
    s_add_u32 s43, s43, 4096
    v_mfma_f32_16x16x32_bf16 a[12:15], a[192:195], v[96:99], a[12:15]
    v_mfma_f32_16x16x32_bf16 a[16:19], a[196:199], v[96:99], a[16:19]
    v_mfma_f32_16x16x32_bf16 a[20:23], a[180:183], v[100:103], a[20:23]
    v_mfma_f32_16x16x32_bf16 a[24:27], a[184:187], v[100:103], a[24:27]
    buffer_load_dwordx4 a[248:251], v3, s[20:23], s47 offen offset:3072
    v_mfma_f32_16x16x32_bf16 a[28:31], a[188:191], v[100:103], a[28:31]
    v_mfma_f32_16x16x32_bf16 a[32:35], a[192:195], v[100:103], a[32:35]
    v_mfma_f32_16x16x32_bf16 a[36:39], a[196:199], v[100:103], a[36:39]
    buffer_load_dwordx4 a[252:255], v4, s[20:23], s47 offen offset:0
    v_mfma_f32_16x16x32_bf16 a[40:43], a[180:183], v[104:107], a[40:43]
    v_mfma_f32_16x16x32_bf16 a[44:47], a[184:187], v[104:107], a[44:47]
    v_mfma_f32_16x16x32_bf16 a[48:51], a[188:191], v[104:107], a[48:51]
    s_waitcnt vmcnt(26)
    v_max3_u32 v5, v184, v180, v176
    v_max_u32 v5, v5, v112
    v_mfma_f32_16x16x32_bf16 a[52:55], a[192:195], v[104:107], a[52:55]
    buffer_load_dwordx2 v[192:193], v12, s[20:23], s40 offen offset:0
    v_cmp_eq_u32 vcc, -1, v5
    s_cbranch_vccnz .g3r33
.g3r33b:
    v_mfma_f32_16x16x32_bf16 v[228:231], a[196:199], v[104:107], v[228:231]
    v_mfma_f32_16x16x32_bf16 v[240:243], a[180:183], v[108:111], v[240:243]
    v_mfma_f32_16x16x32_bf16 v[244:247], a[184:187], v[108:111], v[244:247]
    buffer_load_dwordx2 v[194:195], v12, s[20:23], s40 offen offset:512
    v_mfma_f32_16x16x32_bf16 v[248:251], a[188:191], v[108:111], v[248:251]
    v_mfma_f32_16x16x32_bf16 v[252:255], a[192:195], v[108:111], v[252:255]
    v_mfma_f32_16x16x32_bf16 v[224:227], a[196:199], v[108:111], v[224:227]
    v_mfma_f32_16x16x32_bf16 a[0:3], a[200:203], v[112:115], a[0:3]
    buffer_load_dwordx2 v[196:197], v12, s[20:23], s40 offen offset:1024
    v_mfma_f32_16x16x32_bf16 a[4:7], a[204:207], v[112:115], a[4:7]
    v_mfma_f32_16x16x32_bf16 a[8:11], a[208:211], v[112:115], a[8:11]
    v_mfma_f32_16x16x32_bf16 a[12:15], a[212:215], v[112:115], a[12:15]
    buffer_load_dwordx2 v[200:201], v12, s[20:23], s41 offen offset:0
    v_mfma_f32_16x16x32_bf16 a[16:19], a[216:219], v[112:115], a[16:19]
    v_mfma_f32_16x16x32_bf16 a[20:23], a[200:203], v[176:179], a[20:23]
    v_mfma_f32_16x16x32_bf16 a[24:27], a[204:207], v[176:179], a[24:27]
    v_mfma_f32_16x16x32_bf16 a[28:31], a[208:211], v[176:179], a[28:31]
    buffer_load_dwordx2 v[202:203], v12, s[20:23], s41 offen offset:512
    v_mfma_f32_16x16x32_bf16 a[32:35], a[212:215], v[176:179], a[32:35]
    v_mfma_f32_16x16x32_bf16 a[36:39], a[216:219], v[176:179], a[36:39]
    v_mfma_f32_16x16x32_bf16 a[40:43], a[200:203], v[180:183], a[40:43]
    buffer_load_dwordx2 v[198:199], v12, s[20:23], s41 offen offset:1024
    v_mfma_f32_16x16x32_bf16 a[44:47], a[204:207], v[180:183], a[44:47]
    v_mfma_f32_16x16x32_bf16 a[48:51], a[208:211], v[180:183], a[48:51]
    s_waitcnt vmcnt(25)
    v_max3_u32 v5, v124, v120, v116
    v_max_u32 v5, v5, v188
    v_mfma_f32_16x16x32_bf16 a[52:55], a[212:215], v[180:183], a[52:55]
    v_cmp_eq_u32 vcc, -1, v5
    s_cbranch_vccnz .g3r34
.g3r34b:
    v_mfma_f32_16x16x32_bf16 v[228:231], a[216:219], v[180:183], v[228:231]
    buffer_load_dwordx2 v[204:205], v12, s[20:23], s42 offen offset:0
    v_mfma_f32_16x16x32_bf16 v[240:243], a[200:203], v[184:187], v[240:243]
    v_mfma_f32_16x16x32_bf16 v[244:247], a[204:207], v[184:187], v[244:247]
    v_mfma_f32_16x16x32_bf16 v[248:251], a[208:211], v[184:187], v[248:251]
    buffer_load_dwordx2 v[206:207], v12, s[20:23], s42 offen offset:512
    v_mfma_f32_16x16x32_bf16 v[252:255], a[212:215], v[184:187], v[252:255]
    v_mfma_f32_16x16x32_bf16 v[224:227], a[216:219], v[184:187], v[224:227]
    v_mfma_f32_16x16x32_bf16 a[0:3], a[220:223], v[188:191], a[0:3]
    v_mfma_f32_16x16x32_bf16 a[4:7], a[224:227], v[188:191], a[4:7]
    buffer_load_dwordx2 v[232:233], v12, s[20:23], s42 offen offset:1024
    v_mfma_f32_16x16x32_bf16 a[8:11], a[56:59], v[188:191], a[8:11]
    v_mfma_f32_16x16x32_bf16 a[12:15], v[236:239], v[188:191], a[12:15]
    v_mfma_f32_16x16x32_bf16 a[16:19], v[16:19], v[188:191], a[16:19]
    buffer_load_dwordx2 v[208:209], v12, s[20:23], s43 offen offset:0
    v_mfma_f32_16x16x32_bf16 a[20:23], a[220:223], v[116:119], a[20:23]
    v_mfma_f32_16x16x32_bf16 a[24:27], a[224:227], v[116:119], a[24:27]
    v_mfma_f32_16x16x32_bf16 a[28:31], a[56:59], v[116:119], a[28:31]
    v_mfma_f32_16x16x32_bf16 a[32:35], v[236:239], v[116:119], a[32:35]
    buffer_load_dwordx2 v[210:211], v12, s[20:23], s43 offen offset:512
    v_mfma_f32_16x16x32_bf16 a[36:39], v[16:19], v[116:119], a[36:39]
    v_mfma_f32_16x16x32_bf16 a[40:43], a[220:223], v[120:123], a[40:43]
    v_mfma_f32_16x16x32_bf16 a[44:47], a[224:227], v[120:123], a[44:47]
    buffer_load_dwordx2 v[234:235], v12, s[20:23], s43 offen offset:1024
    v_mfma_f32_16x16x32_bf16 a[48:51], a[56:59], v[120:123], a[48:51]
    s_waitcnt vmcnt(26)
    v_max3_u32 v5, v140, v136, v132
    v_max_u32 v5, v5, v128
    v_mfma_f32_16x16x32_bf16 a[52:55], v[236:239], v[120:123], a[52:55]
    v_cmp_eq_u32 vcc, -1, v5
    s_cbranch_vccnz .g3r35
.g3r35b:
    v_mfma_f32_16x16x32_bf16 v[228:231], v[16:19], v[120:123], v[228:231]
    v_mfma_f32_16x16x32_bf16 v[240:243], a[220:223], v[124:127], v[240:243]
    buffer_load_dwordx4 a[80:83], v3, s[20:23], s48 offen offset:0
    v_mfma_f32_16x16x32_bf16 v[244:247], a[224:227], v[124:127], v[244:247]
    v_mfma_f32_16x16x32_bf16 v[248:251], a[56:59], v[124:127], v[248:251]
    v_mfma_f32_16x16x32_bf16 v[252:255], v[236:239], v[124:127], v[252:255]
    buffer_load_dwordx4 a[84:87], v3, s[20:23], s48 offen offset:1024
    v_mfma_f32_16x16x32_bf16 v[224:227], v[16:19], v[124:127], v[224:227]
    v_mfma_f32_16x16x32_bf16 a[0:3], v[36:39], v[128:131], a[0:3]
    v_mfma_f32_16x16x32_bf16 a[4:7], v[56:59], v[128:131], a[4:7]
    v_mfma_f32_16x16x32_bf16 a[8:11], v[76:79], v[128:131], a[8:11]
    buffer_load_dwordx4 a[88:91], v3, s[20:23], s48 offen offset:2048
    v_mfma_f32_16x16x32_bf16 a[12:15], a[228:231], v[128:131], a[12:15]
    v_mfma_f32_16x16x32_bf16 a[16:19], a[232:235], v[128:131], a[16:19]
    v_mfma_f32_16x16x32_bf16 a[20:23], v[36:39], v[132:135], a[20:23]
    buffer_load_dwordx4 a[92:95], v3, s[20:23], s48 offen offset:3072
    v_mfma_f32_16x16x32_bf16 a[24:27], v[56:59], v[132:135], a[24:27]
    v_mfma_f32_16x16x32_bf16 a[28:31], v[76:79], v[132:135], a[28:31]
    v_mfma_f32_16x16x32_bf16 a[32:35], a[228:231], v[132:135], a[32:35]
    v_mfma_f32_16x16x32_bf16 a[36:39], a[232:235], v[132:135], a[36:39]
    buffer_load_dwordx4 a[96:99], v4, s[20:23], s48 offen offset:0
    v_mfma_f32_16x16x32_bf16 a[40:43], v[36:39], v[136:139], a[40:43]
    v_mfma_f32_16x16x32_bf16 a[44:47], v[56:59], v[136:139], a[44:47]
    v_mfma_f32_16x16x32_bf16 a[48:51], v[76:79], v[136:139], a[48:51]
    buffer_load_dwordx2 a[100:101], v3, s[20:23], s49 offen offset:0
    s_waitcnt vmcnt(26)
    v_max3_u32 v5, v156, v152, v148
    v_max_u32 v5, v5, v144
    v_mfma_f32_16x16x32_bf16 a[52:55], a[228:231], v[136:139], a[52:55]
    v_cmp_eq_u32 vcc, -1, v5
    s_cbranch_vccnz .g3r36
.g3r36b:
    v_mfma_f32_16x16x32_bf16 v[228:231], a[232:235], v[136:139], v[228:231]
    v_mfma_f32_16x16x32_bf16 v[240:243], v[36:39], v[140:143], v[240:243]
    v_mfma_f32_16x16x32_bf16 v[244:247], v[56:59], v[140:143], v[244:247]
    buffer_load_dwordx2 a[102:103], v3, s[20:23], s49 offen offset:1024
    v_mfma_f32_16x16x32_bf16 v[248:251], v[76:79], v[140:143], v[248:251]
    v_mfma_f32_16x16x32_bf16 v[252:255], a[228:231], v[140:143], v[252:255]
    v_mfma_f32_16x16x32_bf16 v[224:227], a[232:235], v[140:143], v[224:227]
    buffer_load_dwordx2 a[104:105], v3, s[20:23], s49 offen offset:2048
    v_mfma_f32_16x16x32_bf16 a[0:3], a[236:239], v[144:147], a[0:3]
    v_mfma_f32_16x16x32_bf16 a[4:7], a[60:63], v[144:147], a[4:7]
    v_mfma_f32_16x16x32_bf16 a[8:11], a[64:67], v[144:147], a[8:11]
    v_mfma_f32_16x16x32_bf16 a[12:15], a[68:71], v[144:147], a[12:15]
    buffer_load_dwordx2 a[106:107], v3, s[20:23], s49 offen offset:3072
    v_mfma_f32_16x16x32_bf16 a[16:19], a[72:75], v[144:147], a[16:19]
    v_mfma_f32_16x16x32_bf16 a[20:23], a[236:239], v[148:151], a[20:23]
    v_mfma_f32_16x16x32_bf16 a[24:27], a[60:63], v[148:151], a[24:27]
    buffer_load_dwordx2 a[108:109], v4, s[20:23], s49 offen offset:0
    v_mfma_f32_16x16x32_bf16 a[28:31], a[64:67], v[148:151], a[28:31]
    v_mfma_f32_16x16x32_bf16 a[32:35], a[68:71], v[148:151], a[32:35]
    v_mfma_f32_16x16x32_bf16 a[36:39], a[72:75], v[148:151], a[36:39]
    v_mfma_f32_16x16x32_bf16 a[40:43], a[236:239], v[152:155], a[40:43]
    buffer_load_dwordx2 v[212:213], v3, s[20:23], s50 offen offset:0 sc1
    v_mfma_f32_16x16x32_bf16 a[44:47], a[60:63], v[152:155], a[44:47]
    v_mfma_f32_16x16x32_bf16 a[48:51], a[64:67], v[152:155], a[48:51]
    s_waitcnt vmcnt(25)
    v_max3_u32 v5, v172, v168, v164
    v_max_u32 v5, v5, v160
    v_mfma_f32_16x16x32_bf16 a[52:55], a[68:71], v[152:155], a[52:55]
    buffer_load_dwordx2 v[214:215], v3, s[20:23], s50 offen offset:1024 sc1
    v_cmp_eq_u32 vcc, -1, v5
    s_cbranch_vccnz .g3r37
.g3r37b:
    v_mfma_f32_16x16x32_bf16 v[228:231], a[72:75], v[152:155], v[228:231]
    v_mfma_f32_16x16x32_bf16 v[240:243], a[236:239], v[156:159], v[240:243]
    v_mfma_f32_16x16x32_bf16 v[244:247], a[60:63], v[156:159], v[244:247]
    v_mfma_f32_16x16x32_bf16 v[248:251], a[64:67], v[156:159], v[248:251]
    buffer_load_dwordx2 v[20:21], v3, s[20:23], s50 offen offset:2048 sc1
    v_mfma_f32_16x16x32_bf16 v[252:255], a[68:71], v[156:159], v[252:255]
    v_mfma_f32_16x16x32_bf16 v[224:227], a[72:75], v[156:159], v[224:227]
    v_mfma_f32_16x16x32_bf16 a[0:3], a[240:243], v[160:163], a[0:3]
    buffer_load_dwordx2 v[22:23], v3, s[20:23], s50 offen offset:3072 sc1
    v_mfma_f32_16x16x32_bf16 a[4:7], a[76:79], v[160:163], a[4:7]
    v_mfma_f32_16x16x32_bf16 a[8:11], a[244:247], v[160:163], a[8:11]
    s_waitcnt vmcnt(27)
    v_mfma_f32_16x16x32_bf16 a[12:15], a[248:251], v[160:163], a[12:15]
    s_waitcnt vmcnt(26)
    v_mfma_f32_16x16x32_bf16 a[16:19], a[252:255], v[160:163], a[16:19]
    buffer_load_dwordx2 v[24:25], v4, s[20:23], s50 offen offset:0 sc1
    s_waitcnt vmcnt(15)
    v_max3_u32 v5, v234, v210, v208
    v_max3_u32 v5, v5, v232, v206
    v_mfma_f32_16x16x32_bf16 a[20:23], a[240:243], v[164:167], a[20:23]
    v_max3_u32 v5, v5, v204, v198
    v_max3_u32 v5, v5, v202, v200
    v_mfma_f32_16x16x32_bf16 a[24:27], a[76:79], v[164:167], a[24:27]
    v_max3_u32 v5, v5, v196, v194
    v_max_u32 v5, v5, v192
    v_mfma_f32_16x16x32_bf16 a[28:31], a[244:247], v[164:167], a[28:31]
    v_cmp_eq_u32 vcc, -1, v5
    s_cbranch_vccnz .g3r38
.g3r38b:
    v_mfma_f32_16x16x32_bf16 a[32:35], a[248:251], v[164:167], a[32:35]
    v_mfma_f32_16x16x32_bf16 a[36:39], a[252:255], v[164:167], a[36:39]
    v_mfma_f32_16x16x32_bf16 a[40:43], a[240:243], v[168:171], a[40:43]
    v_mfma_f32_16x16x32_bf16 a[44:47], a[76:79], v[168:171], a[44:47]
    v_mfma_f32_16x16x32_bf16 a[48:51], a[244:247], v[168:171], a[48:51]
    v_mfma_f32_16x16x32_bf16 a[52:55], a[248:251], v[168:171], a[52:55]
    v_mfma_f32_16x16x32_bf16 v[228:231], a[252:255], v[168:171], v[228:231]
    v_mfma_f32_16x16x32_bf16 v[240:243], a[240:243], v[172:175], v[240:243]
    v_mfma_f32_16x16x32_bf16 v[244:247], a[76:79], v[172:175], v[244:247]
    v_mfma_f32_16x16x32_bf16 v[248:251], a[244:247], v[172:175], v[248:251]
    v_mfma_f32_16x16x32_bf16 v[252:255], a[248:251], v[172:175], v[252:255]
    v_mfma_f32_16x16x32_bf16 v[224:227], a[252:255], v[172:175], v[224:227]
    s_waitcnt vmcnt(14)
    v_mfma_f32_16x16x32_bf16 a[0:3], a[80:83], v[192:195], a[0:3]
    s_add_u32 s4, s3, 1
    s_and_b32 s4, s4, 3
    s_mul_i32 s4, s4, 15360
    v_add_u32 v8, s4, v3
    s_add_u32 s4, s3, 2
    s_and_b32 s4, s4, 3
    s_mul_i32 s4, s4, 15360
    v_add_u32 v9, s4, v3
    s_waitcnt vmcnt(13)
    v_mfma_f32_16x16x32_bf16 a[4:7], a[84:87], v[192:195], a[4:7]
    s_add_u32 s4, s3, 3
    s_and_b32 s4, s4, 3
    s_mul_i32 s4, s4, 15360
    v_add_u32 v10, s4, v3
    s_add_u32 s4, s3, 4
    s_and_b32 s4, s4, 3
    s_mul_i32 s4, s4, 15360
    v_add_u32 v11, s4, v3
    s_waitcnt vmcnt(12)
    v_mfma_f32_16x16x32_bf16 a[8:11], a[88:91], v[192:195], a[8:11]
    v_lshrrev_b32 v6, 8, v3
    v_bfe_u32 v7, v3, 4, 4
    s_waitcnt vmcnt(11)
    v_mfma_f32_16x16x32_bf16 a[12:15], a[92:95], v[192:195], a[12:15]
    v_mul_u32_u24 v7, 1280, v7
    v_lshl_add_u32 v7, v6, 3, v7
    s_waitcnt vmcnt(10)
    v_mfma_f32_16x16x32_bf16 a[16:19], a[96:99], v[192:195], a[16:19]
    s_waitcnt vmcnt(9)
    v_mfma_f32_16x16x16_bf16 a[0:3], a[100:101], v[196:197], a[0:3]
    s_waitcnt vmcnt(8)
    v_mfma_f32_16x16x16_bf16 a[4:7], a[102:103], v[196:197], a[4:7]
    s_waitcnt vmcnt(7)
    v_mfma_f32_16x16x16_bf16 a[8:11], a[104:105], v[196:197], a[8:11]
    s_waitcnt vmcnt(6)
    v_mfma_f32_16x16x16_bf16 a[12:15], a[106:107], v[196:197], a[12:15]
    s_waitcnt vmcnt(5)
    v_mfma_f32_16x16x16_bf16 a[16:19], a[108:109], v[196:197], a[16:19]
    ds_write_b128 v8, a[0:3] offset:20480
    v_mfma_f32_16x16x32_bf16 a[20:23], a[80:83], v[200:203], a[20:23]
    ds_write_b128 v8, a[4:7] offset:21504
    v_mfma_f32_16x16x32_bf16 a[24:27], a[84:87], v[200:203], a[24:27]
    ds_write_b128 v8, a[8:11] offset:22528
    v_mfma_f32_16x16x32_bf16 a[28:31], a[88:91], v[200:203], a[28:31]
    ds_write_b128 v8, a[12:15] offset:23552
    v_mfma_f32_16x16x32_bf16 a[32:35], a[92:95], v[200:203], a[32:35]
    ds_write_b128 v8, a[16:19] offset:24576
    v_mfma_f32_16x16x32_bf16 a[36:39], a[96:99], v[200:203], a[36:39]
    v_mfma_f32_16x16x16_bf16 a[20:23], a[100:101], v[198:199], a[20:23]
    v_mfma_f32_16x16x16_bf16 a[24:27], a[102:103], v[198:199], a[24:27]
    v_mfma_f32_16x16x16_bf16 a[28:31], a[104:105], v[198:199], a[28:31]
    v_mfma_f32_16x16x16_bf16 a[32:35], a[106:107], v[198:199], a[32:35]
    v_mfma_f32_16x16x16_bf16 a[36:39], a[108:109], v[198:199], a[36:39]
    ds_write_b128 v9, a[20:23] offset:25600
    v_mfma_f32_16x16x32_bf16 a[40:43], a[80:83], v[204:207], a[40:43]
    ds_write_b128 v9, a[24:27] offset:26624
    v_mfma_f32_16x16x32_bf16 a[44:47], a[84:87], v[204:207], a[44:47]
    ds_write_b128 v9, a[28:31] offset:27648
    v_mfma_f32_16x16x32_bf16 a[48:51], a[88:91], v[204:207], a[48:51]
    ds_write_b128 v9, a[32:35] offset:28672
    v_mfma_f32_16x16x32_bf16 a[52:55], a[92:95], v[204:207], a[52:55]
    ds_write_b128 v9, a[36:39] offset:29696
    v_mfma_f32_16x16x32_bf16 v[228:231], a[96:99], v[204:207], v[228:231]
    v_mfma_f32_16x16x16_bf16 a[40:43], a[100:101], v[232:233], a[40:43]
    v_mfma_f32_16x16x16_bf16 a[44:47], a[102:103], v[232:233], a[44:47]
    v_mfma_f32_16x16x16_bf16 a[48:51], a[104:105], v[232:233], a[48:51]
    v_mfma_f32_16x16x16_bf16 a[52:55], a[106:107], v[232:233], a[52:55]
    v_mfma_f32_16x16x16_bf16 v[228:231], a[108:109], v[232:233], v[228:231]
    ds_write_b128 v10, a[40:43] offset:30720
    v_mfma_f32_16x16x32_bf16 v[240:243], a[80:83], v[208:211], v[240:243]
    ds_write_b128 v10, a[44:47] offset:31744
    v_mfma_f32_16x16x32_bf16 v[244:247], a[84:87], v[208:211], v[244:247]
    ds_write_b128 v10, a[48:51] offset:32768
    v_mfma_f32_16x16x32_bf16 v[248:251], a[88:91], v[208:211], v[248:251]
    ds_write_b128 v10, a[52:55] offset:33792
    v_mfma_f32_16x16x32_bf16 v[252:255], a[92:95], v[208:211], v[252:255]
    ds_write_b128 v10, v[228:231] offset:34816
    v_mfma_f32_16x16x32_bf16 v[224:227], a[96:99], v[208:211], v[224:227]
    v_mfma_f32_16x16x16_bf16 v[240:243], a[100:101], v[234:235], v[240:243]
    v_mfma_f32_16x16x16_bf16 v[244:247], a[102:103], v[234:235], v[244:247]
    v_mfma_f32_16x16x16_bf16 v[248:251], a[104:105], v[234:235], v[248:251]
    v_mfma_f32_16x16x16_bf16 v[252:255], a[106:107], v[234:235], v[252:255]
    v_mfma_f32_16x16x16_bf16 v[224:227], a[108:109], v[234:235], v[224:227]
    s_nop 3
    s_waitcnt lgkmcnt(0)
    s_barrier
    ds_read_b128 v[28:31], v11 offset:20480
    ds_read_b128 v[32:35], v11 offset:21504
    ds_read_b128 v[216:219], v11 offset:22528
    ds_read_b128 v[220:223], v11 offset:23552
    ds_read_b128 v[40:43], v11 offset:24576
    ds_read_b128 v[44:47], v11 offset:25600
    ds_read_b128 v[48:51], v11 offset:26624
    ds_read_b128 v[52:55], v11 offset:27648
    ds_read_b128 v[60:63], v11 offset:28672
    ds_read_b128 v[64:67], v11 offset:29696
    ds_read_b128 v[68:71], v11 offset:30720
    ds_read_b128 v[72:75], v11 offset:31744
    ds_read_b128 v[80:83], v11 offset:32768
    ds_read_b128 v[84:87], v11 offset:33792
    ds_read_b128 v[88:91], v11 offset:34816
    s_waitcnt vmcnt(0)
    v_lshlrev_b32 v92, 16, v212
    v_and_b32 v93, s59, v212
    v_lshlrev_b32 v94, 16, v213
    v_and_b32 v95, s59, v213
    v_lshlrev_b32 v96, 16, v214
    v_and_b32 v97, s59, v214
    v_lshlrev_b32 v98, 16, v215
    v_and_b32 v99, s59, v215
    v_lshlrev_b32 v100, 16, v20
    v_and_b32 v101, s59, v20
    v_lshlrev_b32 v102, 16, v21
    v_and_b32 v103, s59, v21
    v_lshlrev_b32 v104, 16, v22
    v_and_b32 v105, s59, v22
    v_lshlrev_b32 v106, 16, v23
    v_and_b32 v107, s59, v23
    v_lshlrev_b32 v108, 16, v24
    v_and_b32 v109, s59, v24
    v_lshlrev_b32 v110, 16, v25
    v_and_b32 v111, s59, v25
    v_pk_add_f32 v[92:93], v[92:93], v[240:241]
    v_pk_add_f32 v[94:95], v[94:95], v[242:243]
    v_pk_add_f32 v[96:97], v[96:97], v[244:245]
    v_pk_add_f32 v[98:99], v[98:99], v[246:247]
    v_pk_add_f32 v[100:101], v[100:101], v[248:249]
    v_pk_add_f32 v[102:103], v[102:103], v[250:251]
    v_pk_add_f32 v[104:105], v[104:105], v[252:253]
    v_pk_add_f32 v[106:107], v[106:107], v[254:255]
    v_pk_add_f32 v[108:109], v[108:109], v[224:225]
    v_pk_add_f32 v[110:111], v[110:111], v[226:227]
    s_waitcnt lgkmcnt(14)
    v_pk_add_f32 v[92:93], v[92:93], v[28:29]
    v_pk_add_f32 v[94:95], v[94:95], v[30:31]
    s_waitcnt lgkmcnt(13)
    v_pk_add_f32 v[96:97], v[96:97], v[32:33]
    v_pk_add_f32 v[98:99], v[98:99], v[34:35]
    s_waitcnt lgkmcnt(12)
    v_pk_add_f32 v[100:101], v[100:101], v[216:217]
    v_pk_add_f32 v[102:103], v[102:103], v[218:219]
    s_waitcnt lgkmcnt(11)
    v_pk_add_f32 v[104:105], v[104:105], v[220:221]
    v_pk_add_f32 v[106:107], v[106:107], v[222:223]
    s_waitcnt lgkmcnt(10)
    v_pk_add_f32 v[108:109], v[108:109], v[40:41]
    v_pk_add_f32 v[110:111], v[110:111], v[42:43]
    s_waitcnt lgkmcnt(9)
    v_pk_add_f32 v[92:93], v[92:93], v[44:45]
    v_pk_add_f32 v[94:95], v[94:95], v[46:47]
    s_waitcnt lgkmcnt(8)
    v_pk_add_f32 v[96:97], v[96:97], v[48:49]
    v_pk_add_f32 v[98:99], v[98:99], v[50:51]
    s_waitcnt lgkmcnt(7)
    v_pk_add_f32 v[100:101], v[100:101], v[52:53]
    v_pk_add_f32 v[102:103], v[102:103], v[54:55]
    s_waitcnt lgkmcnt(6)
    v_pk_add_f32 v[104:105], v[104:105], v[60:61]
    v_pk_add_f32 v[106:107], v[106:107], v[62:63]
    s_waitcnt lgkmcnt(5)
    v_pk_add_f32 v[108:109], v[108:109], v[64:65]
    v_pk_add_f32 v[110:111], v[110:111], v[66:67]
    s_waitcnt lgkmcnt(4)
    v_pk_add_f32 v[92:93], v[92:93], v[68:69]
    v_pk_add_f32 v[94:95], v[94:95], v[70:71]
    v_cvt_pk_bf16_f32 v92, v92, v93
    v_cvt_pk_bf16_f32 v93, v94, v95
    global_store_dwordx2 v7, v[92:93], s[94:95] offset:0
    s_waitcnt lgkmcnt(3)
    v_pk_add_f32 v[96:97], v[96:97], v[72:73]
    v_pk_add_f32 v[98:99], v[98:99], v[74:75]
    v_cvt_pk_bf16_f32 v96, v96, v97
    v_cvt_pk_bf16_f32 v97, v98, v99
    global_store_dwordx2 v7, v[96:97], s[94:95] offset:32
    s_waitcnt lgkmcnt(2)
    v_pk_add_f32 v[100:101], v[100:101], v[80:81]
    v_pk_add_f32 v[102:103], v[102:103], v[82:83]
    v_cvt_pk_bf16_f32 v100, v100, v101
    v_cvt_pk_bf16_f32 v101, v102, v103
    global_store_dwordx2 v7, v[100:101], s[94:95] offset:64
    s_waitcnt lgkmcnt(1)
    v_pk_add_f32 v[104:105], v[104:105], v[84:85]
    v_pk_add_f32 v[106:107], v[106:107], v[86:87]
    v_cvt_pk_bf16_f32 v104, v104, v105
    v_cvt_pk_bf16_f32 v105, v106, v107
    global_store_dwordx2 v7, v[104:105], s[94:95] offset:96
    s_waitcnt lgkmcnt(0)
    v_pk_add_f32 v[108:109], v[108:109], v[88:89]
    v_pk_add_f32 v[110:111], v[110:111], v[90:91]
    v_cvt_pk_bf16_f32 v108, v108, v109
    v_cvt_pk_bf16_f32 v109, v110, v111
    global_store_dwordx2 v7, v[108:109], s[94:95] offset:128
    s_endpgm
.rl1:
    s_mov_b32 s29, 200000
.rl1l:
    global_load_dword v244, v10, s[16:17] sc1
    s_waitcnt vmcnt(0)
    v_cmp_eq_u32 vcc, 0, v244
    s_cbranch_vccz .rl1b
    s_sub_u32 s29, s29, 1
    s_cmp_lg_u32 s29, 0
    s_cbranch_scc1 .rl1l
    s_branch .rl1b
.rl2:
    s_mov_b32 s29, 200000
.rl2l:
    buffer_load_dwordx4 v[160:163], v6, s[20:23], s10 offen sc1
    buffer_load_dwordx4 v[164:167], v249, s[20:23], s10 offen sc1
    buffer_load_dwordx4 v[168:171], v250, s[20:23], s10 offen sc1
    buffer_load_dwordx4 v[172:175], v251, s[20:23], s10 offen sc1
    s_waitcnt vmcnt(0)
    v_max3_u32 v244, v160, v162, v164
    v_max3_u32 v244, v244, v166, v168
    v_max3_u32 v244, v244, v170, v172
    v_max_u32 v244, v244, v174
    v_cmp_eq_u32 vcc, -1, v244
    s_cbranch_vccz .rl2b
    s_sub_u32 s29, s29, 1
    s_cmp_lg_u32 s29, 0
    s_cbranch_scc1 .rl2l
    s_branch .rl2b
.rl3:
    s_mov_b32 s60, 200000
.rl3l:
    buffer_load_dword v188, v189, s[20:23], s13 offen sc1
    buffer_load_dwordx4 v[184:187], v190, s[20:23], s15 offen sc1
    s_waitcnt vmcnt(0)
    v_max3_u32 v184, v184, v185, v186
    v_max3_u32 v184, v184, v187, v188
    v_cmp_eq_u32 vcc, -1, v184
    s_cbranch_vccz .rl3b
    s_sub_u32 s60, s60, 1
    s_cmp_lg_u32 s60, 0
    s_cbranch_scc1 .rl3l
    s_branch .rl3b
.hr4:
    s_mov_b32 s60, 200000
.hr4l:
    buffer_load_dwordx4 v[16:19], v3, s[20:23], s24 offen offset:0 sc1
    buffer_load_dwordx4 v[20:23], v3, s[20:23], s24 offen offset:1024 sc1
    buffer_load_dwordx4 v[24:27], v3, s[20:23], s24 offen offset:2048 sc1
    buffer_load_dwordx4 v[28:31], v3, s[20:23], s24 offen offset:3072 sc1
    buffer_load_dwordx4 v[32:35], v4, s[20:23], s24 offen offset:0 sc1
    buffer_load_dwordx4 v[36:39], v4, s[20:23], s24 offen offset:1024 sc1
    buffer_load_dwordx4 v[40:43], v4, s[20:23], s24 offen offset:2048 sc1
    buffer_load_dwordx4 v[44:47], v4, s[20:23], s24 offen offset:3072 sc1
    buffer_load_dwordx4 v[48:51], v5, s[20:23], s24 offen offset:0 sc1
    buffer_load_dwordx4 v[52:55], v5, s[20:23], s24 offen offset:1024 sc1
    buffer_load_dwordx4 v[56:59], v3, s[20:23], s25 offen offset:0 sc1
    s_waitcnt vmcnt(0)
    v_max_u32 v2, v16, v20
    v_cmp_eq_u32 vcc, -1, v2
    s_cbranch_vccz .hr4b
    s_sub_u32 s60, s60, 1
    s_cmp_lg_u32 s60, 0
    s_cbranch_scc1 .hr4l
    s_branch .hr4b
.hr5:
    s_mov_b32 s60, 200000
.hr5l:
    buffer_load_dwordx4 v[24:27], v3, s[20:23], s24 offen offset:2048 sc1
    buffer_load_dwordx4 v[28:31], v3, s[20:23], s24 offen offset:3072 sc1
    buffer_load_dwordx4 v[32:35], v4, s[20:23], s24 offen offset:0 sc1
    buffer_load_dwordx4 v[36:39], v4, s[20:23], s24 offen offset:1024 sc1
    buffer_load_dwordx4 v[40:43], v4, s[20:23], s24 offen offset:2048 sc1
    buffer_load_dwordx4 v[44:47], v4, s[20:23], s24 offen offset:3072 sc1
    buffer_load_dwordx4 v[48:51], v5, s[20:23], s24 offen offset:0 sc1
    buffer_load_dwordx4 v[52:55], v5, s[20:23], s24 offen offset:1024 sc1
    buffer_load_dwordx4 v[56:59], v3, s[20:23], s25 offen offset:0 sc1
    s_waitcnt vmcnt(0)
    v_max_u32 v2, v24, v28
    v_cmp_eq_u32 vcc, -1, v2
    s_cbranch_vccz .hr5b
    s_sub_u32 s60, s60, 1
    s_cmp_lg_u32 s60, 0
    s_cbranch_scc1 .hr5l
    s_branch .hr5b
.hr6:
    s_mov_b32 s60, 200000
.hr6l:
    buffer_load_dwordx4 v[32:35], v4, s[20:23], s24 offen offset:0 sc1
    buffer_load_dwordx4 v[36:39], v4, s[20:23], s24 offen offset:1024 sc1
    buffer_load_dwordx4 v[40:43], v4, s[20:23], s24 offen offset:2048 sc1
    buffer_load_dwordx4 v[44:47], v4, s[20:23], s24 offen offset:3072 sc1
    buffer_load_dwordx4 v[48:51], v5, s[20:23], s24 offen offset:0 sc1
    buffer_load_dwordx4 v[52:55], v5, s[20:23], s24 offen offset:1024 sc1
    buffer_load_dwordx4 v[56:59], v3, s[20:23], s25 offen offset:0 sc1
    buffer_load_dwordx4 v[60:63], v3, s[20:23], s25 offen offset:1024 sc1
    s_waitcnt vmcnt(0)
    v_max_u32 v2, v32, v36
    v_cmp_eq_u32 vcc, -1, v2
    s_cbranch_vccz .hr6b
    s_sub_u32 s60, s60, 1
    s_cmp_lg_u32 s60, 0
    s_cbranch_scc1 .hr6l
    s_branch .hr6b
.hr7:
    s_mov_b32 s60, 200000
.hr7l:
    buffer_load_dwordx4 v[40:43], v4, s[20:23], s24 offen offset:2048 sc1
    buffer_load_dwordx4 v[44:47], v4, s[20:23], s24 offen offset:3072 sc1
    buffer_load_dwordx4 v[48:51], v5, s[20:23], s24 offen offset:0 sc1
    buffer_load_dwordx4 v[52:55], v5, s[20:23], s24 offen offset:1024 sc1
    buffer_load_dwordx4 v[56:59], v3, s[20:23], s25 offen offset:0 sc1
    buffer_load_dwordx4 v[60:63], v3, s[20:23], s25 offen offset:1024 sc1
    buffer_load_dwordx4 v[64:67], v3, s[20:23], s25 offen offset:2048 sc1
    buffer_load_dwordx4 v[68:71], v3, s[20:23], s25 offen offset:3072 sc1
    s_waitcnt vmcnt(0)
    v_max_u32 v2, v40, v44
    v_cmp_eq_u32 vcc, -1, v2
    s_cbranch_vccz .hr7b
    s_sub_u32 s60, s60, 1
    s_cmp_lg_u32 s60, 0
    s_cbranch_scc1 .hr7l
    s_branch .hr7b
.hr8:
    s_mov_b32 s60, 200000
.hr8l:
    buffer_load_dwordx4 v[48:51], v5, s[20:23], s24 offen offset:0 sc1
    buffer_load_dwordx4 v[52:55], v5, s[20:23], s24 offen offset:1024 sc1
    buffer_load_dwordx4 v[56:59], v3, s[20:23], s25 offen offset:0 sc1
    buffer_load_dwordx4 v[60:63], v3, s[20:23], s25 offen offset:1024 sc1
    buffer_load_dwordx4 v[64:67], v3, s[20:23], s25 offen offset:2048 sc1
    buffer_load_dwordx4 v[68:71], v3, s[20:23], s25 offen offset:3072 sc1
    buffer_load_dwordx4 v[72:75], v4, s[20:23], s25 offen offset:0 sc1
    buffer_load_dwordx4 v[76:79], v4, s[20:23], s25 offen offset:1024 sc1
    buffer_load_dwordx4 v[80:83], v4, s[20:23], s25 offen offset:2048 sc1
    buffer_load_dwordx4 v[84:87], v4, s[20:23], s25 offen offset:3072 sc1
    s_waitcnt vmcnt(0)
    v_max_u32 v2, v48, v52
    v_cmp_eq_u32 vcc, -1, v2
    s_cbranch_vccz .hr8b
    s_sub_u32 s60, s60, 1
    s_cmp_lg_u32 s60, 0
    s_cbranch_scc1 .hr8l
    s_branch .hr8b
.hr9:
    s_mov_b32 s60, 200000
.hr9l:
    buffer_load_dwordx4 v[56:59], v3, s[20:23], s25 offen offset:0 sc1
    buffer_load_dwordx4 v[60:63], v3, s[20:23], s25 offen offset:1024 sc1
    buffer_load_dwordx4 v[64:67], v3, s[20:23], s25 offen offset:2048 sc1
    buffer_load_dwordx4 v[68:71], v3, s[20:23], s25 offen offset:3072 sc1
    buffer_load_dwordx4 v[72:75], v4, s[20:23], s25 offen offset:0 sc1
    buffer_load_dwordx4 v[76:79], v4, s[20:23], s25 offen offset:1024 sc1
    buffer_load_dwordx4 v[80:83], v4, s[20:23], s25 offen offset:2048 sc1
    buffer_load_dwordx4 v[84:87], v4, s[20:23], s25 offen offset:3072 sc1
    buffer_load_dwordx4 v[88:91], v5, s[20:23], s25 offen offset:0 sc1
    buffer_load_dwordx4 v[92:95], v5, s[20:23], s25 offen offset:1024 sc1
    buffer_load_dwordx4 v[96:99], v3, s[20:23], s26 offen offset:0 sc1
    buffer_load_dwordx4 v[100:103], v3, s[20:23], s26 offen offset:1024 sc1
    s_waitcnt vmcnt(0)
    v_max_u32 v2, v56, v60
    v_cmp_eq_u32 vcc, -1, v2
    s_cbranch_vccz .hr9b
    s_sub_u32 s60, s60, 1
    s_cmp_lg_u32 s60, 0
    s_cbranch_scc1 .hr9l
    s_branch .hr9b
.hr10:
    s_mov_b32 s60, 200000
.hr10l:
    buffer_load_dwordx4 v[64:67], v3, s[20:23], s25 offen offset:2048 sc1
    buffer_load_dwordx4 v[68:71], v3, s[20:23], s25 offen offset:3072 sc1
    buffer_load_dwordx4 v[72:75], v4, s[20:23], s25 offen offset:0 sc1
    buffer_load_dwordx4 v[76:79], v4, s[20:23], s25 offen offset:1024 sc1
    buffer_load_dwordx4 v[80:83], v4, s[20:23], s25 offen offset:2048 sc1
    buffer_load_dwordx4 v[84:87], v4, s[20:23], s25 offen offset:3072 sc1
    buffer_load_dwordx4 v[88:91], v5, s[20:23], s25 offen offset:0 sc1
    buffer_load_dwordx4 v[92:95], v5, s[20:23], s25 offen offset:1024 sc1
    buffer_load_dwordx4 v[96:99], v3, s[20:23], s26 offen offset:0 sc1
    buffer_load_dwordx4 v[100:103], v3, s[20:23], s26 offen offset:1024 sc1
    s_waitcnt vmcnt(0)
    v_max_u32 v2, v64, v68
    v_cmp_eq_u32 vcc, -1, v2
    s_cbranch_vccz .hr10b
    s_sub_u32 s60, s60, 1
    s_cmp_lg_u32 s60, 0
    s_cbranch_scc1 .hr10l
    s_branch .hr10b
.hr11:
    s_mov_b32 s60, 200000
.hr11l:
    buffer_load_dwordx4 v[72:75], v4, s[20:23], s25 offen offset:0 sc1
    buffer_load_dwordx4 v[76:79], v4, s[20:23], s25 offen offset:1024 sc1
    buffer_load_dwordx4 v[80:83], v4, s[20:23], s25 offen offset:2048 sc1
    buffer_load_dwordx4 v[84:87], v4, s[20:23], s25 offen offset:3072 sc1
    buffer_load_dwordx4 v[88:91], v5, s[20:23], s25 offen offset:0 sc1
    buffer_load_dwordx4 v[92:95], v5, s[20:23], s25 offen offset:1024 sc1
    buffer_load_dwordx4 v[96:99], v3, s[20:23], s26 offen offset:0 sc1
    buffer_load_dwordx4 v[100:103], v3, s[20:23], s26 offen offset:1024 sc1
    buffer_load_dwordx4 v[104:107], v3, s[20:23], s26 offen offset:2048 sc1
    buffer_load_dwordx4 v[108:111], v3, s[20:23], s26 offen offset:3072 sc1
    s_waitcnt vmcnt(0)
    v_max_u32 v2, v72, v76
    v_cmp_eq_u32 vcc, -1, v2
    s_cbranch_vccz .hr11b
    s_sub_u32 s60, s60, 1
    s_cmp_lg_u32 s60, 0
    s_cbranch_scc1 .hr11l
    s_branch .hr11b
.hr12:
    s_mov_b32 s60, 200000
.hr12l:
    buffer_load_dwordx4 v[80:83], v4, s[20:23], s25 offen offset:2048 sc1
    buffer_load_dwordx4 v[84:87], v4, s[20:23], s25 offen offset:3072 sc1
    buffer_load_dwordx4 v[88:91], v5, s[20:23], s25 offen offset:0 sc1
    buffer_load_dwordx4 v[92:95], v5, s[20:23], s25 offen offset:1024 sc1
    buffer_load_dwordx4 v[96:99], v3, s[20:23], s26 offen offset:0 sc1
    buffer_load_dwordx4 v[100:103], v3, s[20:23], s26 offen offset:1024 sc1
    buffer_load_dwordx4 v[104:107], v3, s[20:23], s26 offen offset:2048 sc1
    buffer_load_dwordx4 v[108:111], v3, s[20:23], s26 offen offset:3072 sc1
    buffer_load_dwordx4 v[112:115], v4, s[20:23], s26 offen offset:0 sc1
    buffer_load_dwordx4 v[116:119], v4, s[20:23], s26 offen offset:1024 sc1
    buffer_load_dwordx4 v[120:123], v4, s[20:23], s26 offen offset:2048 sc1
    s_waitcnt vmcnt(0)
    v_max_u32 v2, v80, v84
    v_cmp_eq_u32 vcc, -1, v2
    s_cbranch_vccz .hr12b
    s_sub_u32 s60, s60, 1
    s_cmp_lg_u32 s60, 0
    s_cbranch_scc1 .hr12l
    s_branch .hr12b
.hr13:
    s_mov_b32 s60, 200000
.hr13l:
    buffer_load_dwordx4 v[88:91], v5, s[20:23], s25 offen offset:0 sc1
    buffer_load_dwordx4 v[92:95], v5, s[20:23], s25 offen offset:1024 sc1
    buffer_load_dwordx4 v[96:99], v3, s[20:23], s26 offen offset:0 sc1
    buffer_load_dwordx4 v[100:103], v3, s[20:23], s26 offen offset:1024 sc1
    buffer_load_dwordx4 v[104:107], v3, s[20:23], s26 offen offset:2048 sc1
    buffer_load_dwordx4 v[108:111], v3, s[20:23], s26 offen offset:3072 sc1
    buffer_load_dwordx4 v[112:115], v4, s[20:23], s26 offen offset:0 sc1
    buffer_load_dwordx4 v[116:119], v4, s[20:23], s26 offen offset:1024 sc1
    buffer_load_dwordx4 v[120:123], v4, s[20:23], s26 offen offset:2048 sc1
    buffer_load_dwordx4 v[124:127], v4, s[20:23], s26 offen offset:3072 sc1
    buffer_load_dwordx4 v[128:131], v5, s[20:23], s26 offen offset:0 sc1
    s_waitcnt vmcnt(0)
    v_max_u32 v2, v88, v92
    v_cmp_eq_u32 vcc, -1, v2
    s_cbranch_vccz .hr13b
    s_sub_u32 s60, s60, 1
    s_cmp_lg_u32 s60, 0
    s_cbranch_scc1 .hr13l
    s_branch .hr13b
.rl14:
    s_mov_b32 s60, 200000
.rl14l:
    buffer_load_dword v239, v238, s[20:23], s56 offen sc1
    s_waitcnt vmcnt(0)
    v_cmp_eq_u32 vcc, -1, v239
    s_cbranch_vccz .rl14b
    s_sub_u32 s60, s60, 1
    s_cmp_lg_u32 s60, 0
    s_cbranch_scc1 .rl14l
    s_branch .rl14b
.hr15:
    s_mov_b32 s60, 200000
.hr15l:
    buffer_load_dwordx4 v[96:99], v3, s[20:23], s26 offen offset:0 sc1
    buffer_load_dwordx4 v[100:103], v3, s[20:23], s26 offen offset:1024 sc1
    buffer_load_dwordx4 v[104:107], v3, s[20:23], s26 offen offset:2048 sc1
    buffer_load_dwordx4 v[108:111], v3, s[20:23], s26 offen offset:3072 sc1
    buffer_load_dwordx4 v[112:115], v4, s[20:23], s26 offen offset:0 sc1
    buffer_load_dwordx4 v[116:119], v4, s[20:23], s26 offen offset:1024 sc1
    buffer_load_dwordx4 v[120:123], v4, s[20:23], s26 offen offset:2048 sc1
    buffer_load_dwordx4 v[124:127], v4, s[20:23], s26 offen offset:3072 sc1
    buffer_load_dwordx4 v[128:131], v5, s[20:23], s26 offen offset:0 sc1
    buffer_load_dwordx4 v[132:135], v5, s[20:23], s26 offen offset:1024 sc1
    buffer_load_dwordx4 v[136:139], v3, s[20:23], s27 offen offset:0 sc1
    buffer_load_dwordx4 v[140:143], v3, s[20:23], s27 offen offset:1024 sc1
    s_waitcnt vmcnt(0)
    v_max_u32 v2, v96, v100
    v_cmp_eq_u32 vcc, -1, v2
    s_cbranch_vccz .hr15b
    s_sub_u32 s60, s60, 1
    s_cmp_lg_u32 s60, 0
    s_cbranch_scc1 .hr15l
    s_branch .hr15b
.hr16:
    s_mov_b32 s60, 200000
.hr16l:
    buffer_load_dwordx4 v[104:107], v3, s[20:23], s26 offen offset:2048 sc1
    buffer_load_dwordx4 v[108:111], v3, s[20:23], s26 offen offset:3072 sc1
    buffer_load_dwordx4 v[112:115], v4, s[20:23], s26 offen offset:0 sc1
    buffer_load_dwordx4 v[116:119], v4, s[20:23], s26 offen offset:1024 sc1
    buffer_load_dwordx4 v[120:123], v4, s[20:23], s26 offen offset:2048 sc1
    buffer_load_dwordx4 v[124:127], v4, s[20:23], s26 offen offset:3072 sc1
    buffer_load_dwordx4 v[128:131], v5, s[20:23], s26 offen offset:0 sc1
    buffer_load_dwordx4 v[132:135], v5, s[20:23], s26 offen offset:1024 sc1
    buffer_load_dwordx4 v[136:139], v3, s[20:23], s27 offen offset:0 sc1
    buffer_load_dwordx4 v[140:143], v3, s[20:23], s27 offen offset:1024 sc1
    s_waitcnt vmcnt(0)
    v_max_u32 v2, v104, v108
    v_cmp_eq_u32 vcc, -1, v2
    s_cbranch_vccz .hr16b
    s_sub_u32 s60, s60, 1
    s_cmp_lg_u32 s60, 0
    s_cbranch_scc1 .hr16l
    s_branch .hr16b
.hr17:
    s_mov_b32 s60, 200000
.hr17l:
    buffer_load_dwordx4 v[112:115], v4, s[20:23], s26 offen offset:0 sc1
    buffer_load_dwordx4 v[116:119], v4, s[20:23], s26 offen offset:1024 sc1
    buffer_load_dwordx4 v[120:123], v4, s[20:23], s26 offen offset:2048 sc1
    buffer_load_dwordx4 v[124:127], v4, s[20:23], s26 offen offset:3072 sc1
    buffer_load_dwordx4 v[128:131], v5, s[20:23], s26 offen offset:0 sc1
    buffer_load_dwordx4 v[132:135], v5, s[20:23], s26 offen offset:1024 sc1
    buffer_load_dwordx4 v[136:139], v3, s[20:23], s27 offen offset:0 sc1
    buffer_load_dwordx4 v[140:143], v3, s[20:23], s27 offen offset:1024 sc1
    s_waitcnt vmcnt(0)
    v_max_u32 v2, v112, v116
    v_cmp_eq_u32 vcc, -1, v2
    s_cbranch_vccz .hr17b
    s_sub_u32 s60, s60, 1
    s_cmp_lg_u32 s60, 0
    s_cbranch_scc1 .hr17l
    s_branch .hr17b
.hr18:
    s_mov_b32 s60, 200000
.hr18l:
    buffer_load_dwordx4 v[120:123], v4, s[20:23], s26 offen offset:2048 sc1
    buffer_load_dwordx4 v[124:127], v4, s[20:23], s26 offen offset:3072 sc1
    buffer_load_dwordx4 v[128:131], v5, s[20:23], s26 offen offset:0 sc1
    buffer_load_dwordx4 v[132:135], v5, s[20:23], s26 offen offset:1024 sc1
    buffer_load_dwordx4 v[136:139], v3, s[20:23], s27 offen offset:0 sc1
    buffer_load_dwordx4 v[140:143], v3, s[20:23], s27 offen offset:1024 sc1
    s_waitcnt vmcnt(0)
    v_max_u32 v2, v120, v124
    v_cmp_eq_u32 vcc, -1, v2
    s_cbranch_vccz .hr18b
    s_sub_u32 s60, s60, 1
    s_cmp_lg_u32 s60, 0
    s_cbranch_scc1 .hr18l
    s_branch .hr18b
.hr19:
    s_mov_b32 s60, 200000
.hr19l:
    buffer_load_dwordx4 v[128:131], v5, s[20:23], s26 offen offset:0 sc1
    buffer_load_dwordx4 v[132:135], v5, s[20:23], s26 offen offset:1024 sc1
    buffer_load_dwordx4 v[136:139], v3, s[20:23], s27 offen offset:0 sc1
    buffer_load_dwordx4 v[140:143], v3, s[20:23], s27 offen offset:1024 sc1
    s_waitcnt vmcnt(0)
    v_max_u32 v2, v128, v132
    v_cmp_eq_u32 vcc, -1, v2
    s_cbranch_vccz .hr19b
    s_sub_u32 s60, s60, 1
    s_cmp_lg_u32 s60, 0
    s_cbranch_scc1 .hr19l
    s_branch .hr19b
.hr20:
    s_mov_b32 s60, 200000
.hr20l:
    buffer_load_dwordx4 v[136:139], v3, s[20:23], s27 offen offset:0 sc1
    buffer_load_dwordx4 v[140:143], v3, s[20:23], s27 offen offset:1024 sc1
    buffer_load_dwordx4 v[144:147], v3, s[20:23], s27 offen offset:2048 sc1
    buffer_load_dwordx4 v[148:151], v3, s[20:23], s27 offen offset:3072 sc1
    s_waitcnt vmcnt(0)
    v_max_u32 v2, v136, v140
    v_cmp_eq_u32 vcc, -1, v2
    s_cbranch_vccz .hr20b
    s_sub_u32 s60, s60, 1
    s_cmp_lg_u32 s60, 0
    s_cbranch_scc1 .hr20l
    s_branch .hr20b
.hr21:
    s_mov_b32 s60, 200000
.hr21l:
    buffer_load_dwordx4 v[144:147], v3, s[20:23], s27 offen offset:2048 sc1
    buffer_load_dwordx4 v[148:151], v3, s[20:23], s27 offen offset:3072 sc1
    buffer_load_dwordx4 v[152:155], v4, s[20:23], s27 offen offset:0 sc1
    buffer_load_dwordx4 v[156:159], v4, s[20:23], s27 offen offset:1024 sc1
    buffer_load_dwordx4 v[160:163], v4, s[20:23], s27 offen offset:2048 sc1
    s_waitcnt vmcnt(0)
    v_max_u32 v2, v144, v148
    v_cmp_eq_u32 vcc, -1, v2
    s_cbranch_vccz .hr21b
    s_sub_u32 s60, s60, 1
    s_cmp_lg_u32 s60, 0
    s_cbranch_scc1 .hr21l
    s_branch .hr21b
.hr22:
    s_mov_b32 s60, 200000
.hr22l:
    buffer_load_dwordx4 v[152:155], v4, s[20:23], s27 offen offset:0 sc1
    buffer_load_dwordx4 v[156:159], v4, s[20:23], s27 offen offset:1024 sc1
    buffer_load_dwordx4 v[160:163], v4, s[20:23], s27 offen offset:2048 sc1
    buffer_load_dwordx4 v[164:167], v4, s[20:23], s27 offen offset:3072 sc1
    buffer_load_dwordx4 v[168:171], v5, s[20:23], s27 offen offset:0 sc1
    buffer_load_dwordx4 v[172:175], v5, s[20:23], s27 offen offset:1024 sc1
    s_waitcnt vmcnt(0)
    v_max_u32 v2, v152, v156
    v_cmp_eq_u32 vcc, -1, v2
    s_cbranch_vccz .hr22b
    s_sub_u32 s60, s60, 1
    s_cmp_lg_u32 s60, 0
    s_cbranch_scc1 .hr22l
    s_branch .hr22b
.hr23:
    s_mov_b32 s60, 200000
.hr23l:
    buffer_load_dwordx4 v[160:163], v4, s[20:23], s27 offen offset:2048 sc1
    buffer_load_dwordx4 v[164:167], v4, s[20:23], s27 offen offset:3072 sc1
    buffer_load_dwordx4 v[168:171], v5, s[20:23], s27 offen offset:0 sc1
    buffer_load_dwordx4 v[172:175], v5, s[20:23], s27 offen offset:1024 sc1
    s_waitcnt vmcnt(0)
    v_max_u32 v2, v160, v164
    v_cmp_eq_u32 vcc, -1, v2
    s_cbranch_vccz .hr23b
    s_sub_u32 s60, s60, 1
    s_cmp_lg_u32 s60, 0
    s_cbranch_scc1 .hr23l
    s_branch .hr23b
.hr24:
    s_mov_b32 s60, 200000
.hr24l:
    buffer_load_dwordx4 v[168:171], v5, s[20:23], s27 offen offset:0 sc1
    buffer_load_dwordx4 v[172:175], v5, s[20:23], s27 offen offset:1024 sc1
    s_waitcnt vmcnt(0)
    v_max_u32 v2, v168, v172
    v_cmp_eq_u32 vcc, -1, v2
    s_cbranch_vccz .hr24b
    s_sub_u32 s60, s60, 1
    s_cmp_lg_u32 s60, 0
    s_cbranch_scc1 .hr24l
    s_branch .hr24b
.rl25:
    s_mov_b32 s60, 200000
.rl25l:
    buffer_load_dword v2, v13, s[20:23], s11 offen offset:0 sc1
    s_waitcnt vmcnt(0)
    v_cmp_eq_u32 vcc, -1, v2
    s_cbranch_vccz .rl25b
    s_sub_u32 s60, s60, 1
    s_cmp_lg_u32 s60, 0
    s_cbranch_scc1 .rl25l
    s_branch .rl25b
.g3r26:
    s_mov_b32 s60, 200000
.g3r26l:
    s_sub_u32 s61, s40, 4096
    buffer_load_dwordx4 a[228:231], v8, s[20:23], s61 offen sc1
    s_sub_u32 s61, s41, 4096
    buffer_load_dwordx4 a[232:235], v8, s[20:23], s61 offen sc1
    s_sub_u32 s61, s42, 4096
    buffer_load_dwordx4 a[236:239], v8, s[20:23], s61 offen sc1
    s_sub_u32 s61, s43, 4096
    buffer_load_dwordx4 a[240:243], v8, s[20:23], s61 offen sc1
    s_waitcnt vmcnt(0)
    v_accvgpr_read_b32 v5, a228
    v_accvgpr_read_b32 v2, a232
    v_max_u32 v5, v5, v2
    v_accvgpr_read_b32 v2, a236
    v_max_u32 v5, v5, v2
    v_accvgpr_read_b32 v2, a240
    v_max_u32 v5, v5, v2
    v_cmp_eq_u32 vcc, -1, v5
    s_cbranch_vccz .g3r26b
    s_sub_u32 s60, s60, 1
    s_cmp_lg_u32 s60, 0
    s_cbranch_scc1 .g3r26l
    s_branch .g3r26b
.g3r27:
    s_mov_b32 s60, 200000
.g3r27l:
    s_sub_u32 s61, s40, 4096
    buffer_load_dwordx4 a[244:247], v9, s[20:23], s61 offen sc1
    s_sub_u32 s61, s41, 4096
    buffer_load_dwordx4 a[248:251], v9, s[20:23], s61 offen sc1
    s_sub_u32 s61, s42, 4096
    buffer_load_dwordx4 a[252:255], v9, s[20:23], s61 offen sc1
    s_sub_u32 s61, s43, 4096
    buffer_load_dwordx4 v[232:235], v9, s[20:23], s61 offen sc1
    s_waitcnt vmcnt(0)
    v_accvgpr_read_b32 v5, a244
    v_accvgpr_read_b32 v2, a248
    v_max3_u32 v5, v5, v2, v232
    v_accvgpr_read_b32 v2, a252
    v_max_u32 v5, v5, v2
    v_cmp_eq_u32 vcc, -1, v5
    s_cbranch_vccz .g3r27b
    s_sub_u32 s60, s60, 1
    s_cmp_lg_u32 s60, 0
    s_cbranch_scc1 .g3r27l
    s_branch .g3r27b
.g3r28:
    s_mov_b32 s60, 200000
.g3r28l:
    s_sub_u32 s61, s40, 8192
    buffer_load_dwordx4 v[20:23], v10, s[20:23], s61 offen sc1
    s_sub_u32 s61, s41, 4096
    buffer_load_dwordx4 v[24:27], v10, s[20:23], s61 offen sc1
    s_sub_u32 s61, s42, 4096
    buffer_load_dwordx4 v[28:31], v10, s[20:23], s61 offen sc1
    s_sub_u32 s61, s43, 4096
    buffer_load_dwordx4 v[32:35], v10, s[20:23], s61 offen sc1
    s_waitcnt vmcnt(0)
    v_max3_u32 v5, v32, v28, v24
    v_max_u32 v5, v5, v20
    v_cmp_eq_u32 vcc, -1, v5
    s_cbranch_vccz .g3r28b
    s_sub_u32 s60, s60, 1
    s_cmp_lg_u32 s60, 0
    s_cbranch_scc1 .g3r28l
    s_branch .g3r28b
.g3r29:
    s_mov_b32 s60, 200000
.g3r29l:
    s_sub_u32 s61, s40, 8192
    buffer_load_dwordx4 v[40:43], v11, s[20:23], s61 offen sc1
    s_sub_u32 s61, s41, 8192
    buffer_load_dwordx4 v[44:47], v11, s[20:23], s61 offen sc1
    s_sub_u32 s61, s42, 8192
    buffer_load_dwordx4 v[48:51], v11, s[20:23], s61 offen sc1
    s_sub_u32 s61, s43, 8192
    buffer_load_dwordx4 v[52:55], v11, s[20:23], s61 offen sc1
    s_waitcnt vmcnt(0)
    v_max3_u32 v5, v52, v48, v44
    v_max_u32 v5, v5, v40
    v_cmp_eq_u32 vcc, -1, v5
    s_cbranch_vccz .g3r29b
    s_sub_u32 s60, s60, 1
    s_cmp_lg_u32 s60, 0
    s_cbranch_scc1 .g3r29l
    s_branch .g3r29b
.g3r30:
    s_mov_b32 s60, 200000
.g3r30l:
    s_sub_u32 s61, s40, 4096
    buffer_load_dwordx4 v[60:63], v8, s[20:23], s61 offen sc1
    s_sub_u32 s61, s41, 4096
    buffer_load_dwordx4 v[64:67], v8, s[20:23], s61 offen sc1
    s_sub_u32 s61, s42, 4096
    buffer_load_dwordx4 v[68:71], v8, s[20:23], s61 offen sc1
    s_sub_u32 s61, s43, 4096
    buffer_load_dwordx4 v[72:75], v8, s[20:23], s61 offen sc1
    s_waitcnt vmcnt(0)
    v_max3_u32 v5, v72, v68, v64
    v_max_u32 v5, v5, v60
    v_cmp_eq_u32 vcc, -1, v5
    s_cbranch_vccz .g3r30b
    s_sub_u32 s60, s60, 1
    s_cmp_lg_u32 s60, 0
    s_cbranch_scc1 .g3r30l
    s_branch .g3r30b
.g3r31:
    s_mov_b32 s60, 200000
.g3r31l:
    s_sub_u32 s61, s40, 4096
    buffer_load_dwordx4 v[80:83], v9, s[20:23], s61 offen sc1
    s_sub_u32 s61, s41, 4096
    buffer_load_dwordx4 v[84:87], v9, s[20:23], s61 offen sc1
    s_sub_u32 s61, s42, 4096
    buffer_load_dwordx4 v[88:91], v9, s[20:23], s61 offen sc1
    s_sub_u32 s61, s43, 4096
    buffer_load_dwordx4 v[92:95], v9, s[20:23], s61 offen sc1
    s_waitcnt vmcnt(0)
    v_max3_u32 v5, v92, v88, v84
    v_max_u32 v5, v5, v80
    v_cmp_eq_u32 vcc, -1, v5
    s_cbranch_vccz .g3r31b
    s_sub_u32 s60, s60, 1
    s_cmp_lg_u32 s60, 0
    s_cbranch_scc1 .g3r31l
    s_branch .g3r31b
.g3r32:
    s_mov_b32 s60, 200000
.g3r32l:
    s_sub_u32 s61, s40, 8192
    buffer_load_dwordx4 v[96:99], v10, s[20:23], s61 offen sc1
    s_sub_u32 s61, s41, 4096
    buffer_load_dwordx4 v[100:103], v10, s[20:23], s61 offen sc1
    s_sub_u32 s61, s42, 4096
    buffer_load_dwordx4 v[104:107], v10, s[20:23], s61 offen sc1
    s_sub_u32 s61, s43, 4096
    buffer_load_dwordx4 v[108:111], v10, s[20:23], s61 offen sc1
    s_waitcnt vmcnt(0)
    v_max3_u32 v5, v108, v104, v100
    v_max_u32 v5, v5, v96
    v_cmp_eq_u32 vcc, -1, v5
    s_cbranch_vccz .g3r32b
    s_sub_u32 s60, s60, 1
    s_cmp_lg_u32 s60, 0
    s_cbranch_scc1 .g3r32l
    s_branch .g3r32b
.g3r33:
    s_mov_b32 s60, 200000
.g3r33l:
    s_sub_u32 s61, s40, 8192
    buffer_load_dwordx4 v[112:115], v11, s[20:23], s61 offen sc1
    s_sub_u32 s61, s41, 8192
    buffer_load_dwordx4 v[176:179], v11, s[20:23], s61 offen sc1
    s_sub_u32 s61, s42, 8192
    buffer_load_dwordx4 v[180:183], v11, s[20:23], s61 offen sc1
    s_sub_u32 s61, s43, 8192
    buffer_load_dwordx4 v[184:187], v11, s[20:23], s61 offen sc1
    s_waitcnt vmcnt(0)
    v_max3_u32 v5, v184, v180, v176
    v_max_u32 v5, v5, v112
    v_cmp_eq_u32 vcc, -1, v5
    s_cbranch_vccz .g3r33b
    s_sub_u32 s60, s60, 1
    s_cmp_lg_u32 s60, 0
    s_cbranch_scc1 .g3r33l
    s_branch .g3r33b
.g3r34:
    s_mov_b32 s60, 200000
.g3r34l:
    s_sub_u32 s61, s40, 4096
    buffer_load_dwordx4 v[188:191], v8, s[20:23], s61 offen sc1
    s_sub_u32 s61, s41, 4096
    buffer_load_dwordx4 v[116:119], v8, s[20:23], s61 offen sc1
    s_sub_u32 s61, s42, 4096
    buffer_load_dwordx4 v[120:123], v8, s[20:23], s61 offen sc1
    s_sub_u32 s61, s43, 4096
    buffer_load_dwordx4 v[124:127], v8, s[20:23], s61 offen sc1
    s_waitcnt vmcnt(0)
    v_max3_u32 v5, v124, v120, v116
    v_max_u32 v5, v5, v188
    v_cmp_eq_u32 vcc, -1, v5
    s_cbranch_vccz .g3r34b
    s_sub_u32 s60, s60, 1
    s_cmp_lg_u32 s60, 0
    s_cbranch_scc1 .g3r34l
    s_branch .g3r34b
.g3r35:
    s_mov_b32 s60, 200000
.g3r35l:
    s_sub_u32 s61, s40, 4096
    buffer_load_dwordx4 v[128:131], v9, s[20:23], s61 offen sc1
    s_sub_u32 s61, s41, 4096
    buffer_load_dwordx4 v[132:135], v9, s[20:23], s61 offen sc1
    s_sub_u32 s61, s42, 4096
    buffer_load_dwordx4 v[136:139], v9, s[20:23], s61 offen sc1
    s_sub_u32 s61, s43, 4096
    buffer_load_dwordx4 v[140:143], v9, s[20:23], s61 offen sc1
    s_waitcnt vmcnt(0)
    v_max3_u32 v5, v140, v136, v132
    v_max_u32 v5, v5, v128
    v_cmp_eq_u32 vcc, -1, v5
    s_cbranch_vccz .g3r35b
    s_sub_u32 s60, s60, 1
    s_cmp_lg_u32 s60, 0
    s_cbranch_scc1 .g3r35l
    s_branch .g3r35b
.g3r36:
    s_mov_b32 s60, 200000
.g3r36l:
    s_sub_u32 s61, s40, 4096
    buffer_load_dwordx4 v[144:147], v10, s[20:23], s61 offen sc1
    s_sub_u32 s61, s41, 4096
    buffer_load_dwordx4 v[148:151], v10, s[20:23], s61 offen sc1
    s_sub_u32 s61, s42, 4096
    buffer_load_dwordx4 v[152:155], v10, s[20:23], s61 offen sc1
    s_sub_u32 s61, s43, 4096
    buffer_load_dwordx4 v[156:159], v10, s[20:23], s61 offen sc1
    s_waitcnt vmcnt(0)
    v_max3_u32 v5, v156, v152, v148
    v_max_u32 v5, v5, v144
    v_cmp_eq_u32 vcc, -1, v5
    s_cbranch_vccz .g3r36b
    s_sub_u32 s60, s60, 1
    s_cmp_lg_u32 s60, 0
    s_cbranch_scc1 .g3r36l
    s_branch .g3r36b
.g3r37:
    s_mov_b32 s60, 200000
.g3r37l:
    s_sub_u32 s61, s40, 4096
    buffer_load_dwordx4 v[160:163], v11, s[20:23], s61 offen sc1
    s_sub_u32 s61, s41, 4096
    buffer_load_dwordx4 v[164:167], v11, s[20:23], s61 offen sc1
    s_sub_u32 s61, s42, 4096
    buffer_load_dwordx4 v[168:171], v11, s[20:23], s61 offen sc1
    s_sub_u32 s61, s43, 4096
    buffer_load_dwordx4 v[172:175], v11, s[20:23], s61 offen sc1
    s_waitcnt vmcnt(0)
    v_max3_u32 v5, v172, v168, v164
    v_max_u32 v5, v5, v160
    v_cmp_eq_u32 vcc, -1, v5
    s_cbranch_vccz .g3r37b
    s_sub_u32 s60, s60, 1
    s_cmp_lg_u32 s60, 0
    s_cbranch_scc1 .g3r37l
    s_branch .g3r37b
.g3r38:
    s_mov_b32 s60, 200000
.g3r38l:
    buffer_load_dwordx2 v[192:193], v12, s[20:23], s40 offen offset:0 sc1
    buffer_load_dwordx2 v[194:195], v12, s[20:23], s40 offen offset:512 sc1
    buffer_load_dwordx2 v[196:197], v12, s[20:23], s40 offen offset:1024 sc1
    buffer_load_dwordx2 v[200:201], v12, s[20:23], s41 offen offset:0 sc1
    buffer_load_dwordx2 v[202:203], v12, s[20:23], s41 offen offset:512 sc1
    buffer_load_dwordx2 v[198:199], v12, s[20:23], s41 offen offset:1024 sc1
    buffer_load_dwordx2 v[204:205], v12, s[20:23], s42 offen offset:0 sc1
    buffer_load_dwordx2 v[206:207], v12, s[20:23], s42 offen offset:512 sc1
    buffer_load_dwordx2 v[232:233], v12, s[20:23], s42 offen offset:1024 sc1
    buffer_load_dwordx2 v[208:209], v12, s[20:23], s43 offen offset:0 sc1
    buffer_load_dwordx2 v[210:211], v12, s[20:23], s43 offen offset:512 sc1
    buffer_load_dwordx2 v[234:235], v12, s[20:23], s43 offen offset:1024 sc1
    s_waitcnt vmcnt(0)
    v_max3_u32 v5, v234, v210, v208
    v_max3_u32 v5, v5, v232, v206
    v_max3_u32 v5, v5, v204, v198
    v_max3_u32 v5, v5, v202, v200
    v_max3_u32 v5, v5, v196, v194
    v_max_u32 v5, v5, v192
    v_cmp_eq_u32 vcc, -1, v5
    s_cbranch_vccz .g3r38b
    s_sub_u32 s60, s60, 1
    s_cmp_lg_u32 s60, 0
    s_cbranch_scc1 .g3r38l
    s_branch .g3r38b
.Lfz_h:
    s_cmp_ge_u32 s2, 256
    s_cbranch_scc1 .Lfz_end
    s_load_dwordx4 s[4:7], s[0:1], 8
    s_load_dwordx4 s[8:11], s[0:1], 56
    s_load_dwordx2 s[12:13], s[0:1], 72
    s_load_dwordx2 s[14:15], s[0:1], 0
    s_load_dwordx4 s[16:19], s[0:1], 88
    s_load_dwordx2 s[94:95], s[0:1], 80
    v_lshrrev_b32 v1, 6, v0
    v_and_b32 v2, 63, v0
    v_readfirstlane_b32 s3, v1
    s_mov_b32 s23, 0x00020000
    s_mov_b32 s27, 0x00020000
    s_mov_b32 s39, 0x00020000
    s_mov_b32 s38, 0x10000000
    s_sub_u32 s33, s2, 192
    s_cbranch_scc1 .hln40
    s_lshr_b32 s28, s33, 3
    s_lshl_b32 s28, s28, 2
    s_add_u32 s28, s28, s3
    s_mul_i32 s28, s28, 20480
    s_and_b32 s29, s2, 7
    s_mul_i32 s29, s29, 160
    s_add_u32 s28, s29, s28
    v_lshrrev_b32 v3, 1, v2
    v_and_b32 v4, 1, v2
    v_mul_u32_u24 v4, 156, v4
    v_mul_u32_u24 v3, 1280, v3
    v_add3_u32 v3, v3, v4, s28
    v_add_u32 v4, 655360, v3
    s_mov_b32 exec_hi, 0
    s_waitcnt lgkmcnt(0)
    global_load_dword v200, v3, s[4:5]
    global_load_dword v201, v3, s[6:7]
    s_mov_b32 exec_hi, -1
.hnp44:
    s_sub_u32 s33, s2, 202
    s_cbranch_scc1 .hln40
    s_waitcnt lgkmcnt(0)
    s_mov_b32 s36, s18
    s_mov_b32 s37, s19
    s_cmp_ge_u32 s3, 2
    s_cbranch_scc1 .hb042
    s_mul_i32 s34, s3, 40960
    s_lshl_b32 s32, s33, 1
    s_add_u32 s32, s32, s3
    s_lshr_b32 s30, s32, 2
    s_and_b32 s31, s32, 3
    s_mov_b32 s20, s8
    s_mov_b32 s21, s9
    s_mov_b32 s22, 2211840
    s_mov_b32 s24, s10
    s_mov_b32 s25, s11
    s_mov_b32 s26, 2211840
    s_mul_i32 s28, s31, 552960
    s_lshl_b32 s29, s30, 7
    s_add_u32 s28, s28, s29
    v_lshrrev_b32 v6, 3, v2
    v_lshrrev_b32 v7, 4, v2
    v_xor_b32 v7, v7, v2
    v_and_b32 v7, 7, v7
    v_mul_u32_u24 v6, 3456, v6
    v_xor_b32 v12, 0, v7
    v_lshl_add_u32 v8, v12, 4, v6
    v_xor_b32 v12, 4, v7
    v_lshl_add_u32 v9, v12, 4, v6
    s_add_u32 m0, s34, 0
    s_nop 0
    buffer_load_dwordx4 v8, s[20:23], s28 offen lds
    s_add_u32 m0, s34, 20480
    s_nop 0
    buffer_load_dwordx4 v9, s[24:27], s28 offen lds
    s_add_u32 s28, s28, 27648
    s_add_u32 m0, s34, 1024
    s_nop 0
    buffer_load_dwordx4 v8, s[20:23], s28 offen lds
    s_add_u32 m0, s34, 21504
    s_nop 0
    buffer_load_dwordx4 v9, s[24:27], s28 offen lds
    s_add_u32 s28, s28, 27648
    s_add_u32 m0, s34, 2048
    s_nop 0
    buffer_load_dwordx4 v8, s[20:23], s28 offen lds
    s_lshl_b32 s4, s30, 3
    v_add_u32 v40, s4, v2
    v_mul_u32_u24 v41, 1214, v40
    v_lshrrev_b32 v41, 16, v41
    s_add_u32 m0, s34, 22528
    s_nop 0
    buffer_load_dwordx4 v9, s[24:27], s28 offen lds
    v_mul_u32_u24 v42, 54, v41
    v_sub_u32 v40, v40, v42
    v_and_b32 v42, 1, v41
    v_lshlrev_b32 v42, 1, v42
    s_add_u32 s28, s28, 27648
    s_add_u32 m0, s34, 3072
    s_nop 0
    buffer_load_dwordx4 v8, s[20:23], s28 offen lds
    v_sub_u32 v40, v40, v42
    v_add_u32 v42, 54, v40
    v_min_u32 v40, v40, v42
    v_lshrrev_b32 v42, 4, v40
    s_add_u32 m0, s34, 23552
    s_nop 0
    buffer_load_dwordx4 v9, s[24:27], s28 offen lds
    v_lshlrev_b32 v42, 2, v42
    v_bfe_u32 v43, v40, 2, 2
    v_and_b32 v44, 3, v40
    v_subrev_u32 v45, 48, v40
    s_add_u32 s28, s28, 27648
    s_add_u32 m0, s34, 4096
    s_nop 0
    buffer_load_dwordx4 v8, s[20:23], s28 offen lds
    v_lshrrev_b32 v46, 3, v45
    v_lshl_add_u32 v46, v46, 1, 12
    v_bfe_u32 v47, v45, 1, 2
    v_and_b32 v45, 1, v45
    s_add_u32 m0, s34, 24576
    s_nop 0
    buffer_load_dwordx4 v9, s[24:27], s28 offen lds
    v_cmp_gt_u32 vcc, 48, v40
    v_cndmask_b32 v42, v46, v42, vcc
    v_cndmask_b32 v43, v47, v43, vcc
    v_cndmask_b32 v44, v45, v44, vcc
    s_add_u32 s28, s28, 27648
    s_add_u32 m0, s34, 5120
    s_nop 0
    buffer_load_dwordx4 v8, s[20:23], s28 offen lds
    v_cndmask_b32_e64 v45, 2, 4, vcc
    v_lshl_add_u32 v41, v41, 2, v43
    v_mul_u32_u24 v40, 280, v41
    v_mad_u32_u24 v40, v42, 20, v40
    s_add_u32 m0, s34, 25600
    s_nop 0
    buffer_load_dwordx4 v9, s[24:27], s28 offen lds
    v_add_u32 v40, v40, v44
    s_mul_i32 s5, s31, 5
    v_mad_u32_u24 v40, v45, s5, v40
    v_lshlrev_b32 v40, 10, v40
    s_add_u32 s28, s28, 27648
    s_add_u32 m0, s34, 6144
    s_nop 0
    buffer_load_dwordx4 v8, s[20:23], s28 offen lds
    v_add_u32 v40, 25165824, v40
    v_lshlrev_b32 v45, 10, v45
    v_add_u32 v42, v42, v44
    v_lshrrev_b32 v43, 2, v42
    s_add_u32 m0, s34, 26624
    s_nop 0
    buffer_load_dwordx4 v9, s[24:27], s28 offen lds
    v_lshl_add_u32 v41, v41, 2, v43
    v_lshl_add_u32 v41, v41, 2, s31
    v_and_b32 v42, 3, v42
    v_lshl_add_u32 v41, v41, 6, v42
    s_add_u32 s28, s28, 27648
    s_add_u32 m0, s34, 7168
    s_nop 0
    buffer_load_dwordx4 v8, s[20:23], s28 offen lds
    v_lshlrev_b32 v41, 2, v41
    v_add_u32 v41, 18874368, v41
    s_nop 0
    v_readlane_b32 s40, v40, 0
    s_add_u32 m0, s34, 27648
    s_nop 0
    buffer_load_dwordx4 v9, s[24:27], s28 offen lds
    v_readlane_b32 s48, v45, 0
    v_readlane_b32 s56, v41, 0
    v_readlane_b32 s41, v40, 1
    v_readlane_b32 s49, v45, 1
    s_add_u32 s28, s28, 27648
    s_add_u32 m0, s34, 8192
    s_nop 0
    buffer_load_dwordx4 v8, s[20:23], s28 offen lds
    v_readlane_b32 s57, v41, 1
    v_readlane_b32 s42, v40, 2
    v_readlane_b32 s50, v45, 2
    v_readlane_b32 s58, v41, 2
    s_add_u32 m0, s34, 28672
    s_nop 0
    buffer_load_dwordx4 v9, s[24:27], s28 offen lds
    v_readlane_b32 s43, v40, 3
    v_readlane_b32 s51, v45, 3
    v_readlane_b32 s59, v41, 3
    v_readlane_b32 s44, v40, 4
    s_add_u32 s28, s28, 27648
    s_add_u32 m0, s34, 9216
    s_nop 0
    buffer_load_dwordx4 v8, s[20:23], s28 offen lds
    v_readlane_b32 s52, v45, 4
    v_readlane_b32 s60, v41, 4
    v_readlane_b32 s45, v40, 5
    v_readlane_b32 s53, v45, 5
    s_add_u32 m0, s34, 29696
    s_nop 0
    buffer_load_dwordx4 v9, s[24:27], s28 offen lds
    v_readlane_b32 s61, v41, 5
    v_readlane_b32 s46, v40, 6
    v_readlane_b32 s54, v45, 6
    v_readlane_b32 s62, v41, 6
    s_add_u32 s28, s28, 27648
    s_add_u32 m0, s34, 10240
    s_nop 0
    buffer_load_dwordx4 v8, s[20:23], s28 offen lds
    v_readlane_b32 s47, v40, 7
    v_readlane_b32 s55, v45, 7
    v_readlane_b32 s63, v41, 7
    s_add_u32 m0, s34, 30720
    s_nop 0
    buffer_load_dwordx4 v9, s[24:27], s28 offen lds
    s_add_u32 s28, s28, 27648
    s_add_u32 m0, s34, 11264
    s_nop 0
    buffer_load_dwordx4 v8, s[20:23], s28 offen lds
    s_add_u32 m0, s34, 31744
    s_nop 0
    buffer_load_dwordx4 v9, s[24:27], s28 offen lds
    s_add_u32 s28, s28, 27648
    v_lshrrev_b32 v6, 2, v2
    v_lshlrev_b32 v6, 7, v6
    v_bfe_u32 v7, v2, 1, 1
    v_mul_u32_u24 v12, 20544, v7
    v_add_u32 v6, v6, v12
    v_and_b32 v12, 1, v2
    v_lshl_add_u32 v6, v12, 3, v6
    v_bfe_u32 v12, v2, 3, 2
    v_lshl_add_u32 v6, v12, 4, v6
    v_add_u32 v6, s34, v6
    v_bfe_u32 v7, v2, 1, 2
    v_lshlrev_b32 v7, 2, v7
    v_bfe_u32 v12, v2, 3, 1
    v_lshl_add_u32 v7, v12, 1, v7
    v_and_b32 v12, 49, v2
    v_add_u32 v7, v7, v12
    v_lshlrev_b32 v7, 4, v7
    v_xor_b32 v24, 0, v6
    v_xor_b32 v25, 16, v6
    v_xor_b32 v26, 32, v6
    v_xor_b32 v27, 48, v6
    v_xor_b32 v28, 64, v6
    v_xor_b32 v29, 80, v6
    v_xor_b32 v30, 96, v6
    v_xor_b32 v31, 112, v6
    v_mov_b32 v16, 0x3f803f80
    v_mov_b32 v17, 0x3f803f80
    v_mov_b32 v18, 0x3f803f80
    v_mov_b32 v19, 0x3f803f80
    s_waitcnt vmcnt(16)
    ds_read_b64_tr_b16 v[32:33], v24 offset:0
    ds_read_b64_tr_b16 v[34:35], v24 offset:2048
    ds_read_b64_tr_b16 v[36:37], v25 offset:0
    ds_read_b64_tr_b16 v[38:39], v25 offset:2048
    ds_read_b64_tr_b16 v[40:41], v26 offset:0
    ds_read_b64_tr_b16 v[42:43], v26 offset:2048
    ds_read_b64_tr_b16 v[44:45], v27 offset:0
    ds_read_b64_tr_b16 v[46:47], v27 offset:2048
    ds_read_b64_tr_b16 v[48:49], v28 offset:0
    ds_read_b64_tr_b16 v[50:51], v28 offset:2048
    ds_read_b64_tr_b16 v[52:53], v29 offset:0
    ds_read_b64_tr_b16 v[54:55], v29 offset:2048
    ds_read_b64_tr_b16 v[56:57], v30 offset:0
    ds_read_b64_tr_b16 v[58:59], v30 offset:2048
    ds_read_b64_tr_b16 v[60:61], v31 offset:0
    ds_read_b64_tr_b16 v[62:63], v31 offset:2048
    s_waitcnt lgkmcnt(14)
    buffer_store_dwordx4 v[32:35], v7, s[36:39], s40 offen sc1
    s_add_u32 s40, s40, s48
    v_mfma_f32_16x16x32_bf16 v[96:99], v[16:19], v[32:35], 0
    s_waitcnt lgkmcnt(12)
    buffer_store_dwordx4 v[36:39], v7, s[36:39], s41 offen sc1
    s_add_u32 s41, s41, s49
    v_mfma_f32_16x16x32_bf16 v[100:103], v[16:19], v[36:39], 0
    s_waitcnt lgkmcnt(10)
    buffer_store_dwordx4 v[40:43], v7, s[36:39], s42 offen sc1
    s_add_u32 s42, s42, s50
    v_mfma_f32_16x16x32_bf16 v[104:107], v[16:19], v[40:43], 0
    s_waitcnt lgkmcnt(8)
    buffer_store_dwordx4 v[44:47], v7, s[36:39], s43 offen sc1
    s_add_u32 s43, s43, s51
    v_mfma_f32_16x16x32_bf16 v[108:111], v[16:19], v[44:47], 0
    s_waitcnt lgkmcnt(6)
    buffer_store_dwordx4 v[48:51], v7, s[36:39], s44 offen sc1
    s_add_u32 s44, s44, s52
    v_mfma_f32_16x16x32_bf16 v[112:115], v[16:19], v[48:51], 0
    s_waitcnt lgkmcnt(4)
    buffer_store_dwordx4 v[52:55], v7, s[36:39], s45 offen sc1
    s_add_u32 s45, s45, s53
    v_mfma_f32_16x16x32_bf16 v[116:119], v[16:19], v[52:55], 0
    s_waitcnt lgkmcnt(2)
    buffer_store_dwordx4 v[56:59], v7, s[36:39], s46 offen sc1
    s_add_u32 s46, s46, s54
    v_mfma_f32_16x16x32_bf16 v[120:123], v[16:19], v[56:59], 0
    s_waitcnt lgkmcnt(0)
    buffer_store_dwordx4 v[60:63], v7, s[36:39], s47 offen sc1
    s_add_u32 s47, s47, s55
    v_mfma_f32_16x16x32_bf16 v[124:127], v[16:19], v[60:63], 0
    s_add_u32 m0, s34, 12288
    s_nop 0
    buffer_load_dwordx4 v8, s[20:23], s28 offen lds
    s_add_u32 m0, s34, 32768
    s_nop 0
    buffer_load_dwordx4 v9, s[24:27], s28 offen lds
    s_add_u32 s28, s28, 27648
    s_add_u32 m0, s34, 13312
    s_nop 0
    buffer_load_dwordx4 v8, s[20:23], s28 offen lds
    s_add_u32 m0, s34, 33792
    s_nop 0
    buffer_load_dwordx4 v9, s[24:27], s28 offen lds
    s_add_u32 s28, s28, 27648
    s_add_u32 m0, s34, 14336
    s_nop 0
    buffer_load_dwordx4 v8, s[20:23], s28 offen lds
    s_add_u32 m0, s34, 34816
    s_nop 0
    buffer_load_dwordx4 v9, s[24:27], s28 offen lds
    s_add_u32 s28, s28, 27648
    s_add_u32 m0, s34, 15360
    s_nop 0
    buffer_load_dwordx4 v8, s[20:23], s28 offen lds
    s_add_u32 m0, s34, 35840
    s_nop 0
    buffer_load_dwordx4 v9, s[24:27], s28 offen lds
    s_add_u32 s28, s28, 27648
    s_waitcnt vmcnt(24)
    ds_read_b64_tr_b16 v[64:65], v24 offset:4096
    ds_read_b64_tr_b16 v[66:67], v24 offset:6144
    ds_read_b64_tr_b16 v[68:69], v25 offset:4096
    ds_read_b64_tr_b16 v[70:71], v25 offset:6144
    ds_read_b64_tr_b16 v[72:73], v26 offset:4096
    ds_read_b64_tr_b16 v[74:75], v26 offset:6144
    ds_read_b64_tr_b16 v[76:77], v27 offset:4096
    ds_read_b64_tr_b16 v[78:79], v27 offset:6144
    ds_read_b64_tr_b16 v[80:81], v28 offset:4096
    ds_read_b64_tr_b16 v[82:83], v28 offset:6144
    ds_read_b64_tr_b16 v[84:85], v29 offset:4096
    ds_read_b64_tr_b16 v[86:87], v29 offset:6144
    ds_read_b64_tr_b16 v[88:89], v30 offset:4096
    ds_read_b64_tr_b16 v[90:91], v30 offset:6144
    ds_read_b64_tr_b16 v[92:93], v31 offset:4096
    ds_read_b64_tr_b16 v[94:95], v31 offset:6144
    s_waitcnt lgkmcnt(14)
    buffer_store_dwordx4 v[64:67], v7, s[36:39], s40 offen sc1
    s_add_u32 s40, s40, s48
    v_mfma_f32_16x16x32_bf16 v[96:99], v[16:19], v[64:67], v[96:99]
    s_waitcnt lgkmcnt(12)
    buffer_store_dwordx4 v[68:71], v7, s[36:39], s41 offen sc1
    s_add_u32 s41, s41, s49
    v_mfma_f32_16x16x32_bf16 v[100:103], v[16:19], v[68:71], v[100:103]
    s_waitcnt lgkmcnt(10)
    buffer_store_dwordx4 v[72:75], v7, s[36:39], s42 offen sc1
    s_add_u32 s42, s42, s50
    v_mfma_f32_16x16x32_bf16 v[104:107], v[16:19], v[72:75], v[104:107]
    s_waitcnt lgkmcnt(8)
    buffer_store_dwordx4 v[76:79], v7, s[36:39], s43 offen sc1
    s_add_u32 s43, s43, s51
    v_mfma_f32_16x16x32_bf16 v[108:111], v[16:19], v[76:79], v[108:111]
    s_waitcnt lgkmcnt(6)
    buffer_store_dwordx4 v[80:83], v7, s[36:39], s44 offen sc1
    s_add_u32 s44, s44, s52
    v_mfma_f32_16x16x32_bf16 v[112:115], v[16:19], v[80:83], v[112:115]
    s_waitcnt lgkmcnt(4)
    buffer_store_dwordx4 v[84:87], v7, s[36:39], s45 offen sc1
    s_add_u32 s45, s45, s53
    v_mfma_f32_16x16x32_bf16 v[116:119], v[16:19], v[84:87], v[116:119]
    s_waitcnt lgkmcnt(2)
    buffer_store_dwordx4 v[88:91], v7, s[36:39], s46 offen sc1
    s_add_u32 s46, s46, s54
    v_mfma_f32_16x16x32_bf16 v[120:123], v[16:19], v[88:91], v[120:123]
    s_waitcnt lgkmcnt(0)
    buffer_store_dwordx4 v[92:95], v7, s[36:39], s47 offen sc1
    s_add_u32 s47, s47, s55
    v_mfma_f32_16x16x32_bf16 v[124:127], v[16:19], v[92:95], v[124:127]
    s_add_u32 m0, s34, 16384
    s_nop 0
    buffer_load_dwordx4 v8, s[20:23], s28 offen lds
    s_add_u32 m0, s34, 36864
    s_nop 0
    buffer_load_dwordx4 v9, s[24:27], s28 offen lds
    s_add_u32 s28, s28, 27648
    s_add_u32 m0, s34, 17408
    s_nop 0
    buffer_load_dwordx4 v8, s[20:23], s28 offen lds
    s_add_u32 m0, s34, 37888
    s_nop 0
    buffer_load_dwordx4 v9, s[24:27], s28 offen lds
    s_add_u32 s28, s28, 27648
    s_add_u32 m0, s34, 18432
    s_nop 0
    buffer_load_dwordx4 v8, s[20:23], s28 offen lds
    s_add_u32 m0, s34, 38912
    s_nop 0
    buffer_load_dwordx4 v9, s[24:27], s28 offen lds
    s_add_u32 s28, s28, 27648
    s_add_u32 m0, s34, 19456
    s_nop 0
    buffer_load_dwordx4 v8, s[20:23], s28 offen lds
    s_add_u32 m0, s34, 39936
    s_nop 0
    buffer_load_dwordx4 v9, s[24:27], s28 offen lds
    s_waitcnt vmcnt(32)
    ds_read_b64_tr_b16 v[32:33], v24 offset:8192
    ds_read_b64_tr_b16 v[34:35], v24 offset:10240
    ds_read_b64_tr_b16 v[36:37], v25 offset:8192
    ds_read_b64_tr_b16 v[38:39], v25 offset:10240
    ds_read_b64_tr_b16 v[40:41], v26 offset:8192
    ds_read_b64_tr_b16 v[42:43], v26 offset:10240
    ds_read_b64_tr_b16 v[44:45], v27 offset:8192
    ds_read_b64_tr_b16 v[46:47], v27 offset:10240
    ds_read_b64_tr_b16 v[48:49], v28 offset:8192
    ds_read_b64_tr_b16 v[50:51], v28 offset:10240
    ds_read_b64_tr_b16 v[52:53], v29 offset:8192
    ds_read_b64_tr_b16 v[54:55], v29 offset:10240
    ds_read_b64_tr_b16 v[56:57], v30 offset:8192
    ds_read_b64_tr_b16 v[58:59], v30 offset:10240
    ds_read_b64_tr_b16 v[60:61], v31 offset:8192
    ds_read_b64_tr_b16 v[62:63], v31 offset:10240
    s_waitcnt lgkmcnt(14)
    buffer_store_dwordx4 v[32:35], v7, s[36:39], s40 offen sc1
    s_add_u32 s40, s40, s48
    v_mfma_f32_16x16x32_bf16 v[96:99], v[16:19], v[32:35], v[96:99]
    s_waitcnt lgkmcnt(12)
    buffer_store_dwordx4 v[36:39], v7, s[36:39], s41 offen sc1
    s_add_u32 s41, s41, s49
    v_mfma_f32_16x16x32_bf16 v[100:103], v[16:19], v[36:39], v[100:103]
    s_waitcnt lgkmcnt(10)
    buffer_store_dwordx4 v[40:43], v7, s[36:39], s42 offen sc1
    s_add_u32 s42, s42, s50
    v_mfma_f32_16x16x32_bf16 v[104:107], v[16:19], v[40:43], v[104:107]
    s_waitcnt lgkmcnt(8)
    buffer_store_dwordx4 v[44:47], v7, s[36:39], s43 offen sc1
    s_add_u32 s43, s43, s51
    v_mfma_f32_16x16x32_bf16 v[108:111], v[16:19], v[44:47], v[108:111]
    s_waitcnt lgkmcnt(6)
    buffer_store_dwordx4 v[48:51], v7, s[36:39], s44 offen sc1
    s_add_u32 s44, s44, s52
    v_mfma_f32_16x16x32_bf16 v[112:115], v[16:19], v[48:51], v[112:115]
    s_waitcnt lgkmcnt(4)
    buffer_store_dwordx4 v[52:55], v7, s[36:39], s45 offen sc1
    s_add_u32 s45, s45, s53
    v_mfma_f32_16x16x32_bf16 v[116:119], v[16:19], v[52:55], v[116:119]
    s_waitcnt lgkmcnt(2)
    buffer_store_dwordx4 v[56:59], v7, s[36:39], s46 offen sc1
    s_add_u32 s46, s46, s54
    v_mfma_f32_16x16x32_bf16 v[120:123], v[16:19], v[56:59], v[120:123]
    s_waitcnt lgkmcnt(0)
    buffer_store_dwordx4 v[60:63], v7, s[36:39], s47 offen sc1
    s_add_u32 s47, s47, s55
    v_mfma_f32_16x16x32_bf16 v[124:127], v[16:19], v[60:63], v[124:127]
    s_waitcnt vmcnt(24)
    ds_read_b64_tr_b16 v[64:65], v24 offset:12288
    ds_read_b64_tr_b16 v[66:67], v24 offset:14336
    ds_read_b64_tr_b16 v[68:69], v25 offset:12288
    ds_read_b64_tr_b16 v[70:71], v25 offset:14336
    ds_read_b64_tr_b16 v[72:73], v26 offset:12288
    ds_read_b64_tr_b16 v[74:75], v26 offset:14336
    ds_read_b64_tr_b16 v[76:77], v27 offset:12288
    ds_read_b64_tr_b16 v[78:79], v27 offset:14336
    ds_read_b64_tr_b16 v[80:81], v28 offset:12288
    ds_read_b64_tr_b16 v[82:83], v28 offset:14336
    ds_read_b64_tr_b16 v[84:85], v29 offset:12288
    ds_read_b64_tr_b16 v[86:87], v29 offset:14336
    ds_read_b64_tr_b16 v[88:89], v30 offset:12288
    ds_read_b64_tr_b16 v[90:91], v30 offset:14336
    ds_read_b64_tr_b16 v[92:93], v31 offset:12288
    ds_read_b64_tr_b16 v[94:95], v31 offset:14336
    s_waitcnt lgkmcnt(14)
    buffer_store_dwordx4 v[64:67], v7, s[36:39], s40 offen sc1
    s_add_u32 s40, s40, s48
    v_mfma_f32_16x16x32_bf16 v[96:99], v[16:19], v[64:67], v[96:99]
    s_waitcnt lgkmcnt(12)
    buffer_store_dwordx4 v[68:71], v7, s[36:39], s41 offen sc1
    s_add_u32 s41, s41, s49
    v_mfma_f32_16x16x32_bf16 v[100:103], v[16:19], v[68:71], v[100:103]
    s_waitcnt lgkmcnt(10)
    buffer_store_dwordx4 v[72:75], v7, s[36:39], s42 offen sc1
    s_add_u32 s42, s42, s50
    v_mfma_f32_16x16x32_bf16 v[104:107], v[16:19], v[72:75], v[104:107]
    s_waitcnt lgkmcnt(8)
    buffer_store_dwordx4 v[76:79], v7, s[36:39], s43 offen sc1
    s_add_u32 s43, s43, s51
    v_mfma_f32_16x16x32_bf16 v[108:111], v[16:19], v[76:79], v[108:111]
    s_waitcnt lgkmcnt(6)
    buffer_store_dwordx4 v[80:83], v7, s[36:39], s44 offen sc1
    s_add_u32 s44, s44, s52
    v_mfma_f32_16x16x32_bf16 v[112:115], v[16:19], v[80:83], v[112:115]
    s_waitcnt lgkmcnt(4)
    buffer_store_dwordx4 v[84:87], v7, s[36:39], s45 offen sc1
    s_add_u32 s45, s45, s53
    v_mfma_f32_16x16x32_bf16 v[116:119], v[16:19], v[84:87], v[116:119]
    s_waitcnt lgkmcnt(2)
    buffer_store_dwordx4 v[88:91], v7, s[36:39], s46 offen sc1
    s_add_u32 s46, s46, s54
    v_mfma_f32_16x16x32_bf16 v[120:123], v[16:19], v[88:91], v[120:123]
    s_waitcnt lgkmcnt(0)
    buffer_store_dwordx4 v[92:95], v7, s[36:39], s47 offen sc1
    s_add_u32 s47, s47, s55
    v_mfma_f32_16x16x32_bf16 v[124:127], v[16:19], v[92:95], v[124:127]
    s_waitcnt vmcnt(16)
    ds_read_b64_tr_b16 v[32:33], v24 offset:16384
    ds_read_b64_tr_b16 v[34:35], v24 offset:18432
    ds_read_b64_tr_b16 v[36:37], v25 offset:16384
    ds_read_b64_tr_b16 v[38:39], v25 offset:18432
    ds_read_b64_tr_b16 v[40:41], v26 offset:16384
    ds_read_b64_tr_b16 v[42:43], v26 offset:18432
    ds_read_b64_tr_b16 v[44:45], v27 offset:16384
    ds_read_b64_tr_b16 v[46:47], v27 offset:18432
    ds_read_b64_tr_b16 v[48:49], v28 offset:16384
    ds_read_b64_tr_b16 v[50:51], v28 offset:18432
    ds_read_b64_tr_b16 v[52:53], v29 offset:16384
    ds_read_b64_tr_b16 v[54:55], v29 offset:18432
    ds_read_b64_tr_b16 v[56:57], v30 offset:16384
    ds_read_b64_tr_b16 v[58:59], v30 offset:18432
    ds_read_b64_tr_b16 v[60:61], v31 offset:16384
    ds_read_b64_tr_b16 v[62:63], v31 offset:18432
    s_waitcnt lgkmcnt(14)
    buffer_store_dwordx4 v[32:35], v7, s[36:39], s40 offen sc1
    v_mfma_f32_16x16x32_bf16 v[96:99], v[16:19], v[32:35], v[96:99]
    s_waitcnt lgkmcnt(12)
    buffer_store_dwordx4 v[36:39], v7, s[36:39], s41 offen sc1
    v_mfma_f32_16x16x32_bf16 v[100:103], v[16:19], v[36:39], v[100:103]
    s_waitcnt lgkmcnt(10)
    buffer_store_dwordx4 v[40:43], v7, s[36:39], s42 offen sc1
    v_mfma_f32_16x16x32_bf16 v[104:107], v[16:19], v[40:43], v[104:107]
    s_waitcnt lgkmcnt(8)
    buffer_store_dwordx4 v[44:47], v7, s[36:39], s43 offen sc1
    v_mfma_f32_16x16x32_bf16 v[108:111], v[16:19], v[44:47], v[108:111]
    s_waitcnt lgkmcnt(6)
    buffer_store_dwordx4 v[48:51], v7, s[36:39], s44 offen sc1
    v_mfma_f32_16x16x32_bf16 v[112:115], v[16:19], v[48:51], v[112:115]
    s_waitcnt lgkmcnt(4)
    buffer_store_dwordx4 v[52:55], v7, s[36:39], s45 offen sc1
    v_mfma_f32_16x16x32_bf16 v[116:119], v[16:19], v[52:55], v[116:119]
    s_waitcnt lgkmcnt(2)
    buffer_store_dwordx4 v[56:59], v7, s[36:39], s46 offen sc1
    v_mfma_f32_16x16x32_bf16 v[120:123], v[16:19], v[56:59], v[120:123]
    s_waitcnt lgkmcnt(0)
    buffer_store_dwordx4 v[60:63], v7, s[36:39], s47 offen sc1
    v_mfma_f32_16x16x32_bf16 v[124:127], v[16:19], v[60:63], v[124:127]
    s_mov_b64 exec, 0xffff
    s_nop 7
    v_cvt_pk_bf16_f32 v97, v96, v96
    v_lshlrev_b32 v97, 16, v97
    v_sub_f32 v97, v96, v97
    v_cvt_pk_bf16_f32 v97, v96, v97
    buffer_store_dword v97, v7, s[36:39], s56 offen sc1
    v_cvt_pk_bf16_f32 v101, v100, v100
    v_lshlrev_b32 v101, 16, v101
    v_sub_f32 v101, v100, v101
    v_cvt_pk_bf16_f32 v101, v100, v101
    buffer_store_dword v101, v7, s[36:39], s57 offen sc1
    v_cvt_pk_bf16_f32 v105, v104, v104
    v_lshlrev_b32 v105, 16, v105
    v_sub_f32 v105, v104, v105
    v_cvt_pk_bf16_f32 v105, v104, v105
    buffer_store_dword v105, v7, s[36:39], s58 offen sc1
    v_cvt_pk_bf16_f32 v109, v108, v108
    v_lshlrev_b32 v109, 16, v109
    v_sub_f32 v109, v108, v109
    v_cvt_pk_bf16_f32 v109, v108, v109
    buffer_store_dword v109, v7, s[36:39], s59 offen sc1
    v_cvt_pk_bf16_f32 v113, v112, v112
    v_lshlrev_b32 v113, 16, v113
    v_sub_f32 v113, v112, v113
    v_cvt_pk_bf16_f32 v113, v112, v113
    buffer_store_dword v113, v7, s[36:39], s60 offen sc1
    v_cvt_pk_bf16_f32 v117, v116, v116
    v_lshlrev_b32 v117, 16, v117
    v_sub_f32 v117, v116, v117
    v_cvt_pk_bf16_f32 v117, v116, v117
    buffer_store_dword v117, v7, s[36:39], s61 offen sc1
    v_cvt_pk_bf16_f32 v121, v120, v120
    v_lshlrev_b32 v121, 16, v121
    v_sub_f32 v121, v120, v121
    v_cvt_pk_bf16_f32 v121, v120, v121
    buffer_store_dword v121, v7, s[36:39], s62 offen sc1
    v_cvt_pk_bf16_f32 v125, v124, v124
    v_lshlrev_b32 v125, 16, v125
    v_sub_f32 v125, v124, v125
    v_cvt_pk_bf16_f32 v125, v124, v125
    buffer_store_dword v125, v7, s[36:39], s63 offen sc1
    s_mov_b64 exec, -1
    v_and_b32 v208, 7, v2
    v_lshlrev_b32 v208, 2, v208
    global_load_dword v209, v208, s[16:17]
    s_waitcnt vmcnt(0)
    v_cmp_eq_u32 vcc, 0, v209
    s_cbranch_vccnz .rl45
.rl45b:
    s_lshl_b32 s28, s32, 7
    s_add_u32 s28, s28, 11034624
    s_mov_b64 exec, 1
    buffer_store_dword v2, off, s[36:39], s28 sc1
    s_mov_b64 exec, -1
    s_barrier
    s_branch .hdn43
.hb042:
    s_barrier
.hb042n:
    s_mul_i32 s34, s3, 20480
    s_sub_u32 s33, s2, 202
    s_cbranch_scc0 .hdn43
    s_lshl_b32 s32, s33, 1
    s_add_u32 s32, s32, s3
    s_add_u32 s32, s32, 82
    s_add_u32 s30, s33, 108
    s_cmp_eq_u32 s3, 1
    s_cselect_b32 s32, s30, s32
    s_cselect_b32 s30, 84, 0
    s_cmp_eq_u32 s3, 0
    s_cbranch_scc1 .hdn43
    s_cmp_lt_u32 s32, s30
    s_cbranch_scc1 .hdn43
.hw239:
    s_mov_b32 s20, s12
    s_mov_b32 s21, s13
    s_mov_b32 s22, 2211840
    s_lshr_b32 s30, s32, 1
    s_and_b32 s31, s32, 1
    s_mul_i32 s28, s30, 40960
    s_mul_i32 s29, s31, 640
    s_add_u32 s28, s28, s29
    v_add_u32 v3, 0, v2
    v_mul_u32_u24 v6, 1639, v3
    v_lshrrev_b32 v6, 16, v6
    v_mad_u32_u24 v3, v6, 40, v3
    v_and_b32 v6, 2, v6
    v_xor_b32 v3, v3, v6
    v_lshlrev_b32 v16, 4, v3
    s_add_u32 m0, s34, 0
    v_xor_b32 v21, 64, v16
    buffer_load_dwordx4 v16, s[20:23], s28 offen lds
    v_add_u32 v3, 64, v2
    v_mul_u32_u24 v6, 1639, v3
    v_lshrrev_b32 v6, 16, v6
    v_mad_u32_u24 v3, v6, 40, v3
    v_and_b32 v6, 2, v6
    v_xor_b32 v3, v3, v6
    v_lshlrev_b32 v17, 4, v3
    s_add_u32 m0, s34, 1024
    v_xor_b32 v22, 64, v17
    buffer_load_dwordx4 v17, s[20:23], s28 offen lds
    v_add_u32 v3, 128, v2
    v_mul_u32_u24 v6, 1639, v3
    v_lshrrev_b32 v6, 16, v6
    v_mad_u32_u24 v3, v6, 40, v3
    v_and_b32 v6, 2, v6
    v_xor_b32 v3, v3, v6
    v_lshlrev_b32 v18, 4, v3
    s_add_u32 m0, s34, 2048
    v_xor_b32 v23, 64, v18
    buffer_load_dwordx4 v18, s[20:23], s28 offen lds
    v_add_u32 v3, 192, v2
    v_mul_u32_u24 v6, 1639, v3
    v_lshrrev_b32 v6, 16, v6
    v_mad_u32_u24 v3, v6, 40, v3
    v_and_b32 v6, 2, v6
    v_xor_b32 v3, v3, v6
    v_lshlrev_b32 v19, 4, v3
    s_add_u32 m0, s34, 3072
    v_xor_b32 v24, 64, v19
    buffer_load_dwordx4 v19, s[20:23], s28 offen lds
    v_add_u32 v3, 256, v2
    v_mul_u32_u24 v6, 1639, v3
    v_lshrrev_b32 v6, 16, v6
    v_mad_u32_u24 v3, v6, 40, v3
    v_and_b32 v6, 2, v6
    v_xor_b32 v3, v3, v6
    v_lshlrev_b32 v20, 4, v3
    s_add_u32 m0, s34, 4096
    v_xor_b32 v25, 64, v20
    buffer_load_dwordx4 v20, s[20:23], s28 offen lds
    s_add_u32 s28, s28, 10240
    s_add_u32 m0, s34, 5120
    s_nop 0
    buffer_load_dwordx4 v21, s[20:23], s28 offen lds
    s_add_u32 m0, s34, 6144
    s_nop 0
    buffer_load_dwordx4 v22, s[20:23], s28 offen lds
    s_add_u32 m0, s34, 7168
    s_nop 0
    buffer_load_dwordx4 v23, s[20:23], s28 offen lds
    s_add_u32 m0, s34, 8192
    s_nop 0
    buffer_load_dwordx4 v24, s[20:23], s28 offen lds
    s_add_u32 m0, s34, 9216
    s_nop 0
    buffer_load_dwordx4 v25, s[20:23], s28 offen lds
    s_add_u32 s28, s28, 10240
    s_add_u32 m0, s34, 10240
    s_nop 0
    buffer_load_dwordx4 v16, s[20:23], s28 offen lds
    s_add_u32 m0, s34, 11264
    s_nop 0
    buffer_load_dwordx4 v17, s[20:23], s28 offen lds
    s_add_u32 m0, s34, 12288
    s_nop 0
    buffer_load_dwordx4 v18, s[20:23], s28 offen lds
    s_add_u32 m0, s34, 13312
    s_nop 0
    buffer_load_dwordx4 v19, s[20:23], s28 offen lds
    s_add_u32 m0, s34, 14336
    s_nop 0
    buffer_load_dwordx4 v20, s[20:23], s28 offen lds
    s_add_u32 s28, s28, 10240
    s_add_u32 m0, s34, 15360
    s_nop 0
    buffer_load_dwordx4 v21, s[20:23], s28 offen lds
    s_add_u32 m0, s34, 16384
    s_nop 0
    buffer_load_dwordx4 v22, s[20:23], s28 offen lds
    s_add_u32 m0, s34, 17408
    s_nop 0
    buffer_load_dwordx4 v23, s[20:23], s28 offen lds
    s_add_u32 m0, s34, 18432
    s_nop 0
    buffer_load_dwordx4 v24, s[20:23], s28 offen lds
    s_add_u32 m0, s34, 19456
    s_nop 0
    buffer_load_dwordx4 v25, s[20:23], s28 offen lds
    v_lshrrev_b32 v3, 4, v2
    v_bfe_u32 v6, v2, 3, 1
    v_bfe_u32 v7, v2, 2, 1
    v_lshl_add_u32 v7, v3, 1, v7
    v_and_b32 v8, 1, v3
    v_lshl_add_u32 v8, v6, 1, v8
    v_lshl_add_u32 v7, v6, 3, v7
    v_mul_u32_u24 v7, 640, v7
    v_lshl_add_u32 v7, v8, 5, v7
    v_and_b32 v8, 3, v2
    v_lshl_add_u32 v7, v8, 3, v7
    v_add_u32 v7, s34, v7
    v_lshlrev_b32 v14, 4, v2
    v_add_u32 v15, 4096, v14
    s_mul_i32 s29, s31, 216
    s_add_u32 s29, s29, s30
    s_mul_i32 s29, s29, 5120
    s_add_u32 s29, s29, 30408704
    v_xor_b32 v32, 0, v7
    v_xor_b32 v33, 32, v7
    v_xor_b32 v34, 64, v7
    v_xor_b32 v35, 96, v7
    s_waitcnt vmcnt(0)
    ds_read_b64_tr_b16 v[48:49], v32 offset:0
    ds_read_b64_tr_b16 v[50:51], v32 offset:10240
    ds_read_b64_tr_b16 v[52:53], v33 offset:0
    ds_read_b64_tr_b16 v[54:55], v33 offset:10240
    ds_read_b64_tr_b16 v[56:57], v34 offset:0
    ds_read_b64_tr_b16 v[58:59], v34 offset:10240
    ds_read_b64_tr_b16 v[60:61], v35 offset:0
    ds_read_b64_tr_b16 v[62:63], v35 offset:10240
    ds_read_b64_tr_b16 v[64:65], v32 offset:128
    ds_read_b64_tr_b16 v[66:67], v32 offset:10368
    s_waitcnt lgkmcnt(0)
    ds_read_b64_tr_b16 v[68:69], v33 offset:128
    ds_read_b64_tr_b16 v[70:71], v33 offset:10368
    ds_read_b64_tr_b16 v[72:73], v34 offset:128
    ds_read_b64_tr_b16 v[74:75], v34 offset:10368
    ds_read_b64_tr_b16 v[76:77], v35 offset:128
    ds_read_b64_tr_b16 v[78:79], v35 offset:10368
    ds_read_b64_tr_b16 v[80:81], v32 offset:256
    ds_read_b64_tr_b16 v[82:83], v32 offset:10496
    ds_read_b64_tr_b16 v[84:85], v33 offset:256
    ds_read_b64_tr_b16 v[86:87], v33 offset:10496
    buffer_store_dwordx4 v[48:51], v14, s[36:39], s29 offen offset:0 sc1
    buffer_store_dwordx4 v[52:55], v14, s[36:39], s29 offen offset:1024 sc1
    buffer_store_dwordx4 v[56:59], v14, s[36:39], s29 offen offset:2048 sc1
    buffer_store_dwordx4 v[60:63], v14, s[36:39], s29 offen offset:3072 sc1
    buffer_store_dwordx4 v[64:67], v15, s[36:39], s29 offen offset:0 sc1
    s_add_u32 s29, s29, 276480
    s_waitcnt lgkmcnt(0)
    ds_read_b64_tr_b16 v[88:89], v34 offset:256
    ds_read_b64_tr_b16 v[90:91], v34 offset:10496
    ds_read_b64_tr_b16 v[92:93], v35 offset:256
    ds_read_b64_tr_b16 v[94:95], v35 offset:10496
    ds_read_b64_tr_b16 v[96:97], v32 offset:384
    ds_read_b64_tr_b16 v[98:99], v32 offset:10624
    ds_read_b64_tr_b16 v[100:101], v33 offset:384
    ds_read_b64_tr_b16 v[102:103], v33 offset:10624
    ds_read_b64_tr_b16 v[104:105], v34 offset:384
    ds_read_b64_tr_b16 v[106:107], v34 offset:10624
    buffer_store_dwordx4 v[68:71], v14, s[36:39], s29 offen offset:0 sc1
    buffer_store_dwordx4 v[72:75], v14, s[36:39], s29 offen offset:1024 sc1
    buffer_store_dwordx4 v[76:79], v14, s[36:39], s29 offen offset:2048 sc1
    buffer_store_dwordx4 v[80:83], v14, s[36:39], s29 offen offset:3072 sc1
    buffer_store_dwordx4 v[84:87], v15, s[36:39], s29 offen offset:0 sc1
    s_add_u32 s29, s29, 276480
    s_waitcnt lgkmcnt(0)
    ds_read_b64_tr_b16 v[108:109], v35 offset:384
    ds_read_b64_tr_b16 v[110:111], v35 offset:10624
    ds_read_b64_tr_b16 v[112:113], v32 offset:512
    ds_read_b64_tr_b16 v[114:115], v32 offset:10752
    ds_read_b64_tr_b16 v[116:117], v33 offset:512
    ds_read_b64_tr_b16 v[118:119], v33 offset:10752
    ds_read_b64_tr_b16 v[120:121], v34 offset:512
    ds_read_b64_tr_b16 v[122:123], v34 offset:10752
    ds_read_b64_tr_b16 v[124:125], v35 offset:512
    ds_read_b64_tr_b16 v[126:127], v35 offset:10752
    buffer_store_dwordx4 v[88:91], v14, s[36:39], s29 offen offset:0 sc1
    buffer_store_dwordx4 v[92:95], v14, s[36:39], s29 offen offset:1024 sc1
    buffer_store_dwordx4 v[96:99], v14, s[36:39], s29 offen offset:2048 sc1
    buffer_store_dwordx4 v[100:103], v14, s[36:39], s29 offen offset:3072 sc1
    buffer_store_dwordx4 v[104:107], v15, s[36:39], s29 offen offset:0 sc1
    s_add_u32 s29, s29, 276480
    s_waitcnt lgkmcnt(0)
    buffer_store_dwordx4 v[108:111], v14, s[36:39], s29 offen offset:0 sc1
    buffer_store_dwordx4 v[112:115], v14, s[36:39], s29 offen offset:1024 sc1
    buffer_store_dwordx4 v[116:119], v14, s[36:39], s29 offen offset:2048 sc1
    buffer_store_dwordx4 v[120:123], v14, s[36:39], s29 offen offset:3072 sc1
    buffer_store_dwordx4 v[124:127], v15, s[36:39], s29 offen offset:0 sc1
    v_and_b32 v208, 7, v2
    v_lshlrev_b32 v208, 2, v208
    global_load_dword v209, v208, s[16:17]
    s_waitcnt vmcnt(0)
    v_cmp_eq_u32 vcc, 0, v209
    s_cbranch_vccnz .rl46
.rl46b:
    s_lshl_b32 s28, s32, 7
    s_add_u32 s28, s28, 11048448
    s_mov_b64 exec, 1
    buffer_store_dword v2, off, s[36:39], s28 sc1
    s_mov_b64 exec, -1
    s_branch .hdn43
.hln40:
    s_sub_u32 s32, s2, 160
    s_mul_i32 s30, s32, 3
    s_add_u32 s30, s30, s3
    s_add_u32 s28, s32, 126
    s_cmp_eq_u32 s3, 3
    s_cselect_b32 s30, s28, s30
    s_cmp_ge_u32 s30, 128
    s_cbranch_scc1 .hfl41
    v_and_b32 v6, 7, v2
    v_lshrrev_b32 v5, 3, v2
    v_mul_u32_u24 v7, 1280, v5
    v_lshl_add_u32 v7, v6, 4, v7
    s_lshr_b32 s28, s30, 1
    s_lshl_b32 s28, s28, 2
    s_and_b32 s29, s30, 1
    s_add_u32 s28, s28, s29
    s_mul_i32 s28, s28, 10240
    v_add_u32 v7, s28, v7
    v_add_u32 v8, 20480, v7
    s_waitcnt lgkmcnt(0)
    global_load_dwordx4 v[16:19], v7, s[14:15] offset:0
    global_load_dwordx4 v[20:23], v8, s[14:15] offset:0
    global_load_dwordx4 v[24:27], v7, s[14:15] offset:128
    global_load_dwordx4 v[28:31], v8, s[14:15] offset:128
    global_load_dwordx4 v[32:35], v7, s[14:15] offset:256
    global_load_dwordx4 v[36:39], v8, s[14:15] offset:256
    global_load_dwordx4 v[40:43], v7, s[14:15] offset:384
    global_load_dwordx4 v[44:47], v8, s[14:15] offset:384
    global_load_dwordx4 v[48:51], v7, s[14:15] offset:512
    global_load_dwordx4 v[52:55], v8, s[14:15] offset:512
    global_load_dwordx4 v[56:59], v7, s[14:15] offset:640
    global_load_dwordx4 v[60:63], v8, s[14:15] offset:640
    global_load_dwordx4 v[64:67], v7, s[14:15] offset:768
    global_load_dwordx4 v[68:71], v8, s[14:15] offset:768
    global_load_dwordx4 v[72:75], v7, s[14:15] offset:896
    global_load_dwordx4 v[76:79], v8, s[14:15] offset:896
    global_load_dwordx4 v[80:83], v7, s[14:15] offset:1024
    global_load_dwordx4 v[84:87], v8, s[14:15] offset:1024
    global_load_dwordx4 v[88:91], v7, s[14:15] offset:1152
    global_load_dwordx4 v[92:95], v8, s[14:15] offset:1152
    s_mov_b32 s36, s18
    s_mov_b32 s37, s19
    v_lshlrev_b32 v11, 4, v5
    v_lshl_add_u32 v10, v6, 9, v11
    v_lshl_add_u32 v11, v6, 3, v11
    s_lshr_b32 s28, s30, 1
    s_mul_i32 s28, s28, 40960
    s_lshl_b32 s29, s29, 7
    s_add_u32 s29, s29, s28
    s_add_u32 s29, s29, 11534336
    s_mov_b32 s4, 0xaaaaaaaa
    s_mov_b32 s5, s4
    s_mov_b32 s6, 0x03030303
    s_mov_b32 s7, s6
    s_lshl_b32 s31, s30, 7
    s_add_u32 s31, s31, 11018240
    s_mov_b32 s35, 0x3f803f80
    s_mov_b32 s26, 0xffff0000
    s_mov_b32 s28, 0x3acccccd
    s_waitcnt vmcnt(19)
    v_dot2_f32_bf16 v12, v16, s35, 0
    v_dot2_f32_bf16 v13, v16, v16, 0
    v_dot2_f32_bf16 v12, v17, s35, v12
    v_dot2_f32_bf16 v13, v17, v17, v13
    v_dot2_f32_bf16 v12, v18, s35, v12
    v_dot2_f32_bf16 v13, v18, v18, v13
    v_dot2_f32_bf16 v12, v19, s35, v12
    v_dot2_f32_bf16 v13, v19, v19, v13
    s_waitcnt vmcnt(18)
    v_dot2_f32_bf16 v14, v20, s35, 0
    v_dot2_f32_bf16 v15, v20, v20, 0
    v_dot2_f32_bf16 v14, v21, s35, v14
    v_dot2_f32_bf16 v15, v21, v21, v15
    v_dot2_f32_bf16 v14, v22, s35, v14
    v_dot2_f32_bf16 v15, v22, v22, v15
    v_dot2_f32_bf16 v14, v23, s35, v14
    v_dot2_f32_bf16 v15, v23, v23, v15
    v_swap_b32 v18, v20
    v_swap_b32 v19, v21
    buffer_store_dwordx4 v[16:19], v10, s[36:39], s29 offen offset:0 sc1
    buffer_store_dwordx4 v[20:23], v10, s[36:39], s29 offen offset:256 sc1
    s_add_u32 s29, s29, 4096
    s_waitcnt vmcnt(19)
    v_dot2_f32_bf16 v12, v24, s35, v12
    v_dot2_f32_bf16 v13, v24, v24, v13
    v_dot2_f32_bf16 v12, v25, s35, v12
    v_dot2_f32_bf16 v13, v25, v25, v13
    v_dot2_f32_bf16 v12, v26, s35, v12
    v_dot2_f32_bf16 v13, v26, v26, v13
    v_dot2_f32_bf16 v12, v27, s35, v12
    v_dot2_f32_bf16 v13, v27, v27, v13
    s_waitcnt vmcnt(18)
    v_dot2_f32_bf16 v14, v28, s35, v14
    v_dot2_f32_bf16 v15, v28, v28, v15
    v_dot2_f32_bf16 v14, v29, s35, v14
    v_dot2_f32_bf16 v15, v29, v29, v15
    v_dot2_f32_bf16 v14, v30, s35, v14
    v_dot2_f32_bf16 v15, v30, v30, v15
    v_dot2_f32_bf16 v14, v31, s35, v14
    v_dot2_f32_bf16 v15, v31, v31, v15
    v_swap_b32 v26, v28
    v_swap_b32 v27, v29
    buffer_store_dwordx4 v[24:27], v10, s[36:39], s29 offen offset:0 sc1
    buffer_store_dwordx4 v[28:31], v10, s[36:39], s29 offen offset:256 sc1
    s_add_u32 s29, s29, 4096
    s_waitcnt vmcnt(19)
    v_dot2_f32_bf16 v12, v32, s35, v12
    v_dot2_f32_bf16 v13, v32, v32, v13
    v_dot2_f32_bf16 v12, v33, s35, v12
    v_dot2_f32_bf16 v13, v33, v33, v13
    v_dot2_f32_bf16 v12, v34, s35, v12
    v_dot2_f32_bf16 v13, v34, v34, v13
    v_dot2_f32_bf16 v12, v35, s35, v12
    v_dot2_f32_bf16 v13, v35, v35, v13
    s_waitcnt vmcnt(18)
    v_dot2_f32_bf16 v14, v36, s35, v14
    v_dot2_f32_bf16 v15, v36, v36, v15
    v_dot2_f32_bf16 v14, v37, s35, v14
    v_dot2_f32_bf16 v15, v37, v37, v15
    v_dot2_f32_bf16 v14, v38, s35, v14
    v_dot2_f32_bf16 v15, v38, v38, v15
    v_dot2_f32_bf16 v14, v39, s35, v14
    v_dot2_f32_bf16 v15, v39, v39, v15
    v_swap_b32 v34, v36
    v_swap_b32 v35, v37
    buffer_store_dwordx4 v[32:35], v10, s[36:39], s29 offen offset:0 sc1
    buffer_store_dwordx4 v[36:39], v10, s[36:39], s29 offen offset:256 sc1
    s_add_u32 s29, s29, 4096
    s_waitcnt vmcnt(19)
    v_dot2_f32_bf16 v12, v40, s35, v12
    v_dot2_f32_bf16 v13, v40, v40, v13
    v_dot2_f32_bf16 v12, v41, s35, v12
    v_dot2_f32_bf16 v13, v41, v41, v13
    v_dot2_f32_bf16 v12, v42, s35, v12
    v_dot2_f32_bf16 v13, v42, v42, v13
    v_dot2_f32_bf16 v12, v43, s35, v12
    v_dot2_f32_bf16 v13, v43, v43, v13
    s_waitcnt vmcnt(18)
    v_dot2_f32_bf16 v14, v44, s35, v14
    v_dot2_f32_bf16 v15, v44, v44, v15
    v_dot2_f32_bf16 v14, v45, s35, v14
    v_dot2_f32_bf16 v15, v45, v45, v15
    v_dot2_f32_bf16 v14, v46, s35, v14
    v_dot2_f32_bf16 v15, v46, v46, v15
    v_dot2_f32_bf16 v14, v47, s35, v14
    v_dot2_f32_bf16 v15, v47, v47, v15
    v_swap_b32 v42, v44
    v_swap_b32 v43, v45
    buffer_store_dwordx4 v[40:43], v10, s[36:39], s29 offen offset:0 sc1
    buffer_store_dwordx4 v[44:47], v10, s[36:39], s29 offen offset:256 sc1
    s_add_u32 s29, s29, 4096
    s_waitcnt vmcnt(19)
    v_dot2_f32_bf16 v12, v48, s35, v12
    v_dot2_f32_bf16 v13, v48, v48, v13
    v_dot2_f32_bf16 v12, v49, s35, v12
    v_dot2_f32_bf16 v13, v49, v49, v13
    v_dot2_f32_bf16 v12, v50, s35, v12
    v_dot2_f32_bf16 v13, v50, v50, v13
    v_dot2_f32_bf16 v12, v51, s35, v12
    v_dot2_f32_bf16 v13, v51, v51, v13
    s_waitcnt vmcnt(18)
    v_dot2_f32_bf16 v14, v52, s35, v14
    v_dot2_f32_bf16 v15, v52, v52, v15
    v_dot2_f32_bf16 v14, v53, s35, v14
    v_dot2_f32_bf16 v15, v53, v53, v15
    v_dot2_f32_bf16 v14, v54, s35, v14
    v_dot2_f32_bf16 v15, v54, v54, v15
    v_dot2_f32_bf16 v14, v55, s35, v14
    v_dot2_f32_bf16 v15, v55, v55, v15
    v_swap_b32 v50, v52
    v_swap_b32 v51, v53
    buffer_store_dwordx4 v[48:51], v10, s[36:39], s29 offen offset:0 sc1
    buffer_store_dwordx4 v[52:55], v10, s[36:39], s29 offen offset:256 sc1
    s_add_u32 s29, s29, 4096
    s_waitcnt vmcnt(19)
    v_dot2_f32_bf16 v12, v56, s35, v12
    v_dot2_f32_bf16 v13, v56, v56, v13
    v_dot2_f32_bf16 v12, v57, s35, v12
    v_dot2_f32_bf16 v13, v57, v57, v13
    v_dot2_f32_bf16 v12, v58, s35, v12
    v_dot2_f32_bf16 v13, v58, v58, v13
    v_dot2_f32_bf16 v12, v59, s35, v12
    v_dot2_f32_bf16 v13, v59, v59, v13
    s_waitcnt vmcnt(18)
    v_dot2_f32_bf16 v14, v60, s35, v14
    v_dot2_f32_bf16 v15, v60, v60, v15
    v_dot2_f32_bf16 v14, v61, s35, v14
    v_dot2_f32_bf16 v15, v61, v61, v15
    v_dot2_f32_bf16 v14, v62, s35, v14
    v_dot2_f32_bf16 v15, v62, v62, v15
    v_dot2_f32_bf16 v14, v63, s35, v14
    v_dot2_f32_bf16 v15, v63, v63, v15
    v_swap_b32 v58, v60
    v_swap_b32 v59, v61
    buffer_store_dwordx4 v[56:59], v10, s[36:39], s29 offen offset:0 sc1
    buffer_store_dwordx4 v[60:63], v10, s[36:39], s29 offen offset:256 sc1
    s_add_u32 s29, s29, 4096
    s_waitcnt vmcnt(19)
    v_dot2_f32_bf16 v12, v64, s35, v12
    v_dot2_f32_bf16 v13, v64, v64, v13
    v_dot2_f32_bf16 v12, v65, s35, v12
    v_dot2_f32_bf16 v13, v65, v65, v13
    v_dot2_f32_bf16 v12, v66, s35, v12
    v_dot2_f32_bf16 v13, v66, v66, v13
    v_dot2_f32_bf16 v12, v67, s35, v12
    v_dot2_f32_bf16 v13, v67, v67, v13
    s_waitcnt vmcnt(18)
    v_dot2_f32_bf16 v14, v68, s35, v14
    v_dot2_f32_bf16 v15, v68, v68, v15
    v_dot2_f32_bf16 v14, v69, s35, v14
    v_dot2_f32_bf16 v15, v69, v69, v15
    v_dot2_f32_bf16 v14, v70, s35, v14
    v_dot2_f32_bf16 v15, v70, v70, v15
    v_dot2_f32_bf16 v14, v71, s35, v14
    v_dot2_f32_bf16 v15, v71, v71, v15
    v_swap_b32 v66, v68
    v_swap_b32 v67, v69
    buffer_store_dwordx4 v[64:67], v10, s[36:39], s29 offen offset:0 sc1
    buffer_store_dwordx4 v[68:71], v10, s[36:39], s29 offen offset:256 sc1
    s_add_u32 s29, s29, 4096
    s_waitcnt vmcnt(19)
    v_dot2_f32_bf16 v12, v72, s35, v12
    v_dot2_f32_bf16 v13, v72, v72, v13
    v_dot2_f32_bf16 v12, v73, s35, v12
    v_dot2_f32_bf16 v13, v73, v73, v13
    v_dot2_f32_bf16 v12, v74, s35, v12
    v_dot2_f32_bf16 v13, v74, v74, v13
    v_dot2_f32_bf16 v12, v75, s35, v12
    v_dot2_f32_bf16 v13, v75, v75, v13
    s_waitcnt vmcnt(18)
    v_dot2_f32_bf16 v14, v76, s35, v14
    v_dot2_f32_bf16 v15, v76, v76, v15
    v_dot2_f32_bf16 v14, v77, s35, v14
    v_dot2_f32_bf16 v15, v77, v77, v15
    v_dot2_f32_bf16 v14, v78, s35, v14
    v_dot2_f32_bf16 v15, v78, v78, v15
    v_dot2_f32_bf16 v14, v79, s35, v14
    v_dot2_f32_bf16 v15, v79, v79, v15
    v_swap_b32 v74, v76
    v_swap_b32 v75, v77
    buffer_store_dwordx4 v[72:75], v10, s[36:39], s29 offen offset:0 sc1
    buffer_store_dwordx4 v[76:79], v10, s[36:39], s29 offen offset:256 sc1
    s_add_u32 s29, s29, 4096
    s_waitcnt vmcnt(19)
    v_dot2_f32_bf16 v12, v80, s35, v12
    v_dot2_f32_bf16 v13, v80, v80, v13
    v_dot2_f32_bf16 v12, v81, s35, v12
    v_dot2_f32_bf16 v13, v81, v81, v13
    v_dot2_f32_bf16 v12, v82, s35, v12
    v_dot2_f32_bf16 v13, v82, v82, v13
    v_dot2_f32_bf16 v12, v83, s35, v12
    v_dot2_f32_bf16 v13, v83, v83, v13
    s_waitcnt vmcnt(18)
    v_dot2_f32_bf16 v14, v84, s35, v14
    v_dot2_f32_bf16 v15, v84, v84, v15
    v_dot2_f32_bf16 v14, v85, s35, v14
    v_dot2_f32_bf16 v15, v85, v85, v15
    v_dot2_f32_bf16 v14, v86, s35, v14
    v_dot2_f32_bf16 v15, v86, v86, v15
    v_dot2_f32_bf16 v14, v87, s35, v14
    v_dot2_f32_bf16 v15, v87, v87, v15
    v_swap_b32 v82, v84
    v_swap_b32 v83, v85
    buffer_store_dwordx4 v[80:83], v10, s[36:39], s29 offen offset:0 sc1
    buffer_store_dwordx4 v[84:87], v10, s[36:39], s29 offen offset:256 sc1
    s_add_u32 s29, s29, 4096
    s_waitcnt vmcnt(19)
    v_dot2_f32_bf16 v12, v88, s35, v12
    v_dot2_f32_bf16 v13, v88, v88, v13
    v_dot2_f32_bf16 v12, v89, s35, v12
    v_dot2_f32_bf16 v13, v89, v89, v13
    v_dot2_f32_bf16 v12, v90, s35, v12
    v_dot2_f32_bf16 v13, v90, v90, v13
    v_dot2_f32_bf16 v12, v91, s35, v12
    v_dot2_f32_bf16 v13, v91, v91, v13
    s_waitcnt vmcnt(18)
    v_dot2_f32_bf16 v14, v92, s35, v14
    v_dot2_f32_bf16 v15, v92, v92, v15
    v_dot2_f32_bf16 v14, v93, s35, v14
    v_dot2_f32_bf16 v15, v93, v93, v15
    v_dot2_f32_bf16 v14, v94, s35, v14
    v_dot2_f32_bf16 v15, v94, v94, v15
    v_dot2_f32_bf16 v14, v95, s35, v14
    v_dot2_f32_bf16 v15, v95, v95, v15
    v_swap_b32 v90, v92
    v_swap_b32 v91, v93
    buffer_store_dwordx4 v[88:91], v10, s[36:39], s29 offen offset:0 sc1
    buffer_store_dwordx4 v[92:95], v10, s[36:39], s29 offen offset:256 sc1
    v_and_b32 v208, 7, v2
    v_lshlrev_b32 v208, 2, v208
    global_load_dword v209, v208, s[16:17]
    s_nop 3
    v_add_f32_dpp v12, v12, v12 quad_perm:[1,0,3,2] row_mask:0xf bank_mask:0xf
    v_add_f32_dpp v13, v13, v13 quad_perm:[1,0,3,2] row_mask:0xf bank_mask:0xf
    v_add_f32_dpp v14, v14, v14 quad_perm:[1,0,3,2] row_mask:0xf bank_mask:0xf
    v_add_f32_dpp v15, v15, v15 quad_perm:[1,0,3,2] row_mask:0xf bank_mask:0xf
    v_add_f32_dpp v12, v12, v12 quad_perm:[2,3,0,1] row_mask:0xf bank_mask:0xf
    v_add_f32_dpp v13, v13, v13 quad_perm:[2,3,0,1] row_mask:0xf bank_mask:0xf
    v_add_f32_dpp v14, v14, v14 quad_perm:[2,3,0,1] row_mask:0xf bank_mask:0xf
    v_add_f32_dpp v15, v15, v15 quad_perm:[2,3,0,1] row_mask:0xf bank_mask:0xf
    v_add_f32_dpp v12, v12, v12 row_half_mirror row_mask:0xf bank_mask:0xf
    v_add_f32_dpp v13, v13, v13 row_half_mirror row_mask:0xf bank_mask:0xf
    v_add_f32_dpp v14, v14, v14 row_half_mirror row_mask:0xf bank_mask:0xf
    v_add_f32_dpp v15, v15, v15 row_half_mirror row_mask:0xf bank_mask:0xf
    v_cndmask_b32_e64 v12, v12, v14, s[4:5]
    v_cndmask_b32_e64 v13, v13, v15, s[4:5]
    v_mul_f32 v12, s28, v12
    v_mul_f32 v13, s28, v13
    v_fma_f32 v13, -v12, v12, v13
    v_max_f32 v13, 0, v13
    v_cvt_pk_bf16_f32 v14, v12, v13
    v_lshlrev_b32 v15, 16, v14
    v_and_b32 v13, s26, v14
    v_add_f32 v13, 0x3727c5ac, v13
    v_cvt_pk_bf16_f32 v13, v13, v13
    v_and_b32 v13, s26, v13
    v_sqrt_f32 v13, v13
    s_nop 0
    v_cvt_pk_bf16_f32 v13, v13, v13
    v_and_b32 v13, s26, v13
    v_rcp_f32 v100, v13
    s_nop 0
    v_mul_f32 v101, v15, v100
    v_min_u32 v100, -2, v100
    s_waitcnt vmcnt(0)
    v_cmp_eq_u32 vcc, 0, v209
    s_cbranch_vccnz .rl48
.rl48b:
    s_mov_b64 exec, s[6:7]
    buffer_store_dwordx2 v[100:101], v11, s[36:39], s31 offen sc1
    s_mov_b64 exec, -1
    s_branch .hb042
.hfl41:
    s_waitcnt lgkmcnt(0)
    s_mov_b32 s36, s18
    s_mov_b32 s37, s19
    s_sub_u32 s32, s30, 128
    s_cmp_ge_u32 s32, 8
    s_cbranch_scc1 .hb042
    s_mul_i32 s28, s32, 3072
    s_add_u32 s28, s28, 11010048
    s_lshl_b32 s29, s32, 12
    s_add_u32 s29, s29, 11034624
    v_lshlrev_b32 v210, 4, v2
    v_lshlrev_b32 v211, 6, v2
    v_mov_b32 v212, -1
    v_mov_b32 v213, -1
    v_mov_b32 v214, -1
    v_mov_b32 v215, -1
    buffer_store_dwordx4 v[212:215], v210, s[36:39], s28 offen sc1
    buffer_store_dwordx4 v[212:215], v210, s[36:39], s28 offen offset:1024 sc1
    buffer_store_dwordx4 v[212:215], v210, s[36:39], s28 offen offset:2048 sc1
    buffer_store_dword v212, v211, s[36:39], s29 offen sc1
    s_lshl_b32 s32, s32, 2
    v_mov_b32 v210, s32
    s_mov_b64 exec, 1
    s_waitcnt vmcnt(0)
    global_store_dword v210, v212, s[16:17] sc1
    s_mov_b64 exec, -1
    s_branch .hb042
.hdn43:
    s_barrier
    s_mov_b32 s20, s18
    s_mov_b32 s21, s19
    s_mov_b32 s22, 0x10000000
    v_lshlrev_b32 v3, 4, v2
    s_mov_b32 s59, 0xffff0000
    s_and_b32 s6, s2, 1
    s_lshr_b32 s7, s2, 5
    s_lshl_b32 s8, s7, 1
    s_add_u32 s6, s6, s8
    s_bfe_u32 s8, s2, 0x20001
    s_mul_i32 s13, s8, 27
    s_and_b32 s13, s13, -4
    v_and_b32 v189, 31, v2
    v_add_u32 v189, s13, v189
    v_min_u32 v189, 0x6b, v189
    v_lshlrev_b32 v189, 7, v189
    s_mov_b32 s13, 11034624
    v_min_u32 v190, 624, v3
    s_and_b32 s15, s6, 3
    s_mul_i32 s15, s15, 640
    s_add_u32 s15, s15, 11014144
    buffer_load_dword v188, v189, s[20:23], s13 offen sc1
    s_bfe_u32 s9, s2, 0x20003
    s_lshl_b32 s10, s8, 2
    s_add_u32 s10, s10, s9
    s_lshl_b32 s12, s6, 2
    s_add_u32 s12, s12, s3
    s_mul_i32 s24, s12, 40960
    s_add_u32 s24, s24, 8388608
    s_add_u32 s25, s24, 10240
    s_add_u32 s26, s24, 20480
    s_add_u32 s27, s24, 30720
    s_mul_i32 s34, s3, 5120
    s_mul_i32 s14, s10, 286720
    s_add_u32 s14, s14, 25165824
    s_add_u32 s28, s14, s34
    s_add_u32 s29, s28, 20480
    s_add_u32 s30, s28, 40960
    s_add_u32 s31, s28, 61440
    v_add_u32 v4, 4096, v3
    v_add_u32 v5, 8192, v3
    s_and_b32 s5, s3, 1
    s_add_u32 s32, s28, 245760
    s_add_u32 s33, s32, 20480
    s_lshl_b32 s4, s12, 3
    s_add_u32 s4, s4, s8
    s_mul_i32 s4, s4, 14336
    s_lshl_b32 s18, s9, 9
    s_add_u32 s4, s4, s18
    s_add_u32 s35, s4, s18
    s_add_u32 s36, s35, 57344
    s_add_u32 s37, s4, 12288
    s_add_u32 s38, s37, 57344
    s_lshr_b32 s4, s12, 1
    s_lshl_b32 s4, s4, 2
    s_add_u32 s4, s4, s8
    s_lshl_b32 s4, s4, 2
    s_add_u32 s4, s4, s9
    s_lshl_b32 s4, s4, 1
    s_add_u32 s4, s4, s5
    s_lshl_b32 s62, s4, 2
    s_add_u32 s62, s62, 11010048
    s_lshl_b32 s51, s10, 12
    s_add_u32 s51, s51, 18874368
    s_mov_b32 s52, 0xaaaaaaaa
    s_mov_b32 s53, s52
    s_mov_b32 s54, 0xcccccccc
    s_mov_b32 s55, s54
    s_mov_b32 s58, 0x3acccccd
    s_lshl_b32 s4, s6, 1
    s_bfe_u32 s18, s2, 0x10001
    s_add_u32 s4, s4, s18
    s_lshl_b32 s4, s4, 2
    s_bfe_u32 s18, s2, 0x10002
    s_lshl_b32 s18, s18, 2
    s_add_u32 s18, s18, s9
    s_mul_i32 s19, s18, 54
    s_lshr_b32 s39, s3, 1
    s_mul_i32 s39, s39, 27
    s_mul_i32 s56, s5, 13
    s_add_u32 s56, s56, s39
    s_lshl_b32 s56, s56, 1
    s_bfe_u32 s57, s2, 0x10002
    s_add_u32 s56, s56, s57
    s_lshl_b32 s56, s56, 7
    s_add_u32 s56, s56, 11048448
    s_add_u32 s19, s19, s39
    s_add_u32 s49, s19, 13
    s_mul_i32 s39, s5, 14
    s_add_u32 s19, s19, s39
    s_mul_i32 s19, s19, 5120
    s_add_u32 s44, s19, 30408704
    s_add_u32 s45, s44, 5120
    s_add_u32 s46, s44, 10240
    s_add_u32 s47, s44, 15360
    s_add_u32 s48, s44, 61440
    s_mul_i32 s49, s49, 5120
    s_lshl_b32 s39, s5, 3
    s_add_u32 s49, s49, s39
    s_add_u32 s49, s49, 30408704
    s_add_u32 s60, s4, s3
    s_lshl_b32 s11, s60, 5
    s_add_u32 s11, s11, 11010048
    s_lshr_b32 s50, s60, 1
    s_mul_i32 s50, s50, 40960
    s_add_u32 s50, s50, s39
    s_mul_i32 s39, s18, 5120
    s_add_u32 s50, s50, s39
    s_add_u32 s50, s50, 8388608
    s_mul_i32 s60, s60, 20480
    s_mul_i32 s39, s18, 160
    s_add_u32 s60, s60, s39
    s_add_u32 s94, s94, s60
    s_addc_u32 s95, s95, 0
    s_add_u32 s39, s3, 1
    s_and_b32 s39, s39, 3
    s_add_u32 s39, s39, s4
    s_lshl_b32 s39, s39, 2
    s_add_u32 s39, s39, s3
    s_mul_i32 s40, s39, 14336
    s_add_u32 s39, s3, 2
    s_and_b32 s39, s39, 3
    s_add_u32 s39, s39, s4
    s_lshl_b32 s39, s39, 2
    s_add_u32 s39, s39, s3
    s_mul_i32 s41, s39, 14336
    s_add_u32 s39, s3, 3
    s_and_b32 s39, s39, 3
    s_add_u32 s39, s39, s4
    s_lshl_b32 s39, s39, 2
    s_add_u32 s39, s39, s3
    s_mul_i32 s42, s39, 14336
    s_add_u32 s39, s3, 4
    s_and_b32 s39, s39, 3
    s_add_u32 s39, s39, s4
    s_lshl_b32 s39, s39, 2
    s_add_u32 s39, s39, s3
    s_mul_i32 s43, s39, 14336
    v_add_u32 v6, 61440, v3
    v_add_u32 v7, 122880, v3
    v_mov_b32 v1, 0x3f803f80
    v_accvgpr_write_b32 a56, v1
    v_accvgpr_write_b32 a57, v1
    v_accvgpr_write_b32 a58, v1
    v_accvgpr_write_b32 a59, v1
    v_accvgpr_write_b32 a49, 0
    v_accvgpr_write_b32 a50, 0
    v_accvgpr_write_b32 a53, 0
    v_accvgpr_write_b32 a54, 0
    v_lshlrev_b32 v12, 3, v2
    v_and_b32 v13, 15, v2
    v_lshrrev_b32 v8, 2, v13
    v_lshl_add_u32 v13, v8, 4, v13
    v_lshlrev_b32 v13, 2, v13
    v_mov_b32 v8, v3
    v_add_u32 v9, 1024, v3
    v_add_u32 v10, 2048, v3
    v_add_u32 v11, 3072, v3
    v_min_u32 v238, 13, v2
    v_lshlrev_b32 v238, 8, v238
    v_mov_b32 v232, -1
    v_mov_b32 v233, -1
    v_mov_b32 v234, -1
    v_mov_b32 v235, -1
    v_min_u32 v17, 39, v2
    v_lshlrev_b32 v17, 8, v17
    s_mov_b32 s61, s3
    s_mul_i32 s61, s61, 10240
    s_add_u32 s61, s61, s24
    v_mov_b32 v19, 0
    s_waitcnt vmcnt(0)
    v_cmp_eq_u32 vcc, -1, v188
    s_cbranch_vccz .Lfz_ef
    s_mov_b32 s60, 200000
.sp49:
    buffer_load_dword v188, v189, s[20:23], s13 offen sc1
    s_waitcnt vmcnt(0)
    v_cmp_eq_u32 vcc, -1, v188
    s_cbranch_vccz .sp49x
    s_sub_u32 s60, s60, 1
    s_cmp_lg_u32 s60, 0
    s_cbranch_scc1 .sp49
.sp49x:
.Lfz_ef:
    s_add_u32 m0, s34, 61440
    s_nop 0
    buffer_load_dwordx4 v3, s[20:23], s28 offen offset:0 lds
    buffer_load_dwordx4 v3, s[20:23], s28 offen offset:1024 lds
    buffer_load_dwordx4 v3, s[20:23], s28 offen offset:2048 lds
    buffer_load_dwordx4 v3, s[20:23], s28 offen offset:3072 lds
    s_add_u32 m0, s34, 65536
    s_nop 0
    buffer_load_dwordx4 v4, s[20:23], s28 offen offset:0 lds
    s_add_u32 s28, s28, 81920
    s_add_u32 m0, s34, 81920
    s_nop 0
    buffer_load_dwordx4 v3, s[20:23], s29 offen offset:0 lds
    buffer_load_dwordx4 v3, s[20:23], s29 offen offset:1024 lds
    buffer_load_dwordx4 v3, s[20:23], s29 offen offset:2048 lds
    buffer_load_dwordx4 v3, s[20:23], s29 offen offset:3072 lds
    s_add_u32 m0, s34, 86016
    s_nop 0
    buffer_load_dwordx4 v4, s[20:23], s29 offen offset:0 lds
    s_add_u32 s29, s29, 81920
    s_add_u32 m0, s34, 102400
    s_nop 0
    buffer_load_dwordx4 v3, s[20:23], s30 offen offset:0 lds
    buffer_load_dwordx4 v3, s[20:23], s30 offen offset:1024 lds
    buffer_load_dwordx4 v3, s[20:23], s30 offen offset:2048 lds
    buffer_load_dwordx4 v3, s[20:23], s30 offen offset:3072 lds
    s_add_u32 m0, s34, 106496
    s_nop 0
    buffer_load_dwordx4 v4, s[20:23], s30 offen offset:0 lds
    s_add_u32 s30, s30, 81920
    s_add_u32 m0, s34, 122880
    s_nop 0
    buffer_load_dwordx4 v3, s[20:23], s31 offen offset:0 lds
    buffer_load_dwordx4 v3, s[20:23], s31 offen offset:1024 lds
    buffer_load_dwordx4 v3, s[20:23], s31 offen offset:2048 lds
    buffer_load_dwordx4 v3, s[20:23], s31 offen offset:3072 lds
    s_add_u32 m0, s34, 126976
    s_nop 0
    buffer_load_dwordx4 v4, s[20:23], s31 offen offset:0 lds
    s_add_u32 s31, s31, 81920
    s_add_u32 m0, s34, 143360
    s_nop 0
    buffer_load_dwordx4 v3, s[20:23], s28 offen offset:0 lds
    buffer_load_dwordx4 v3, s[20:23], s28 offen offset:1024 lds
    buffer_load_dwordx4 v3, s[20:23], s28 offen offset:2048 lds
    buffer_load_dwordx4 v3, s[20:23], s28 offen offset:3072 lds
    s_add_u32 m0, s34, 147456
    s_nop 0
    buffer_load_dwordx4 v4, s[20:23], s28 offen offset:0 lds
    s_add_u32 s28, s28, 81920
    s_add_u32 m0, s34, 0
    s_nop 0
    buffer_load_dwordx4 v3, s[20:23], s29 offen offset:0 lds
    buffer_load_dwordx4 v3, s[20:23], s29 offen offset:1024 lds
    buffer_load_dwordx4 v3, s[20:23], s29 offen offset:2048 lds
    buffer_load_dwordx4 v3, s[20:23], s29 offen offset:3072 lds
    s_add_u32 m0, s34, 4096
    s_nop 0
    buffer_load_dwordx4 v4, s[20:23], s29 offen offset:0 lds
    s_add_u32 s29, s29, 81920
    s_add_u32 m0, s34, 20480
    s_nop 0
    buffer_load_dwordx4 v3, s[20:23], s30 offen offset:0 lds
    buffer_load_dwordx4 v3, s[20:23], s30 offen offset:1024 lds
    buffer_load_dwordx4 v3, s[20:23], s30 offen offset:2048 lds
    buffer_load_dwordx4 v3, s[20:23], s30 offen offset:3072 lds
    s_add_u32 m0, s34, 24576
    s_nop 0
    buffer_load_dwordx4 v4, s[20:23], s30 offen offset:0 lds
    s_add_u32 s30, s30, 81920
    s_add_u32 m0, s34, 40960
    s_nop 0
    buffer_load_dwordx4 v3, s[20:23], s31 offen offset:0 lds
    buffer_load_dwordx4 v3, s[20:23], s31 offen offset:1024 lds
    buffer_load_dwordx4 v3, s[20:23], s31 offen offset:2048 lds
    buffer_load_dwordx4 v3, s[20:23], s31 offen offset:3072 lds
    s_add_u32 m0, s34, 45056
    s_nop 0
    buffer_load_dwordx4 v4, s[20:23], s31 offen offset:0 lds
    s_add_u32 s31, s31, 81920
    buffer_load_dwordx4 a[32:35], v3, s[20:23], s51 offen offset:0 sc1
    buffer_load_dwordx4 a[36:39], v3, s[20:23], s51 offen offset:1024 sc1
    buffer_load_dwordx4 a[40:43], v3, s[20:23], s51 offen offset:2048 sc1
    buffer_load_dwordx4 a[44:47], v3, s[20:23], s51 offen offset:3072 sc1
    buffer_store_dwordx4 v[232:235], v3, s[20:23], s35 offen sc1
    buffer_store_dwordx4 v[232:235], v3, s[20:23], s36 offen sc1
    buffer_store_dwordx4 v[232:235], v4, s[20:23], s35 offen sc1
    buffer_store_dwordx4 v[232:235], v4, s[20:23], s36 offen sc1
    buffer_store_dwordx4 v[232:235], v5, s[20:23], s35 offen sc1
    buffer_store_dwordx4 v[232:235], v5, s[20:23], s36 offen sc1
    buffer_store_dwordx2 v[232:233], v12, s[20:23], s37 offen sc1
    buffer_store_dwordx2 v[232:233], v12, s[20:23], s38 offen sc1
    s_mov_b32 s60, 200000
.sp50:
    buffer_load_dwordx4 v[184:187], v190, s[20:23], s15 offen sc1
    s_waitcnt vmcnt(0)
    v_max3_u32 v184, v184, v185, v186
    v_max3_u32 v184, v184, v187, v188
    v_cmp_eq_u32 vcc, -1, v184
    s_cbranch_vccz .sp50x
    s_sub_u32 s60, s60, 1
    s_cmp_lg_u32 s60, 0
    s_cbranch_scc1 .sp50
.sp50x:
.Lfz_e2:
    s_mov_b64 exec, 1
    s_mov_b32 s60, 200000
.sp51:
    buffer_load_dword v18, v19, s[20:23], s61 offen sc1
    s_waitcnt vmcnt(0)
    v_cmp_eq_u32 vcc, -1, v18
    s_cbranch_vccz .sp51x
    s_sub_u32 s60, s60, 1
    s_cmp_lg_u32 s60, 0
    s_cbranch_scc1 .sp51
.sp51x:
    s_mov_b64 exec, -1
    s_mov_b32 s60, 200000
.sp52:
    buffer_load_dword v18, v17, s[20:23], s61 offen sc1
    s_waitcnt vmcnt(0)
    v_cmp_eq_u32 vcc, -1, v18
    s_cbranch_vccz .sp52x
    s_sub_u32 s60, s60, 1
    s_cmp_lg_u32 s60, 0
    s_cbranch_scc1 .sp52
.sp52x:
.Lfz_e3:
    s_barrier
    buffer_load_dwordx4 v[16:19], v3, s[20:23], s24 offen offset:0
    buffer_load_dwordx4 v[20:23], v3, s[20:23], s24 offen offset:1024
    buffer_load_dwordx4 v[24:27], v3, s[20:23], s24 offen offset:2048
    buffer_load_dwordx4 v[28:31], v3, s[20:23], s24 offen offset:3072
    buffer_load_dwordx4 v[32:35], v4, s[20:23], s24 offen offset:0
    buffer_load_dwordx4 v[36:39], v4, s[20:23], s24 offen offset:1024
    buffer_load_dwordx4 v[40:43], v4, s[20:23], s24 offen offset:2048
    buffer_load_dwordx4 v[44:47], v4, s[20:23], s24 offen offset:3072
    buffer_load_dwordx4 v[48:51], v5, s[20:23], s24 offen offset:0
    buffer_load_dwordx4 v[52:55], v5, s[20:23], s24 offen offset:1024
    buffer_load_dwordx4 v[56:59], v3, s[20:23], s25 offen offset:0
    buffer_load_dwordx4 v[60:63], v3, s[20:23], s25 offen offset:1024
    buffer_load_dwordx4 v[64:67], v3, s[20:23], s25 offen offset:2048
    buffer_load_dwordx4 v[68:71], v3, s[20:23], s25 offen offset:3072
    buffer_load_dwordx4 v[72:75], v4, s[20:23], s25 offen offset:0
    buffer_load_dwordx4 v[76:79], v4, s[20:23], s25 offen offset:1024
    s_waitcnt vmcnt(14)
    v_max_u32 v2, v16, v20
    v_cmp_eq_u32 vcc, -1, v2
    s_cbranch_vccnz .hr53
.hr53b:
    v_swap_b32 v18, v20
    v_swap_b32 v19, v21
    s_nop 1
    v_mfma_f32_16x16x32_bf16 v[240:243], v[16:19], v[16:19], 0
    s_barrier
    ds_read_b128 a[0:3], v6 offset:0
    s_waitcnt vmcnt(12)
    v_max_u32 v2, v24, v28
    v_mfma_f32_16x16x32_bf16 v[244:247], a[56:59], v[16:19], 0
    ds_read_b128 a[4:7], v6 offset:1024
    v_cmp_eq_u32 vcc, -1, v2
    s_cbranch_vccnz .hr54
.hr54b:
    v_mfma_f32_16x16x32_bf16 v[248:251], v[20:23], v[20:23], 0
    ds_read_b128 a[8:11], v6 offset:2048
    v_swap_b32 v26, v28
    v_mfma_f32_16x16x32_bf16 v[252:255], a[56:59], v[20:23], 0
    buffer_load_dwordx4 v[80:83], v4, s[20:23], s25 offen offset:2048
    v_swap_b32 v27, v29
    s_nop 1
    v_mfma_f32_16x16x32_bf16 v[240:243], v[24:27], v[24:27], v[240:243]
    ds_read_b128 a[12:15], v6 offset:3072
    v_mfma_f32_16x16x32_bf16 v[244:247], a[56:59], v[24:27], v[244:247]
    buffer_load_dwordx4 v[84:87], v4, s[20:23], s25 offen offset:3072
    v_mfma_f32_16x16x32_bf16 v[248:251], v[28:31], v[28:31], v[248:251]
    buffer_load_dwordx4 v[88:91], v5, s[20:23], s25 offen offset:0
    v_mfma_f32_16x16x32_bf16 v[252:255], a[56:59], v[28:31], v[252:255]
    s_waitcnt lgkmcnt(2)
    v_mfma_f32_16x16x32_bf16 v[176:179], a[0:3], v[16:19], 0
    v_mfma_f32_16x16x32_bf16 v[192:195], a[0:3], v[20:23], 0
    buffer_load_dwordx4 v[92:95], v5, s[20:23], s25 offen offset:1024
    v_mfma_f32_16x16x32_bf16 v[180:183], a[4:7], v[16:19], 0
    ds_read_b128 a[16:19], v6 offset:4096
    s_waitcnt vmcnt(14)
    v_max_u32 v2, v32, v36
    v_mfma_f32_16x16x32_bf16 v[196:199], a[4:7], v[20:23], 0
    v_cmp_eq_u32 vcc, -1, v2
    s_cbranch_vccnz .hr55
.hr55b:
    v_swap_b32 v34, v36
    s_waitcnt lgkmcnt(1)
    v_mfma_f32_16x16x32_bf16 v[184:187], a[8:11], v[16:19], 0
    ds_read_b128 a[20:23], v6 offset:5120
    v_swap_b32 v35, v37
    v_mfma_f32_16x16x32_bf16 v[200:203], a[8:11], v[20:23], 0
    buffer_load_dwordx4 v[96:99], v3, s[20:23], s26 offen offset:0
    v_mfma_f32_16x16x32_bf16 v[188:191], a[12:15], v[16:19], 0
    ds_read_b128 a[24:27], v6 offset:6144
    v_mfma_f32_16x16x32_bf16 v[204:207], a[12:15], v[20:23], 0
    buffer_load_dwordx4 v[100:103], v3, s[20:23], s26 offen offset:1024
    v_mfma_f32_16x16x32_bf16 v[240:243], v[32:35], v[32:35], v[240:243]
    ds_read_b128 a[28:31], v6 offset:7168
    v_mfma_f32_16x16x32_bf16 v[244:247], a[56:59], v[32:35], v[244:247]
    v_mfma_f32_16x16x32_bf16 v[248:251], v[36:39], v[36:39], v[248:251]
    buffer_load_dwordx4 v[104:107], v3, s[20:23], s26 offen offset:2048
    v_mfma_f32_16x16x32_bf16 v[252:255], a[56:59], v[36:39], v[252:255]
    s_waitcnt lgkmcnt(2)
    v_mfma_f32_16x16x32_bf16 v[176:179], a[16:19], v[24:27], v[176:179]
    v_mfma_f32_16x16x32_bf16 v[192:195], a[16:19], v[28:31], v[192:195]
    buffer_load_dwordx4 v[108:111], v3, s[20:23], s26 offen offset:3072
    v_mfma_f32_16x16x32_bf16 v[180:183], a[20:23], v[24:27], v[180:183]
    ds_read_b128 a[0:3], v6 offset:8192
    s_waitcnt vmcnt(16)
    v_max_u32 v2, v40, v44
    v_mfma_f32_16x16x32_bf16 v[196:199], a[20:23], v[28:31], v[196:199]
    v_cmp_eq_u32 vcc, -1, v2
    s_cbranch_vccnz .hr56
.hr56b:
    v_swap_b32 v42, v44
    s_waitcnt lgkmcnt(1)
    v_mfma_f32_16x16x32_bf16 v[184:187], a[24:27], v[24:27], v[184:187]
    ds_read_b128 a[4:7], v6 offset:9216
    v_swap_b32 v43, v45
    v_mfma_f32_16x16x32_bf16 v[200:203], a[24:27], v[28:31], v[200:203]
    buffer_load_dwordx4 v[112:115], v4, s[20:23], s26 offen offset:0
    v_mfma_f32_16x16x32_bf16 v[188:191], a[28:31], v[24:27], v[188:191]
    ds_read_b128 a[8:11], v6 offset:10240
    v_mfma_f32_16x16x32_bf16 v[204:207], a[28:31], v[28:31], v[204:207]
    buffer_load_dwordx4 v[116:119], v4, s[20:23], s26 offen offset:1024
    v_mfma_f32_16x16x32_bf16 v[240:243], v[40:43], v[40:43], v[240:243]
    ds_read_b128 a[12:15], v6 offset:11264
    v_mfma_f32_16x16x32_bf16 v[244:247], a[56:59], v[40:43], v[244:247]
    v_mfma_f32_16x16x32_bf16 v[248:251], v[44:47], v[44:47], v[248:251]
    buffer_load_dwordx4 v[120:123], v4, s[20:23], s26 offen offset:2048
    v_mfma_f32_16x16x32_bf16 v[252:255], a[56:59], v[44:47], v[252:255]
    s_waitcnt lgkmcnt(2)
    v_mfma_f32_16x16x32_bf16 v[176:179], a[0:3], v[32:35], v[176:179]
    v_mfma_f32_16x16x32_bf16 v[192:195], a[0:3], v[36:39], v[192:195]
    buffer_load_dwordx4 v[124:127], v4, s[20:23], s26 offen offset:3072
    v_mfma_f32_16x16x32_bf16 v[180:183], a[4:7], v[32:35], v[180:183]
    ds_read_b128 a[16:19], v6 offset:12288
    s_waitcnt vmcnt(18)
    v_max_u32 v2, v48, v52
    v_mfma_f32_16x16x32_bf16 v[196:199], a[4:7], v[36:39], v[196:199]
    v_cmp_eq_u32 vcc, -1, v2
    s_cbranch_vccnz .hr57
.hr57b:
    v_swap_b32 v50, v52
    s_waitcnt lgkmcnt(1)
    v_mfma_f32_16x16x32_bf16 v[184:187], a[8:11], v[32:35], v[184:187]
    ds_read_b128 a[20:23], v6 offset:13312
    v_swap_b32 v51, v53
    v_mfma_f32_16x16x32_bf16 v[200:203], a[8:11], v[36:39], v[200:203]
    buffer_load_dwordx4 v[128:131], v5, s[20:23], s26 offen offset:0
    v_mfma_f32_16x16x32_bf16 v[188:191], a[12:15], v[32:35], v[188:191]
    ds_read_b128 a[24:27], v6 offset:14336
    v_mfma_f32_16x16x32_bf16 v[204:207], a[12:15], v[36:39], v[204:207]
    buffer_load_dwordx4 v[132:135], v5, s[20:23], s26 offen offset:1024
    v_mfma_f32_16x16x32_bf16 v[240:243], v[48:51], v[48:51], v[240:243]
    ds_read_b128 a[28:31], v6 offset:15360
    v_mfma_f32_16x16x32_bf16 v[244:247], a[56:59], v[48:51], v[244:247]
    v_mfma_f32_16x16x32_bf16 v[248:251], v[52:55], v[52:55], v[248:251]
    buffer_load_dwordx4 v[136:139], v3, s[20:23], s27 offen offset:0
    v_mfma_f32_16x16x32_bf16 v[252:255], a[56:59], v[52:55], v[252:255]
    s_waitcnt lgkmcnt(2)
    v_mfma_f32_16x16x32_bf16 v[176:179], a[16:19], v[40:43], v[176:179]
    v_mfma_f32_16x16x32_bf16 v[192:195], a[16:19], v[44:47], v[192:195]
    buffer_load_dwordx4 v[140:143], v3, s[20:23], s27 offen offset:1024
    v_mfma_f32_16x16x32_bf16 v[180:183], a[20:23], v[40:43], v[180:183]
    ds_read_b128 a[0:3], v6 offset:16384
    s_waitcnt vmcnt(20)
    v_max_u32 v2, v56, v60
    v_mfma_f32_16x16x32_bf16 v[196:199], a[20:23], v[44:47], v[196:199]
    v_cmp_eq_u32 vcc, -1, v2
    s_cbranch_vccnz .hr58
.hr58b:
    v_swap_b32 v58, v60
    s_waitcnt lgkmcnt(1)
    v_mfma_f32_16x16x32_bf16 v[184:187], a[24:27], v[40:43], v[184:187]
    ds_read_b128 a[4:7], v6 offset:17408
    v_swap_b32 v59, v61
    v_mfma_f32_16x16x32_bf16 v[200:203], a[24:27], v[44:47], v[200:203]
    buffer_load_dwordx4 v[144:147], v3, s[20:23], s27 offen offset:2048
    v_mfma_f32_16x16x32_bf16 v[188:191], a[28:31], v[40:43], v[188:191]
    ds_read_b128 a[8:11], v6 offset:18432
    v_mfma_f32_16x16x32_bf16 v[204:207], a[28:31], v[44:47], v[204:207]
    buffer_load_dwordx4 v[148:151], v3, s[20:23], s27 offen offset:3072
    v_mfma_f32_16x16x32_bf16 v[240:243], v[56:59], v[56:59], v[240:243]
    ds_read_b128 a[12:15], v6 offset:19456
    v_mfma_f32_16x16x32_bf16 v[244:247], a[56:59], v[56:59], v[244:247]
    v_mfma_f32_16x16x32_bf16 v[248:251], v[60:63], v[60:63], v[248:251]
    buffer_load_dwordx4 v[152:155], v4, s[20:23], s27 offen offset:0
    v_mfma_f32_16x16x32_bf16 v[252:255], a[56:59], v[60:63], v[252:255]
    s_waitcnt lgkmcnt(2)
    v_mfma_f32_16x16x32_bf16 v[176:179], a[0:3], v[48:51], v[176:179]
    v_mfma_f32_16x16x32_bf16 v[192:195], a[0:3], v[52:55], v[192:195]
    buffer_load_dwordx4 v[156:159], v4, s[20:23], s27 offen offset:1024
    v_mfma_f32_16x16x32_bf16 v[180:183], a[4:7], v[48:51], v[180:183]
    s_barrier
    ds_read_b128 a[16:19], v6 offset:20480
    s_waitcnt vmcnt(22)
    v_max_u32 v2, v64, v68
    v_mfma_f32_16x16x32_bf16 v[196:199], a[4:7], v[52:55], v[196:199]
    v_cmp_eq_u32 vcc, -1, v2
    s_cbranch_vccnz .hr59
.hr59b:
    v_swap_b32 v66, v68
    s_waitcnt lgkmcnt(1)
    v_mfma_f32_16x16x32_bf16 v[184:187], a[8:11], v[48:51], v[184:187]
    buffer_load_dword v239, v238, s[20:23], s56 offen sc1
    ds_read_b128 a[20:23], v6 offset:21504
    v_swap_b32 v67, v69
    v_mfma_f32_16x16x32_bf16 v[200:203], a[8:11], v[52:55], v[200:203]
    buffer_load_dwordx4 v[160:163], v4, s[20:23], s27 offen offset:2048
    v_mfma_f32_16x16x32_bf16 v[188:191], a[12:15], v[48:51], v[188:191]
    ds_read_b128 a[24:27], v6 offset:22528
    v_mfma_f32_16x16x32_bf16 v[204:207], a[12:15], v[52:55], v[204:207]
    buffer_load_dwordx4 v[164:167], v4, s[20:23], s27 offen offset:3072
    v_mfma_f32_16x16x32_bf16 v[240:243], v[64:67], v[64:67], v[240:243]
    ds_read_b128 a[28:31], v6 offset:23552
    v_mfma_f32_16x16x32_bf16 v[244:247], a[56:59], v[64:67], v[244:247]
    v_mfma_f32_16x16x32_bf16 v[248:251], v[68:71], v[68:71], v[248:251]
    buffer_load_dwordx4 v[168:171], v5, s[20:23], s27 offen offset:0
    v_mfma_f32_16x16x32_bf16 v[252:255], a[56:59], v[68:71], v[252:255]
    s_waitcnt lgkmcnt(2)
    v_mfma_f32_16x16x32_bf16 v[176:179], a[16:19], v[56:59], v[176:179]
    v_mfma_f32_16x16x32_bf16 v[192:195], a[16:19], v[60:63], v[192:195]
    buffer_load_dwordx4 v[172:175], v5, s[20:23], s27 offen offset:1024
    v_mfma_f32_16x16x32_bf16 v[180:183], a[20:23], v[56:59], v[180:183]
    s_mov_b64 exec, 1
    buffer_store_dword v3, off, s[20:23], s62 offset:0 sc1
    s_mov_b64 exec, -1
    ds_read_b128 a[0:3], v6 offset:24576
    s_waitcnt vmcnt(26)
    v_max_u32 v2, v72, v76
    v_mfma_f32_16x16x32_bf16 v[196:199], a[20:23], v[60:63], v[196:199]
    v_cmp_eq_u32 vcc, -1, v2
    s_cbranch_vccnz .hr60
.hr60b:
    v_swap_b32 v74, v76
    s_waitcnt lgkmcnt(1)
    v_mfma_f32_16x16x32_bf16 v[184:187], a[24:27], v[56:59], v[184:187]
    ds_read_b128 a[4:7], v6 offset:25600
    v_swap_b32 v75, v77
    v_mfma_f32_16x16x32_bf16 v[200:203], a[24:27], v[60:63], v[200:203]
    v_mfma_f32_16x16x32_bf16 v[188:191], a[28:31], v[56:59], v[188:191]
    ds_read_b128 a[8:11], v6 offset:26624
    v_mfma_f32_16x16x32_bf16 v[204:207], a[28:31], v[60:63], v[204:207]
    v_mfma_f32_16x16x32_bf16 v[240:243], v[72:75], v[72:75], v[240:243]
    ds_read_b128 a[12:15], v6 offset:27648
    v_mfma_f32_16x16x32_bf16 v[244:247], a[56:59], v[72:75], v[244:247]
    v_mfma_f32_16x16x32_bf16 v[248:251], v[76:79], v[76:79], v[248:251]
    v_mfma_f32_16x16x32_bf16 v[252:255], a[56:59], v[76:79], v[252:255]
    s_waitcnt lgkmcnt(2)
    v_mfma_f32_16x16x32_bf16 v[176:179], a[0:3], v[64:67], v[176:179]
    v_mfma_f32_16x16x32_bf16 v[192:195], a[0:3], v[68:71], v[192:195]
    v_mfma_f32_16x16x32_bf16 v[180:183], a[4:7], v[64:67], v[180:183]
    ds_read_b128 a[16:19], v6 offset:28672
    s_waitcnt vmcnt(24)
    v_max_u32 v2, v80, v84
    v_mfma_f32_16x16x32_bf16 v[196:199], a[4:7], v[68:71], v[196:199]
    v_cmp_eq_u32 vcc, -1, v2
    s_cbranch_vccnz .hr61
.hr61b:
    v_swap_b32 v82, v84
    s_waitcnt lgkmcnt(1)
    v_mfma_f32_16x16x32_bf16 v[184:187], a[8:11], v[64:67], v[184:187]
    ds_read_b128 a[20:23], v6 offset:29696
    v_swap_b32 v83, v85
    v_mfma_f32_16x16x32_bf16 v[200:203], a[8:11], v[68:71], v[200:203]
    v_mfma_f32_16x16x32_bf16 v[188:191], a[12:15], v[64:67], v[188:191]
    ds_read_b128 a[24:27], v6 offset:30720
    v_mfma_f32_16x16x32_bf16 v[204:207], a[12:15], v[68:71], v[204:207]
    v_mfma_f32_16x16x32_bf16 v[240:243], v[80:83], v[80:83], v[240:243]
    ds_read_b128 a[28:31], v6 offset:31744
    v_mfma_f32_16x16x32_bf16 v[244:247], a[56:59], v[80:83], v[244:247]
    v_mfma_f32_16x16x32_bf16 v[248:251], v[84:87], v[84:87], v[248:251]
    v_mfma_f32_16x16x32_bf16 v[252:255], a[56:59], v[84:87], v[252:255]
    s_waitcnt lgkmcnt(2)
    v_mfma_f32_16x16x32_bf16 v[176:179], a[16:19], v[72:75], v[176:179]
    v_mfma_f32_16x16x32_bf16 v[192:195], a[16:19], v[76:79], v[192:195]
    v_mfma_f32_16x16x32_bf16 v[180:183], a[20:23], v[72:75], v[180:183]
    ds_read_b128 a[0:3], v6 offset:32768
    s_waitcnt vmcnt(22)
    v_max_u32 v2, v88, v92
    v_mfma_f32_16x16x32_bf16 v[196:199], a[20:23], v[76:79], v[196:199]
    v_cmp_eq_u32 vcc, -1, v2
    s_cbranch_vccnz .hr62
.hr62b:
    v_swap_b32 v90, v92
    s_waitcnt lgkmcnt(1)
    v_mfma_f32_16x16x32_bf16 v[184:187], a[24:27], v[72:75], v[184:187]
    ds_read_b128 a[4:7], v6 offset:33792
    v_swap_b32 v91, v93
    v_mfma_f32_16x16x32_bf16 v[200:203], a[24:27], v[76:79], v[200:203]
    v_mfma_f32_16x16x32_bf16 v[188:191], a[28:31], v[72:75], v[188:191]
    ds_read_b128 a[8:11], v6 offset:34816
    v_mfma_f32_16x16x32_bf16 v[204:207], a[28:31], v[76:79], v[204:207]
    v_mfma_f32_16x16x32_bf16 v[240:243], v[88:91], v[88:91], v[240:243]
    s_waitcnt vmcnt(5)
    v_cmp_eq_u32 vcc, -1, v239
    s_cbranch_vccnz .rl63
.rl63b:
    ds_read_b128 a[12:15], v6 offset:35840
    v_mfma_f32_16x16x32_bf16 v[244:247], a[56:59], v[88:91], v[244:247]
    buffer_load_dwordx4 a[60:63], v3, s[20:23], s44 offen offset:0
    v_mfma_f32_16x16x32_bf16 v[248:251], v[92:95], v[92:95], v[248:251]
    buffer_load_dwordx4 a[64:67], v3, s[20:23], s44 offen offset:1024
    v_mfma_f32_16x16x32_bf16 v[252:255], a[56:59], v[92:95], v[252:255]
    buffer_load_dwordx4 a[68:71], v3, s[20:23], s44 offen offset:2048
    s_waitcnt lgkmcnt(2)
    v_mfma_f32_16x16x32_bf16 v[176:179], a[0:3], v[80:83], v[176:179]
    v_mfma_f32_16x16x32_bf16 v[192:195], a[0:3], v[84:87], v[192:195]
    buffer_load_dwordx4 a[72:75], v3, s[20:23], s44 offen offset:3072
    v_mfma_f32_16x16x32_bf16 v[180:183], a[4:7], v[80:83], v[180:183]
    ds_read_b128 a[16:19], v6 offset:36864
    v_max_u32 v2, v96, v100
    v_mfma_f32_16x16x32_bf16 v[196:199], a[4:7], v[84:87], v[196:199]
    v_cmp_eq_u32 vcc, -1, v2
    s_cbranch_vccnz .hr64
.hr64b:
    v_swap_b32 v98, v100
    s_waitcnt lgkmcnt(1)
    v_mfma_f32_16x16x32_bf16 v[184:187], a[8:11], v[80:83], v[184:187]
    ds_read_b128 a[20:23], v6 offset:37888
    v_swap_b32 v99, v101
    v_mfma_f32_16x16x32_bf16 v[200:203], a[8:11], v[84:87], v[200:203]
    buffer_load_dwordx4 a[76:79], v4, s[20:23], s44 offen offset:0
    s_add_u32 s44, s44, 20480
    v_mfma_f32_16x16x32_bf16 v[188:191], a[12:15], v[80:83], v[188:191]
    ds_read_b128 a[24:27], v6 offset:38912
    v_mfma_f32_16x16x32_bf16 v[204:207], a[12:15], v[84:87], v[204:207]
    v_mfma_f32_16x16x32_bf16 v[240:243], v[96:99], v[96:99], v[240:243]
    ds_read_b128 a[28:31], v6 offset:39936
    v_mfma_f32_16x16x32_bf16 v[244:247], a[56:59], v[96:99], v[244:247]
    buffer_load_dwordx4 a[80:83], v3, s[20:23], s45 offen offset:0
    v_mfma_f32_16x16x32_bf16 v[248:251], v[100:103], v[100:103], v[248:251]
    v_mfma_f32_16x16x32_bf16 v[252:255], a[56:59], v[100:103], v[252:255]
    s_waitcnt lgkmcnt(2)
    v_mfma_f32_16x16x32_bf16 v[176:179], a[16:19], v[88:91], v[176:179]
    v_mfma_f32_16x16x32_bf16 v[192:195], a[16:19], v[92:95], v[192:195]
    buffer_load_dwordx4 a[84:87], v3, s[20:23], s45 offen offset:1024
    v_mfma_f32_16x16x32_bf16 v[180:183], a[20:23], v[88:91], v[180:183]
    s_barrier
    ds_read_b128 a[0:3], v6 offset:40960
    v_max_u32 v2, v104, v108
    v_mfma_f32_16x16x32_bf16 v[196:199], a[20:23], v[92:95], v[196:199]
    v_cmp_eq_u32 vcc, -1, v2
    s_cbranch_vccnz .hr65
.hr65b:
    v_swap_b32 v106, v108
    s_waitcnt lgkmcnt(1)
    v_mfma_f32_16x16x32_bf16 v[184:187], a[24:27], v[88:91], v[184:187]
    ds_read_b128 a[4:7], v6 offset:41984
    v_swap_b32 v107, v109
    v_mfma_f32_16x16x32_bf16 v[200:203], a[24:27], v[92:95], v[200:203]
    s_add_u32 m0, s34, 61440
    s_nop 0
    buffer_load_dwordx4 v3, s[20:23], s28 offen offset:0 lds
    v_mfma_f32_16x16x32_bf16 v[188:191], a[28:31], v[88:91], v[188:191]
    ds_read_b128 a[8:11], v6 offset:43008
    v_mfma_f32_16x16x32_bf16 v[204:207], a[28:31], v[92:95], v[204:207]
    v_mfma_f32_16x16x32_bf16 v[240:243], v[104:107], v[104:107], v[240:243]
    ds_read_b128 a[12:15], v6 offset:44032
    v_mfma_f32_16x16x32_bf16 v[244:247], a[56:59], v[104:107], v[244:247]
    buffer_load_dwordx4 v3, s[20:23], s28 offen offset:1024 lds
    v_mfma_f32_16x16x32_bf16 v[248:251], v[108:111], v[108:111], v[248:251]
    v_mfma_f32_16x16x32_bf16 v[252:255], a[56:59], v[108:111], v[252:255]
    s_waitcnt lgkmcnt(2)
    v_mfma_f32_16x16x32_bf16 v[176:179], a[0:3], v[96:99], v[176:179]
    v_mfma_f32_16x16x32_bf16 v[192:195], a[0:3], v[100:103], v[192:195]
    buffer_load_dwordx4 v3, s[20:23], s28 offen offset:2048 lds
    v_mfma_f32_16x16x32_bf16 v[180:183], a[4:7], v[96:99], v[180:183]
    ds_read_b128 a[16:19], v6 offset:45056
    v_max_u32 v2, v112, v116
    v_mfma_f32_16x16x32_bf16 v[196:199], a[4:7], v[100:103], v[196:199]
    v_cmp_eq_u32 vcc, -1, v2
    s_cbranch_vccnz .hr66
.hr66b:
    v_swap_b32 v114, v116
    s_waitcnt lgkmcnt(1)
    v_mfma_f32_16x16x32_bf16 v[184:187], a[8:11], v[96:99], v[184:187]
    ds_read_b128 a[20:23], v6 offset:46080
    v_swap_b32 v115, v117
    v_mfma_f32_16x16x32_bf16 v[200:203], a[8:11], v[100:103], v[200:203]
    buffer_load_dwordx4 v3, s[20:23], s28 offen offset:3072 lds
    v_mfma_f32_16x16x32_bf16 v[188:191], a[12:15], v[96:99], v[188:191]
    ds_read_b128 a[24:27], v6 offset:47104
    v_mfma_f32_16x16x32_bf16 v[204:207], a[12:15], v[100:103], v[204:207]
    v_mfma_f32_16x16x32_bf16 v[240:243], v[112:115], v[112:115], v[240:243]
    ds_read_b128 a[28:31], v6 offset:48128
    v_mfma_f32_16x16x32_bf16 v[244:247], a[56:59], v[112:115], v[244:247]
    s_add_u32 m0, s34, 65536
    s_nop 0
    buffer_load_dwordx4 v4, s[20:23], s28 offen offset:0 lds
    v_mfma_f32_16x16x32_bf16 v[248:251], v[116:119], v[116:119], v[248:251]
    v_mfma_f32_16x16x32_bf16 v[252:255], a[56:59], v[116:119], v[252:255]
    s_waitcnt lgkmcnt(2)
    v_mfma_f32_16x16x32_bf16 v[176:179], a[16:19], v[104:107], v[176:179]
    v_mfma_f32_16x16x32_bf16 v[192:195], a[16:19], v[108:111], v[192:195]
    buffer_load_dwordx4 a[88:91], v3, s[20:23], s45 offen offset:2048
    v_mfma_f32_16x16x32_bf16 v[180:183], a[20:23], v[104:107], v[180:183]
    ds_read_b128 a[0:3], v6 offset:49152
    v_max_u32 v2, v120, v124
    v_mfma_f32_16x16x32_bf16 v[196:199], a[20:23], v[108:111], v[196:199]
    v_cmp_eq_u32 vcc, -1, v2
    s_cbranch_vccnz .hr67
.hr67b:
    v_swap_b32 v122, v124
    s_waitcnt lgkmcnt(1)
    v_mfma_f32_16x16x32_bf16 v[184:187], a[24:27], v[104:107], v[184:187]
    ds_read_b128 a[4:7], v6 offset:50176
    v_swap_b32 v123, v125
    v_mfma_f32_16x16x32_bf16 v[200:203], a[24:27], v[108:111], v[200:203]
    buffer_load_dwordx4 a[92:95], v3, s[20:23], s45 offen offset:3072
    v_mfma_f32_16x16x32_bf16 v[188:191], a[28:31], v[104:107], v[188:191]
    ds_read_b128 a[8:11], v6 offset:51200
    v_mfma_f32_16x16x32_bf16 v[204:207], a[28:31], v[108:111], v[204:207]
    v_mfma_f32_16x16x32_bf16 v[240:243], v[120:123], v[120:123], v[240:243]
    ds_read_b128 a[12:15], v6 offset:52224
    v_mfma_f32_16x16x32_bf16 v[244:247], a[56:59], v[120:123], v[244:247]
    buffer_load_dwordx4 a[96:99], v4, s[20:23], s45 offen offset:0
    s_add_u32 s45, s45, 20480
    v_mfma_f32_16x16x32_bf16 v[248:251], v[124:127], v[124:127], v[248:251]
    v_mfma_f32_16x16x32_bf16 v[252:255], a[56:59], v[124:127], v[252:255]
    s_waitcnt lgkmcnt(2)
    v_mfma_f32_16x16x32_bf16 v[176:179], a[0:3], v[112:115], v[176:179]
    v_mfma_f32_16x16x32_bf16 v[192:195], a[0:3], v[116:119], v[192:195]
    buffer_load_dwordx4 a[100:103], v3, s[20:23], s46 offen offset:0
    v_mfma_f32_16x16x32_bf16 v[180:183], a[4:7], v[112:115], v[180:183]
    ds_read_b128 a[16:19], v6 offset:53248
    v_max_u32 v2, v128, v132
    v_mfma_f32_16x16x32_bf16 v[196:199], a[4:7], v[116:119], v[196:199]
    v_cmp_eq_u32 vcc, -1, v2
    s_cbranch_vccnz .hr68
.hr68b:
    v_swap_b32 v130, v132
    s_waitcnt lgkmcnt(1)
    v_mfma_f32_16x16x32_bf16 v[184:187], a[8:11], v[112:115], v[184:187]
    ds_read_b128 a[20:23], v6 offset:54272
    v_swap_b32 v131, v133
    v_mfma_f32_16x16x32_bf16 v[200:203], a[8:11], v[116:119], v[200:203]
    buffer_load_dwordx4 a[104:107], v3, s[20:23], s46 offen offset:1024
    v_mfma_f32_16x16x32_bf16 v[188:191], a[12:15], v[112:115], v[188:191]
    ds_read_b128 a[24:27], v6 offset:55296
    v_mfma_f32_16x16x32_bf16 v[204:207], a[12:15], v[116:119], v[204:207]
    v_mfma_f32_16x16x32_bf16 v[240:243], v[128:131], v[128:131], v[240:243]
    ds_read_b128 a[28:31], v6 offset:56320
    v_mfma_f32_16x16x32_bf16 v[244:247], a[56:59], v[128:131], v[244:247]
    buffer_load_dwordx4 a[108:111], v3, s[20:23], s46 offen offset:2048
    v_mfma_f32_16x16x32_bf16 v[248:251], v[132:135], v[132:135], v[248:251]
    v_mfma_f32_16x16x32_bf16 v[252:255], a[56:59], v[132:135], v[252:255]
    s_waitcnt lgkmcnt(2)
    v_mfma_f32_16x16x32_bf16 v[176:179], a[16:19], v[120:123], v[176:179]
    v_mfma_f32_16x16x32_bf16 v[192:195], a[16:19], v[124:127], v[192:195]
    buffer_load_dwordx4 a[112:115], v3, s[20:23], s46 offen offset:3072
    v_mfma_f32_16x16x32_bf16 v[180:183], a[20:23], v[120:123], v[180:183]
    ds_read_b128 a[0:3], v6 offset:57344
    v_max_u32 v2, v136, v140
    v_mfma_f32_16x16x32_bf16 v[196:199], a[20:23], v[124:127], v[196:199]
    v_cmp_eq_u32 vcc, -1, v2
    s_cbranch_vccnz .hr69
.hr69b:
    v_swap_b32 v138, v140
    s_waitcnt lgkmcnt(1)
    v_mfma_f32_16x16x32_bf16 v[184:187], a[24:27], v[120:123], v[184:187]
    ds_read_b128 a[4:7], v6 offset:58368
    v_swap_b32 v139, v141
    v_mfma_f32_16x16x32_bf16 v[200:203], a[24:27], v[124:127], v[200:203]
    buffer_load_dwordx4 a[116:119], v4, s[20:23], s46 offen offset:0
    s_add_u32 s46, s46, 20480
    v_mfma_f32_16x16x32_bf16 v[188:191], a[28:31], v[120:123], v[188:191]
    ds_read_b128 a[8:11], v6 offset:59392
    v_mfma_f32_16x16x32_bf16 v[204:207], a[28:31], v[124:127], v[204:207]
    v_mfma_f32_16x16x32_bf16 v[240:243], v[136:139], v[136:139], v[240:243]
    ds_read_b128 a[12:15], v6 offset:60416
    v_mfma_f32_16x16x32_bf16 v[244:247], a[56:59], v[136:139], v[244:247]
    buffer_load_dwordx4 a[120:123], v3, s[20:23], s47 offen offset:0
    v_mfma_f32_16x16x32_bf16 v[248:251], v[140:143], v[140:143], v[248:251]
    v_mfma_f32_16x16x32_bf16 v[252:255], a[56:59], v[140:143], v[252:255]
    s_waitcnt lgkmcnt(2)
    v_mfma_f32_16x16x32_bf16 v[176:179], a[0:3], v[128:131], v[176:179]
    v_mfma_f32_16x16x32_bf16 v[192:195], a[0:3], v[132:135], v[192:195]
    buffer_load_dwordx4 a[124:127], v3, s[20:23], s47 offen offset:1024
    v_mfma_f32_16x16x32_bf16 v[180:183], a[4:7], v[128:131], v[180:183]
    s_barrier
    ds_read_b128 a[16:19], v7 offset:0
    v_max_u32 v2, v144, v148
    v_mfma_f32_16x16x32_bf16 v[196:199], a[4:7], v[132:135], v[196:199]
    v_cmp_eq_u32 vcc, -1, v2
    s_cbranch_vccnz .hr70
.hr70b:
    v_swap_b32 v146, v148
    s_waitcnt lgkmcnt(1)
    v_mfma_f32_16x16x32_bf16 v[184:187], a[8:11], v[128:131], v[184:187]
    ds_read_b128 a[20:23], v7 offset:1024
    v_swap_b32 v147, v149
    v_mfma_f32_16x16x32_bf16 v[200:203], a[8:11], v[132:135], v[200:203]
    s_add_u32 m0, s34, 81920
    s_nop 0
    buffer_load_dwordx4 v3, s[20:23], s29 offen offset:0 lds
    v_mfma_f32_16x16x32_bf16 v[188:191], a[12:15], v[128:131], v[188:191]
    ds_read_b128 a[24:27], v7 offset:2048
    v_mfma_f32_16x16x32_bf16 v[204:207], a[12:15], v[132:135], v[204:207]
    v_mfma_f32_16x16x32_bf16 v[240:243], v[144:147], v[144:147], v[240:243]
    ds_read_b128 a[28:31], v7 offset:3072
    v_mfma_f32_16x16x32_bf16 v[244:247], a[56:59], v[144:147], v[244:247]
    buffer_load_dwordx4 v3, s[20:23], s29 offen offset:1024 lds
    v_mfma_f32_16x16x32_bf16 v[248:251], v[148:151], v[148:151], v[248:251]
    v_mfma_f32_16x16x32_bf16 v[252:255], a[56:59], v[148:151], v[252:255]
    s_waitcnt lgkmcnt(2)
    v_mfma_f32_16x16x32_bf16 v[176:179], a[16:19], v[136:139], v[176:179]
    v_mfma_f32_16x16x32_bf16 v[192:195], a[16:19], v[140:143], v[192:195]
    buffer_load_dwordx4 v3, s[20:23], s29 offen offset:2048 lds
    v_mfma_f32_16x16x32_bf16 v[180:183], a[20:23], v[136:139], v[180:183]
    ds_read_b128 a[0:3], v7 offset:4096
    v_max_u32 v2, v152, v156
    v_mfma_f32_16x16x32_bf16 v[196:199], a[20:23], v[140:143], v[196:199]
    v_cmp_eq_u32 vcc, -1, v2
    s_cbranch_vccnz .hr71
.hr71b:
    v_swap_b32 v154, v156
    s_waitcnt lgkmcnt(1)
    v_mfma_f32_16x16x32_bf16 v[184:187], a[24:27], v[136:139], v[184:187]
    ds_read_b128 a[4:7], v7 offset:5120
    v_swap_b32 v155, v157
    v_mfma_f32_16x16x32_bf16 v[200:203], a[24:27], v[140:143], v[200:203]
    buffer_load_dwordx4 v3, s[20:23], s29 offen offset:3072 lds
    v_mfma_f32_16x16x32_bf16 v[188:191], a[28:31], v[136:139], v[188:191]
    ds_read_b128 a[8:11], v7 offset:6144
    v_mfma_f32_16x16x32_bf16 v[204:207], a[28:31], v[140:143], v[204:207]
    v_mfma_f32_16x16x32_bf16 v[240:243], v[152:155], v[152:155], v[240:243]
    ds_read_b128 a[12:15], v7 offset:7168
    v_mfma_f32_16x16x32_bf16 v[244:247], a[56:59], v[152:155], v[244:247]
    s_add_u32 m0, s34, 86016
    s_nop 0
    buffer_load_dwordx4 v4, s[20:23], s29 offen offset:0 lds
    v_mfma_f32_16x16x32_bf16 v[248:251], v[156:159], v[156:159], v[248:251]
    v_mfma_f32_16x16x32_bf16 v[252:255], a[56:59], v[156:159], v[252:255]
    s_waitcnt lgkmcnt(2)
    v_mfma_f32_16x16x32_bf16 v[176:179], a[0:3], v[144:147], v[176:179]
    v_mfma_f32_16x16x32_bf16 v[192:195], a[0:3], v[148:151], v[192:195]
    buffer_load_dwordx4 a[128:131], v3, s[20:23], s47 offen offset:2048
    v_mfma_f32_16x16x32_bf16 v[180:183], a[4:7], v[144:147], v[180:183]
    ds_read_b128 a[16:19], v7 offset:8192
    s_waitcnt vmcnt(31)
    v_max_u32 v2, v160, v164
    v_mfma_f32_16x16x32_bf16 v[196:199], a[4:7], v[148:151], v[196:199]
    v_cmp_eq_u32 vcc, -1, v2
    s_cbranch_vccnz .hr72
.hr72b:
    v_swap_b32 v162, v164
    s_waitcnt lgkmcnt(1)
    v_mfma_f32_16x16x32_bf16 v[184:187], a[8:11], v[144:147], v[184:187]
    ds_read_b128 a[20:23], v7 offset:9216
    v_swap_b32 v163, v165
    v_mfma_f32_16x16x32_bf16 v[200:203], a[8:11], v[148:151], v[200:203]
    buffer_load_dwordx4 a[132:135], v3, s[20:23], s47 offen offset:3072
    v_mfma_f32_16x16x32_bf16 v[188:191], a[12:15], v[144:147], v[188:191]
    ds_read_b128 a[24:27], v7 offset:10240
    v_mfma_f32_16x16x32_bf16 v[204:207], a[12:15], v[148:151], v[204:207]
    v_mfma_f32_16x16x32_bf16 v[240:243], v[160:163], v[160:163], v[240:243]
    ds_read_b128 a[28:31], v7 offset:11264
    v_mfma_f32_16x16x32_bf16 v[244:247], a[56:59], v[160:163], v[244:247]
    buffer_load_dwordx4 a[136:139], v4, s[20:23], s47 offen offset:0
    s_add_u32 s47, s47, 20480
    v_mfma_f32_16x16x32_bf16 v[248:251], v[164:167], v[164:167], v[248:251]
    v_mfma_f32_16x16x32_bf16 v[252:255], a[56:59], v[164:167], v[252:255]
    s_waitcnt lgkmcnt(2)
    v_mfma_f32_16x16x32_bf16 v[176:179], a[16:19], v[152:155], v[176:179]
    v_mfma_f32_16x16x32_bf16 v[192:195], a[16:19], v[156:159], v[192:195]
    buffer_load_dwordx4 a[140:143], v3, s[20:23], s44 offen offset:0
    v_mfma_f32_16x16x32_bf16 v[180:183], a[20:23], v[152:155], v[180:183]
    ds_read_b128 a[0:3], v7 offset:12288
    s_waitcnt vmcnt(32)
    v_max_u32 v2, v168, v172
    v_mfma_f32_16x16x32_bf16 v[196:199], a[20:23], v[156:159], v[196:199]
    v_cmp_eq_u32 vcc, -1, v2
    s_cbranch_vccnz .hr73
.hr73b:
    v_swap_b32 v170, v172
    s_waitcnt lgkmcnt(1)
    v_mfma_f32_16x16x32_bf16 v[184:187], a[24:27], v[152:155], v[184:187]
    ds_read_b128 a[4:7], v7 offset:13312
    v_swap_b32 v171, v173
    v_mfma_f32_16x16x32_bf16 v[200:203], a[24:27], v[156:159], v[200:203]
    buffer_load_dwordx4 a[144:147], v3, s[20:23], s44 offen offset:1024
    v_mfma_f32_16x16x32_bf16 v[188:191], a[28:31], v[152:155], v[188:191]
    ds_read_b128 a[8:11], v7 offset:14336
    v_mfma_f32_16x16x32_bf16 v[204:207], a[28:31], v[156:159], v[204:207]
    v_mfma_f32_16x16x32_bf16 v[240:243], v[168:171], v[168:171], v[240:243]
    ds_read_b128 a[12:15], v7 offset:15360
    v_mfma_f32_16x16x32_bf16 v[244:247], a[56:59], v[168:171], v[244:247]
    buffer_load_dwordx4 a[148:151], v3, s[20:23], s44 offen offset:2048
    v_mfma_f32_16x16x32_bf16 v[248:251], v[172:175], v[172:175], v[248:251]
    ds_read_b128 a[16:19], v7 offset:16384
    v_mfma_f32_16x16x32_bf16 v[252:255], a[56:59], v[172:175], v[252:255]
    s_waitcnt lgkmcnt(3)
    v_mfma_f32_16x16x32_bf16 v[176:179], a[0:3], v[160:163], v[176:179]
    ds_read_b128 a[20:23], v7 offset:17408
    v_mfma_f32_16x16x32_bf16 v[192:195], a[0:3], v[164:167], v[192:195]
    buffer_load_dwordx4 a[152:155], v3, s[20:23], s44 offen offset:3072
    v_cndmask_b32_e64 v240, v240, v241, s[52:53]
    v_cndmask_b32_e64 v248, v248, v249, s[52:53]
    v_mfma_f32_16x16x32_bf16 v[180:183], a[4:7], v[160:163], v[180:183]
    ds_read_b128 a[24:27], v7 offset:18432
    v_cndmask_b32_e64 v242, v242, v243, s[52:53]
    v_mfma_f32_16x16x32_bf16 v[196:199], a[4:7], v[164:167], v[196:199]
    v_cndmask_b32_e64 v250, v250, v251, s[52:53]
    v_mul_f32 v244, s58, v244
    s_waitcnt lgkmcnt(3)
    v_mfma_f32_16x16x32_bf16 v[184:187], a[8:11], v[160:163], v[184:187]
    ds_read_b128 a[28:31], v7 offset:19456
    v_mul_f32 v252, s58, v252
    v_mfma_f32_16x16x32_bf16 v[200:203], a[8:11], v[164:167], v[200:203]
    buffer_load_dwordx4 a[156:159], v4, s[20:23], s44 offen offset:0
    s_add_u32 s44, s44, 20480
    v_cndmask_b32_e64 v240, v240, v242, s[54:55]
    v_cndmask_b32_e64 v248, v248, v250, s[54:55]
    v_mfma_f32_16x16x32_bf16 v[188:191], a[12:15], v[160:163], v[188:191]
    v_cvt_pk_bf16_f32 v245, -v244, -v244
    v_cvt_pk_bf16_f32 v253, -v252, -v252
    v_mfma_f32_16x16x32_bf16 v[204:207], a[12:15], v[164:167], v[204:207]
    ds_bpermute_b32 v240, v13, v240
    ds_bpermute_b32 v248, v13, v248
    s_waitcnt lgkmcnt(4)
    v_mfma_f32_16x16x32_bf16 v[176:179], a[16:19], v[168:171], v[176:179]
    v_accvgpr_write_b32 a48, v245
    v_accvgpr_write_b32 a52, v253
    v_mfma_f32_16x16x32_bf16 v[192:195], a[16:19], v[172:175], v[192:195]
    buffer_load_dwordx4 a[160:163], v3, s[20:23], s45 offen offset:0
    v_accvgpr_write_b32 a51, v245
    v_accvgpr_write_b32 a55, v253
    v_mfma_f32_16x16x32_bf16 v[180:183], a[20:23], v[168:171], v[180:183]
    s_waitcnt lgkmcnt(1)
    s_waitcnt lgkmcnt(0)
    v_mfma_f32_16x16x32_bf16 v[196:199], a[20:23], v[172:175], v[196:199]
    v_mul_f32 v240, s58, v240
    v_mul_f32 v248, s58, v248
    v_mfma_f32_16x16x32_bf16 v[184:187], a[24:27], v[168:171], v[184:187]
    v_fma_f32 v240, -v244, v244, v240
    v_fma_f32 v248, -v252, v252, v248
    v_mfma_f32_16x16x32_bf16 v[200:203], a[24:27], v[172:175], v[200:203]
    buffer_load_dwordx4 a[164:167], v3, s[20:23], s45 offen offset:1024
    v_max_f32 v240, 0, v240
    v_max_f32 v248, 0, v248
    v_mfma_f32_16x16x32_bf16 v[188:191], a[28:31], v[168:171], v[188:191]
    s_barrier
    ds_read_b128 a[0:3], v7 offset:20480
    v_cvt_pk_bf16_f32 v240, v240, v240
    v_mfma_f32_16x16x32_bf16 v[204:207], a[28:31], v[172:175], v[204:207]
    v_cvt_pk_bf16_f32 v248, v248, v248
    v_and_b32 v240, s59, v240
    v_mfma_f32_16x16x16_bf16 v[176:179], a[32:33], a[48:49], v[176:179]
    ds_read_b128 a[4:7], v7 offset:21504
    v_mfma_f32_16x16x16_bf16 v[192:195], a[32:33], a[52:53], v[192:195]
    s_add_u32 m0, s34, 102400
    s_nop 0
    buffer_load_dwordx4 v3, s[20:23], s30 offen offset:0 lds
    v_and_b32 v248, s59, v248
    v_mfma_f32_16x16x16_bf16 v[180:183], a[32:33], a[50:51], v[180:183]
    ds_read_b128 a[8:11], v7 offset:22528
    v_mfma_f32_16x16x16_bf16 v[196:199], a[32:33], a[54:55], v[196:199]
    v_add_f32 v240, 0x3727c5ac, v240
    v_mfma_f32_16x16x16_bf16 v[184:187], a[34:35], a[48:49], v[184:187]
    ds_read_b128 a[12:15], v7 offset:23552
    v_mfma_f32_16x16x16_bf16 v[200:203], a[34:35], a[52:53], v[200:203]
    buffer_load_dwordx4 v3, s[20:23], s30 offen offset:1024 lds
    v_add_f32 v248, 0x3727c5ac, v248
    v_mfma_f32_16x16x16_bf16 v[188:191], a[34:35], a[50:51], v[188:191]
    ds_read_b128 a[16:19], v7 offset:24576
    v_mfma_f32_16x16x16_bf16 v[204:207], a[34:35], a[54:55], v[204:207]
    v_cvt_pk_bf16_f32 v240, v240, v240
    s_waitcnt lgkmcnt(3)
    v_mfma_f32_16x16x32_bf16 v[208:211], a[0:3], v[16:19], 0
    ds_read_b128 a[20:23], v7 offset:25600
    v_cvt_pk_bf16_f32 v248, v248, v248
    v_mfma_f32_16x16x32_bf16 v[224:227], a[0:3], v[20:23], 0
    buffer_load_dwordx4 v3, s[20:23], s30 offen offset:2048 lds
    v_and_b32 v240, s59, v240
    v_and_b32 v248, s59, v248
    v_mfma_f32_16x16x32_bf16 v[212:215], a[4:7], v[16:19], 0
    ds_read_b128 a[24:27], v7 offset:26624
    v_mfma_f32_16x16x32_bf16 v[228:231], a[4:7], v[20:23], 0
    v_sqrt_f32 v240, v240
    s_waitcnt lgkmcnt(3)
    v_mfma_f32_16x16x32_bf16 v[216:219], a[8:11], v[16:19], 0
    ds_read_b128 a[28:31], v7 offset:27648
    v_mfma_f32_16x16x32_bf16 v[232:235], a[8:11], v[20:23], 0
    buffer_load_dwordx4 v3, s[20:23], s30 offen offset:3072 lds
    v_sqrt_f32 v248, v248
    v_mfma_f32_16x16x32_bf16 v[220:223], a[12:15], v[16:19], 0
    ds_read_b128 a[0:3], v7 offset:28672
    v_cvt_pk_bf16_f32 v240, v240, v240
    v_mfma_f32_16x16x32_bf16 v[236:239], a[12:15], v[20:23], 0
    v_cvt_pk_bf16_f32 v248, v248, v248
    v_and_b32 v240, s59, v240
    s_waitcnt lgkmcnt(3)
    v_mfma_f32_16x16x32_bf16 v[208:211], a[16:19], v[24:27], v[208:211]
    ds_read_b128 a[4:7], v7 offset:29696
    v_and_b32 v248, s59, v248
    v_mfma_f32_16x16x32_bf16 v[224:227], a[16:19], v[28:31], v[224:227]
    s_add_u32 m0, s34, 106496
    s_nop 0
    buffer_load_dwordx4 v4, s[20:23], s30 offen offset:0 lds
    v_rcp_f32 v14, v240
    v_mfma_f32_16x16x32_bf16 v[212:215], a[20:23], v[24:27], v[212:215]
    ds_read_b128 a[8:11], v7 offset:30720
    v_mfma_f32_16x16x32_bf16 v[228:231], a[20:23], v[28:31], v[228:231]
    v_rcp_f32 v15, v248
    s_waitcnt lgkmcnt(3)
    v_mfma_f32_16x16x32_bf16 v[216:219], a[24:27], v[24:27], v[216:219]
    ds_read_b128 a[12:15], v7 offset:31744
    v_mul_f32 v0, v240, v240
    v_mfma_f32_16x16x32_bf16 v[232:235], a[24:27], v[28:31], v[232:235]
    buffer_load_dwordx4 a[168:171], v3, s[20:23], s45 offen offset:2048
    v_mul_f32 v1, v248, v248
    v_mul_f32 v14, 0xbfb8aa3b, v14
    v_mfma_f32_16x16x32_bf16 v[220:223], a[28:31], v[24:27], v[220:223]
    ds_read_b128 a[16:19], v7 offset:32768
    v_mul_f32 v15, 0xbfb8aa3b, v15
    v_mfma_f32_16x16x32_bf16 v[236:239], a[28:31], v[28:31], v[236:239]
    v_mul_f32 v178, v176, v178
    v_mul_f32 v179, v177, v179
    s_waitcnt lgkmcnt(3)
    v_mfma_f32_16x16x32_bf16 v[208:211], a[0:3], v[32:35], v[208:211]
    ds_read_b128 a[20:23], v7 offset:33792
    v_mul_f32 v176, v14, v176
    v_mfma_f32_16x16x32_bf16 v[224:227], a[0:3], v[36:39], v[224:227]
    buffer_load_dwordx4 a[172:175], v3, s[20:23], s45 offen offset:3072
    v_mul_f32 v177, v14, v177
    v_mfma_f32_16x16x32_bf16 v[212:215], a[4:7], v[32:35], v[212:215]
    ds_read_b128 a[24:27], v7 offset:34816
    v_mfma_f32_16x16x32_bf16 v[228:231], a[4:7], v[36:39], v[228:231]
    v_exp_f32 v176, v176
    s_waitcnt lgkmcnt(3)
    v_mfma_f32_16x16x32_bf16 v[216:219], a[8:11], v[32:35], v[216:219]
    ds_read_b128 a[28:31], v7 offset:35840
    v_mfma_f32_16x16x32_bf16 v[232:235], a[8:11], v[36:39], v[232:235]
    buffer_load_dwordx4 a[176:179], v4, s[20:23], s45 offen offset:0
    s_add_u32 s45, s45, 20480
    v_exp_f32 v177, v177
    v_mfma_f32_16x16x32_bf16 v[220:223], a[12:15], v[32:35], v[220:223]
    ds_read_b128 a[0:3], v7 offset:36864
    v_fma_f32 v176, v176, v0, v0
    v_mfma_f32_16x16x32_bf16 v[236:239], a[12:15], v[36:39], v[236:239]
    v_fma_f32 v177, v177, v0, v0
    s_waitcnt lgkmcnt(3)
    v_mfma_f32_16x16x32_bf16 v[208:211], a[16:19], v[40:43], v[208:211]
    ds_read_b128 a[4:7], v7 offset:37888
    v_mfma_f32_16x16x32_bf16 v[224:227], a[16:19], v[44:47], v[224:227]
    buffer_load_dwordx4 a[180:183], v3, s[20:23], s46 offen offset:0
    v_rcp_f32 v176, v176
    v_mfma_f32_16x16x32_bf16 v[212:215], a[20:23], v[40:43], v[212:215]
    ds_read_b128 a[8:11], v7 offset:38912
    v_mfma_f32_16x16x32_bf16 v[228:231], a[20:23], v[44:47], v[228:231]
    v_rcp_f32 v177, v177
    s_waitcnt lgkmcnt(3)
    v_mfma_f32_16x16x32_bf16 v[216:219], a[24:27], v[40:43], v[216:219]
    ds_read_b128 a[12:15], v7 offset:39936
    v_mul_f32 v178, v178, v176
    v_mfma_f32_16x16x32_bf16 v[232:235], a[24:27], v[44:47], v[232:235]
    buffer_load_dwordx4 a[184:187], v3, s[20:23], s46 offen offset:1024
    v_mul_f32 v179, v179, v177
    v_cvt_pk_bf16_f32 v176, v178, v179
    v_mfma_f32_16x16x32_bf16 v[220:223], a[28:31], v[40:43], v[220:223]
    ds_read_b128 a[16:19], v3 offset:0
    v_min_u32 v176, -2, v176
    v_mfma_f32_16x16x32_bf16 v[236:239], a[28:31], v[44:47], v[236:239]
    v_mul_f32 v182, v180, v182
    v_mul_f32 v183, v181, v183
    s_waitcnt lgkmcnt(3)
    v_mfma_f32_16x16x32_bf16 v[208:211], a[0:3], v[48:51], v[208:211]
    ds_read_b128 a[20:23], v3 offset:1024
    v_mul_f32 v180, v14, v180
    v_mfma_f32_16x16x32_bf16 v[224:227], a[0:3], v[52:55], v[224:227]
    buffer_load_dwordx4 a[188:191], v3, s[20:23], s46 offen offset:2048
    v_mul_f32 v181, v14, v181
    v_mfma_f32_16x16x32_bf16 v[212:215], a[4:7], v[48:51], v[212:215]
    ds_read_b128 a[24:27], v3 offset:2048
    v_mfma_f32_16x16x32_bf16 v[228:231], a[4:7], v[52:55], v[228:231]
    v_exp_f32 v180, v180
    s_waitcnt lgkmcnt(3)
    v_mfma_f32_16x16x32_bf16 v[216:219], a[8:11], v[48:51], v[216:219]
    ds_read_b128 a[28:31], v3 offset:3072
    v_mfma_f32_16x16x32_bf16 v[232:235], a[8:11], v[52:55], v[232:235]
    buffer_load_dwordx4 a[192:195], v3, s[20:23], s46 offen offset:3072
    v_exp_f32 v181, v181
    v_mfma_f32_16x16x32_bf16 v[220:223], a[12:15], v[48:51], v[220:223]
    ds_read_b128 a[0:3], v3 offset:4096
    v_fma_f32 v180, v180, v0, v0
    v_mfma_f32_16x16x32_bf16 v[236:239], a[12:15], v[52:55], v[236:239]
    v_fma_f32 v181, v181, v0, v0
    s_waitcnt lgkmcnt(3)
    v_mfma_f32_16x16x32_bf16 v[208:211], a[16:19], v[56:59], v[208:211]
    ds_read_b128 a[4:7], v3 offset:5120
    v_mfma_f32_16x16x32_bf16 v[224:227], a[16:19], v[60:63], v[224:227]
    buffer_load_dwordx4 a[196:199], v4, s[20:23], s46 offen offset:0
    s_add_u32 s46, s46, 20480
    v_rcp_f32 v180, v180
    v_mfma_f32_16x16x32_bf16 v[212:215], a[20:23], v[56:59], v[212:215]
    ds_read_b128 a[8:11], v3 offset:6144
    v_mfma_f32_16x16x32_bf16 v[228:231], a[20:23], v[60:63], v[228:231]
    v_rcp_f32 v181, v181
    s_waitcnt lgkmcnt(3)
    v_mfma_f32_16x16x32_bf16 v[216:219], a[24:27], v[56:59], v[216:219]
    ds_read_b128 a[12:15], v3 offset:7168
    v_mul_f32 v182, v182, v180
    v_mfma_f32_16x16x32_bf16 v[232:235], a[24:27], v[60:63], v[232:235]
    buffer_load_dwordx4 a[200:203], v3, s[20:23], s47 offen offset:0
    v_mul_f32 v183, v183, v181
    v_cvt_pk_bf16_f32 v177, v182, v183
    v_mfma_f32_16x16x32_bf16 v[220:223], a[28:31], v[56:59], v[220:223]
    ds_read_b128 a[16:19], v3 offset:8192
    v_mul_f32 v186, v184, v186
    v_mfma_f32_16x16x32_bf16 v[236:239], a[28:31], v[60:63], v[236:239]
    v_mul_f32 v187, v185, v187
    v_mul_f32 v184, v14, v184
    s_waitcnt lgkmcnt(3)
    v_mfma_f32_16x16x32_bf16 v[208:211], a[0:3], v[64:67], v[208:211]
    ds_read_b128 a[20:23], v3 offset:9216
    v_mul_f32 v185, v14, v185
    v_mfma_f32_16x16x32_bf16 v[224:227], a[0:3], v[68:71], v[224:227]
    buffer_load_dwordx4 a[204:207], v3, s[20:23], s47 offen offset:1024
    v_exp_f32 v184, v184
    v_mfma_f32_16x16x32_bf16 v[212:215], a[4:7], v[64:67], v[212:215]
    ds_read_b128 a[24:27], v3 offset:10240
    v_mfma_f32_16x16x32_bf16 v[228:231], a[4:7], v[68:71], v[228:231]
    v_exp_f32 v185, v185
    s_waitcnt lgkmcnt(3)
    v_mfma_f32_16x16x32_bf16 v[216:219], a[8:11], v[64:67], v[216:219]
    ds_read_b128 a[28:31], v3 offset:11264
    v_fma_f32 v184, v184, v0, v0
    v_mfma_f32_16x16x32_bf16 v[232:235], a[8:11], v[68:71], v[232:235]
    buffer_load_dwordx4 a[208:211], v3, s[20:23], s47 offen offset:2048
    v_fma_f32 v185, v185, v0, v0
    v_mfma_f32_16x16x32_bf16 v[220:223], a[12:15], v[64:67], v[220:223]
    ds_read_b128 a[0:3], v3 offset:12288
    v_mfma_f32_16x16x32_bf16 v[236:239], a[12:15], v[68:71], v[236:239]
    v_rcp_f32 v184, v184
    s_waitcnt lgkmcnt(3)
    v_mfma_f32_16x16x32_bf16 v[208:211], a[16:19], v[72:75], v[208:211]
    ds_read_b128 a[4:7], v3 offset:13312
    v_mfma_f32_16x16x32_bf16 v[224:227], a[16:19], v[76:79], v[224:227]
    buffer_load_dwordx4 a[212:215], v3, s[20:23], s47 offen offset:3072
    v_rcp_f32 v185, v185
    v_mfma_f32_16x16x32_bf16 v[212:215], a[20:23], v[72:75], v[212:215]
    ds_read_b128 a[8:11], v3 offset:14336
    v_mul_f32 v186, v186, v184
    v_mfma_f32_16x16x32_bf16 v[228:231], a[20:23], v[76:79], v[228:231]
    v_mul_f32 v187, v187, v185
    v_cvt_pk_bf16_f32 v178, v186, v187
    s_waitcnt lgkmcnt(3)
    v_mfma_f32_16x16x32_bf16 v[216:219], a[24:27], v[72:75], v[216:219]
    ds_read_b128 a[12:15], v3 offset:15360
    v_mul_f32 v190, v188, v190
    v_mfma_f32_16x16x32_bf16 v[232:235], a[24:27], v[76:79], v[232:235]
    buffer_load_dwordx4 a[216:219], v4, s[20:23], s47 offen offset:0
    s_add_u32 s47, s47, 20480
    v_mul_f32 v191, v189, v191
    v_mul_f32 v188, v14, v188
    v_mfma_f32_16x16x32_bf16 v[220:223], a[28:31], v[72:75], v[220:223]
    ds_read_b128 a[16:19], v3 offset:16384
    v_mul_f32 v189, v14, v189
    v_mfma_f32_16x16x32_bf16 v[236:239], a[28:31], v[76:79], v[236:239]
    v_exp_f32 v188, v188
    s_waitcnt lgkmcnt(3)
    v_mfma_f32_16x16x32_bf16 v[208:211], a[0:3], v[80:83], v[208:211]
    ds_read_b128 a[20:23], v3 offset:17408
    v_mfma_f32_16x16x32_bf16 v[224:227], a[0:3], v[84:87], v[224:227]
    buffer_load_dwordx4 a[220:223], v3, s[20:23], s44 offen offset:0
    v_exp_f32 v189, v189
    v_mfma_f32_16x16x32_bf16 v[212:215], a[4:7], v[80:83], v[212:215]
    ds_read_b128 a[24:27], v3 offset:18432
    v_fma_f32 v188, v188, v0, v0
    v_mfma_f32_16x16x32_bf16 v[228:231], a[4:7], v[84:87], v[228:231]
    v_fma_f32 v189, v189, v0, v0
    s_waitcnt lgkmcnt(3)
    v_mfma_f32_16x16x32_bf16 v[216:219], a[8:11], v[80:83], v[216:219]
    ds_read_b128 a[28:31], v3 offset:19456
    v_mfma_f32_16x16x32_bf16 v[232:235], a[8:11], v[84:87], v[232:235]
    buffer_load_dwordx4 a[224:227], v3, s[20:23], s44 offen offset:1024
    v_rcp_f32 v188, v188
    v_mfma_f32_16x16x32_bf16 v[220:223], a[12:15], v[80:83], v[220:223]
    s_barrier
    ds_read_b128 a[0:3], v3 offset:20480
    v_mfma_f32_16x16x32_bf16 v[236:239], a[12:15], v[84:87], v[236:239]
    v_rcp_f32 v189, v189
    s_waitcnt lgkmcnt(3)
    v_mfma_f32_16x16x32_bf16 v[208:211], a[16:19], v[88:91], v[208:211]
    ds_read_b128 a[4:7], v3 offset:21504
    v_mul_f32 v190, v190, v188
    v_mfma_f32_16x16x32_bf16 v[224:227], a[16:19], v[92:95], v[224:227]
    s_add_u32 m0, s34, 122880
    s_nop 0
    buffer_load_dwordx4 v3, s[20:23], s31 offen offset:0 lds
    v_mul_f32 v191, v191, v189
    v_cvt_pk_bf16_f32 v179, v190, v191
    buffer_store_dwordx4 v[176:179], v3, s[20:23], s35 offen sc1
    s_add_u32 s35, s35, 4096
    v_mfma_f32_16x16x32_bf16 v[212:215], a[20:23], v[88:91], v[212:215]
    ds_read_b128 a[8:11], v3 offset:22528
    v_mul_f32 v194, v192, v194
    v_mfma_f32_16x16x32_bf16 v[228:231], a[20:23], v[92:95], v[228:231]
    v_mul_f32 v195, v193, v195
    v_mul_f32 v192, v15, v192
    s_waitcnt lgkmcnt(3)
    v_mfma_f32_16x16x32_bf16 v[216:219], a[24:27], v[88:91], v[216:219]
    ds_read_b128 a[12:15], v3 offset:23552
    v_mul_f32 v193, v15, v193
    v_mfma_f32_16x16x32_bf16 v[232:235], a[24:27], v[92:95], v[232:235]
    buffer_load_dwordx4 v3, s[20:23], s31 offen offset:1024 lds
    v_exp_f32 v192, v192
    v_mfma_f32_16x16x32_bf16 v[220:223], a[28:31], v[88:91], v[220:223]
    v_exp_f32 v193, v193
    v_mfma_f32_16x16x32_bf16 v[236:239], a[28:31], v[92:95], v[236:239]
    v_fma_f32 v192, v192, v1, v1
    v_fma_f32 v193, v193, v1, v1
    s_waitcnt lgkmcnt(2)
    v_mfma_f32_16x16x32_bf16 v[208:211], a[0:3], v[96:99], v[208:211]
    v_rcp_f32 v192, v192
    v_mfma_f32_16x16x32_bf16 v[224:227], a[0:3], v[100:103], v[224:227]
    buffer_load_dwordx4 v3, s[20:23], s31 offen offset:2048 lds
    v_rcp_f32 v193, v193
    v_mfma_f32_16x16x32_bf16 v[212:215], a[4:7], v[96:99], v[212:215]
    v_mul_f32 v194, v194, v192
    v_mul_f32 v195, v195, v193
    v_mfma_f32_16x16x32_bf16 v[228:231], a[4:7], v[100:103], v[228:231]
    v_cvt_pk_bf16_f32 v192, v194, v195
    v_min_u32 v192, -2, v192
    s_waitcnt lgkmcnt(0)
    v_mfma_f32_16x16x32_bf16 v[216:219], a[8:11], v[96:99], v[216:219]
    v_mul_f32 v198, v196, v198
    v_mul_f32 v199, v197, v199
    v_mfma_f32_16x16x32_bf16 v[232:235], a[8:11], v[100:103], v[232:235]
    buffer_load_dwordx4 v3, s[20:23], s31 offen offset:3072 lds
    v_mul_f32 v196, v15, v196
    v_mul_f32 v197, v15, v197
    v_mfma_f32_16x16x32_bf16 v[220:223], a[12:15], v[96:99], v[220:223]
    ds_read_b128 a[16:19], v3 offset:24576
    v_mfma_f32_16x16x32_bf16 v[236:239], a[12:15], v[100:103], v[236:239]
    v_exp_f32 v196, v196
    v_mfma_f32_16x16x16_bf16 v[208:211], a[36:37], a[48:49], v[208:211]
    ds_read_b128 a[20:23], v3 offset:25600
    v_mfma_f32_16x16x16_bf16 v[224:227], a[36:37], a[52:53], v[224:227]
    s_add_u32 m0, s34, 126976
    s_nop 0
    buffer_load_dwordx4 v4, s[20:23], s31 offen offset:0 lds
    v_mfma_f32_16x16x16_bf16 v[212:215], a[36:37], a[50:51], v[212:215]
    ds_read_b128 a[24:27], v3 offset:26624
    v_mfma_f32_16x16x16_bf16 v[228:231], a[36:37], a[54:55], v[228:231]
    v_mfma_f32_16x16x16_bf16 v[216:219], a[38:39], a[48:49], v[216:219]
    ds_read_b128 a[28:31], v3 offset:27648
    v_mfma_f32_16x16x16_bf16 v[232:235], a[38:39], a[52:53], v[232:235]
    s_add_u32 m0, s34, 143360
    s_nop 0
    buffer_load_dwordx4 v3, s[20:23], s32 offen offset:0 lds
    v_mfma_f32_16x16x16_bf16 v[220:223], a[38:39], a[50:51], v[220:223]
    ds_read_b128 a[0:3], v3 offset:28672
    v_mfma_f32_16x16x16_bf16 v[236:239], a[38:39], a[54:55], v[236:239]
    s_waitcnt lgkmcnt(3)
    v_mfma_f32_16x16x32_bf16 v[208:211], a[16:19], v[104:107], v[208:211]
    ds_read_b128 a[4:7], v3 offset:29696
    v_mfma_f32_16x16x32_bf16 v[224:227], a[16:19], v[108:111], v[224:227]
    buffer_load_dwordx4 v3, s[20:23], s32 offen offset:1024 lds
    v_exp_f32 v197, v197
    v_mfma_f32_16x16x32_bf16 v[212:215], a[20:23], v[104:107], v[212:215]
    ds_read_b128 a[8:11], v3 offset:30720
    v_fma_f32 v196, v196, v1, v1
    v_mfma_f32_16x16x32_bf16 v[228:231], a[20:23], v[108:111], v[228:231]
    v_fma_f32 v197, v197, v1, v1
    s_waitcnt lgkmcnt(3)
    v_mfma_f32_16x16x32_bf16 v[216:219], a[24:27], v[104:107], v[216:219]
    ds_read_b128 a[12:15], v3 offset:31744
    v_mfma_f32_16x16x32_bf16 v[232:235], a[24:27], v[108:111], v[232:235]
    buffer_load_dwordx4 v3, s[20:23], s32 offen offset:2048 lds
    v_rcp_f32 v196, v196
    v_mfma_f32_16x16x32_bf16 v[220:223], a[28:31], v[104:107], v[220:223]
    ds_read_b128 a[16:19], v3 offset:32768
    v_mfma_f32_16x16x32_bf16 v[236:239], a[28:31], v[108:111], v[236:239]
    v_rcp_f32 v197, v197
    s_waitcnt lgkmcnt(3)
    v_mfma_f32_16x16x32_bf16 v[208:211], a[0:3], v[112:115], v[208:211]
    ds_read_b128 a[20:23], v3 offset:33792
    v_mul_f32 v198, v198, v196
    v_mfma_f32_16x16x32_bf16 v[224:227], a[0:3], v[116:119], v[224:227]
    buffer_load_dwordx4 v3, s[20:23], s32 offen offset:3072 lds
    v_mul_f32 v199, v199, v197
    v_cvt_pk_bf16_f32 v193, v198, v199
    v_mfma_f32_16x16x32_bf16 v[212:215], a[4:7], v[112:115], v[212:215]
    ds_read_b128 a[24:27], v3 offset:34816
    v_mul_f32 v202, v200, v202
    v_mfma_f32_16x16x32_bf16 v[228:231], a[4:7], v[116:119], v[228:231]
    v_mul_f32 v203, v201, v203
    v_mul_f32 v200, v15, v200
    s_waitcnt lgkmcnt(3)
    v_mfma_f32_16x16x32_bf16 v[216:219], a[8:11], v[112:115], v[216:219]
    ds_read_b128 a[28:31], v3 offset:35840
    v_mul_f32 v201, v15, v201
    v_mfma_f32_16x16x32_bf16 v[232:235], a[8:11], v[116:119], v[232:235]
    s_add_u32 m0, s34, 147456
    s_nop 0
    buffer_load_dwordx4 v4, s[20:23], s32 offen offset:0 lds
    v_exp_f32 v200, v200
    v_mfma_f32_16x16x32_bf16 v[220:223], a[12:15], v[112:115], v[220:223]
    ds_read_b128 a[0:3], v3 offset:36864
    v_mfma_f32_16x16x32_bf16 v[236:239], a[12:15], v[116:119], v[236:239]
    v_exp_f32 v201, v201
    s_waitcnt lgkmcnt(3)
    v_mfma_f32_16x16x32_bf16 v[208:211], a[16:19], v[120:123], v[208:211]
    ds_read_b128 a[4:7], v3 offset:37888
    v_fma_f32 v200, v200, v1, v1
    v_mfma_f32_16x16x32_bf16 v[224:227], a[16:19], v[124:127], v[224:227]
    v_fma_f32 v201, v201, v1, v1
    v_mfma_f32_16x16x32_bf16 v[212:215], a[20:23], v[120:123], v[212:215]
    ds_read_b128 a[8:11], v3 offset:38912
    v_mfma_f32_16x16x32_bf16 v[228:231], a[20:23], v[124:127], v[228:231]
    v_rcp_f32 v200, v200
    s_waitcnt lgkmcnt(3)
    v_mfma_f32_16x16x32_bf16 v[216:219], a[24:27], v[120:123], v[216:219]
    ds_read_b128 a[12:15], v3 offset:39936
    v_mfma_f32_16x16x32_bf16 v[232:235], a[24:27], v[124:127], v[232:235]
    v_rcp_f32 v201, v201
    v_mfma_f32_16x16x32_bf16 v[220:223], a[28:31], v[120:123], v[220:223]
    ds_read_b128 a[16:19], v3 offset:40960
    v_mul_f32 v202, v202, v200
    v_mfma_f32_16x16x32_bf16 v[236:239], a[28:31], v[124:127], v[236:239]
    v_mul_f32 v203, v203, v201
    v_cvt_pk_bf16_f32 v194, v202, v203
    s_waitcnt lgkmcnt(3)
    v_mfma_f32_16x16x32_bf16 v[208:211], a[0:3], v[128:131], v[208:211]
    ds_read_b128 a[20:23], v3 offset:41984
    v_mul_f32 v206, v204, v206
    v_mfma_f32_16x16x32_bf16 v[224:227], a[0:3], v[132:135], v[224:227]
    v_mul_f32 v207, v205, v207
    v_mul_f32 v204, v15, v204
    v_mfma_f32_16x16x32_bf16 v[212:215], a[4:7], v[128:131], v[212:215]
    ds_read_b128 a[24:27], v3 offset:43008
    v_mul_f32 v205, v15, v205
    v_mfma_f32_16x16x32_bf16 v[228:231], a[4:7], v[132:135], v[228:231]
    v_exp_f32 v204, v204
    s_waitcnt lgkmcnt(3)
    v_mfma_f32_16x16x32_bf16 v[216:219], a[8:11], v[128:131], v[216:219]
    ds_read_b128 a[28:31], v3 offset:44032
    v_mfma_f32_16x16x32_bf16 v[232:235], a[8:11], v[132:135], v[232:235]
    v_exp_f32 v205, v205
    v_mfma_f32_16x16x32_bf16 v[220:223], a[12:15], v[128:131], v[220:223]
    ds_read_b128 a[0:3], v3 offset:45056
    v_fma_f32 v204, v204, v1, v1
    v_mfma_f32_16x16x32_bf16 v[236:239], a[12:15], v[132:135], v[236:239]
    v_fma_f32 v205, v205, v1, v1
    s_waitcnt lgkmcnt(3)
    v_mfma_f32_16x16x32_bf16 v[208:211], a[16:19], v[136:139], v[208:211]
    ds_read_b128 a[4:7], v3 offset:46080
    v_mfma_f32_16x16x32_bf16 v[224:227], a[16:19], v[140:143], v[224:227]
    v_rcp_f32 v204, v204
    v_mfma_f32_16x16x32_bf16 v[212:215], a[20:23], v[136:139], v[212:215]
    ds_read_b128 a[8:11], v3 offset:47104
    v_mfma_f32_16x16x32_bf16 v[228:231], a[20:23], v[140:143], v[228:231]
    v_rcp_f32 v205, v205
    s_waitcnt lgkmcnt(3)
    v_mfma_f32_16x16x32_bf16 v[216:219], a[24:27], v[136:139], v[216:219]
    ds_read_b128 a[12:15], v3 offset:48128
    v_mul_f32 v206, v206, v204
    v_mfma_f32_16x16x32_bf16 v[232:235], a[24:27], v[140:143], v[232:235]
    v_mul_f32 v207, v207, v205
    v_cvt_pk_bf16_f32 v195, v206, v207
    buffer_store_dwordx4 v[192:195], v3, s[20:23], s36 offen sc1
    s_add_u32 s36, s36, 4096
    v_mfma_f32_16x16x32_bf16 v[220:223], a[28:31], v[136:139], v[220:223]
    ds_read_b128 a[16:19], v3 offset:49152
    v_mfma_f32_16x16x32_bf16 v[236:239], a[28:31], v[140:143], v[236:239]
    s_waitcnt lgkmcnt(3)
    v_mfma_f32_16x16x32_bf16 v[208:211], a[0:3], v[144:147], v[208:211]
    ds_read_b128 a[20:23], v3 offset:50176
    v_mfma_f32_16x16x32_bf16 v[224:227], a[0:3], v[148:151], v[224:227]
    v_mfma_f32_16x16x32_bf16 v[212:215], a[4:7], v[144:147], v[212:215]
    ds_read_b128 a[24:27], v3 offset:51200
    v_mfma_f32_16x16x32_bf16 v[228:231], a[4:7], v[148:151], v[228:231]
    s_waitcnt lgkmcnt(3)
    v_mfma_f32_16x16x32_bf16 v[216:219], a[8:11], v[144:147], v[216:219]
    ds_read_b128 a[28:31], v3 offset:52224
    v_mfma_f32_16x16x32_bf16 v[232:235], a[8:11], v[148:151], v[232:235]
    v_mfma_f32_16x16x32_bf16 v[220:223], a[12:15], v[144:147], v[220:223]
    ds_read_b128 a[0:3], v3 offset:53248
    v_mfma_f32_16x16x32_bf16 v[236:239], a[12:15], v[148:151], v[236:239]
    s_waitcnt lgkmcnt(3)
    v_mfma_f32_16x16x32_bf16 v[208:211], a[16:19], v[152:155], v[208:211]
    ds_read_b128 a[4:7], v3 offset:54272
    v_mfma_f32_16x16x32_bf16 v[224:227], a[16:19], v[156:159], v[224:227]
    v_mfma_f32_16x16x32_bf16 v[212:215], a[20:23], v[152:155], v[212:215]
    ds_read_b128 a[8:11], v3 offset:55296
    v_mfma_f32_16x16x32_bf16 v[228:231], a[20:23], v[156:159], v[228:231]
    s_waitcnt lgkmcnt(3)
    v_mfma_f32_16x16x32_bf16 v[216:219], a[24:27], v[152:155], v[216:219]
    ds_read_b128 a[12:15], v3 offset:56320
    v_mfma_f32_16x16x32_bf16 v[232:235], a[24:27], v[156:159], v[232:235]
    v_mfma_f32_16x16x32_bf16 v[220:223], a[28:31], v[152:155], v[220:223]
    ds_read_b128 a[16:19], v3 offset:57344
    v_mfma_f32_16x16x32_bf16 v[236:239], a[28:31], v[156:159], v[236:239]
    s_waitcnt lgkmcnt(3)
    v_mfma_f32_16x16x32_bf16 v[208:211], a[0:3], v[160:163], v[208:211]
    v_lshrrev_b32 v13, 2, v3
    v_and_b32 v13, 28, v13
    ds_read_b128 a[20:23], v3 offset:58368
    v_mfma_f32_16x16x32_bf16 v[224:227], a[0:3], v[164:167], v[224:227]
    v_mfma_f32_16x16x32_bf16 v[212:215], a[4:7], v[160:163], v[212:215]
    ds_read_b128 a[24:27], v3 offset:59392
    v_mfma_f32_16x16x32_bf16 v[228:231], a[4:7], v[164:167], v[228:231]
    s_waitcnt lgkmcnt(3)
    v_mfma_f32_16x16x32_bf16 v[216:219], a[8:11], v[160:163], v[216:219]
    ds_read_b128 a[28:31], v3 offset:60416
    v_mfma_f32_16x16x32_bf16 v[232:235], a[8:11], v[164:167], v[232:235]
    v_mfma_f32_16x16x32_bf16 v[220:223], a[12:15], v[160:163], v[220:223]
    s_waitcnt vmcnt(42)
    s_barrier
    ds_read_b128 a[0:3], v6 offset:0
    v_mfma_f32_16x16x32_bf16 v[236:239], a[12:15], v[164:167], v[236:239]
    s_add_u32 m0, s34, 0
    s_nop 0
    buffer_load_dwordx4 v3, s[20:23], s33 offen offset:0 lds
    s_waitcnt lgkmcnt(3)
    v_mfma_f32_16x16x32_bf16 v[208:211], a[16:19], v[168:171], v[208:211]
    ds_read_b128 a[4:7], v6 offset:1024
    v_mfma_f32_16x16x32_bf16 v[224:227], a[16:19], v[172:175], v[224:227]
    buffer_load_dwordx4 v3, s[20:23], s33 offen offset:1024 lds
    v_mfma_f32_16x16x32_bf16 v[212:215], a[20:23], v[168:171], v[212:215]
    ds_read_b128 a[8:11], v6 offset:2048
    v_mul_f32 v210, v208, v210
    v_mfma_f32_16x16x32_bf16 v[228:231], a[20:23], v[172:175], v[228:231]
    buffer_load_dwordx4 v3, s[20:23], s33 offen offset:2048 lds
    v_mul_f32 v211, v209, v211
    v_mul_f32 v208, v14, v208
    s_waitcnt lgkmcnt(3)
    v_mfma_f32_16x16x32_bf16 v[216:219], a[24:27], v[168:171], v[216:219]
    ds_read_b128 a[12:15], v6 offset:3072
    v_mul_f32 v209, v14, v209
    v_mfma_f32_16x16x32_bf16 v[232:235], a[24:27], v[172:175], v[232:235]
    buffer_load_dwordx4 v3, s[20:23], s33 offen offset:3072 lds
    v_exp_f32 v208, v208
    v_mfma_f32_16x16x32_bf16 v[220:223], a[28:31], v[168:171], v[220:223]
    ds_read_b128 a[16:19], v6 offset:4096
    v_mfma_f32_16x16x32_bf16 v[236:239], a[28:31], v[172:175], v[236:239]
    s_add_u32 m0, s34, 4096
    s_nop 0
    buffer_load_dwordx4 v4, s[20:23], s33 offen offset:0 lds
    v_exp_f32 v209, v209
    s_waitcnt lgkmcnt(3)
    v_mfma_f32_16x16x32_bf16 v[176:179], a[0:3], v[16:19], 0
    ds_read_b128 a[20:23], v6 offset:5120
    v_fma_f32 v208, v208, v0, v0
    v_mfma_f32_16x16x32_bf16 v[192:195], a[0:3], v[20:23], 0
    v_fma_f32 v209, v209, v0, v0
    v_mfma_f32_16x16x32_bf16 v[180:183], a[4:7], v[16:19], 0
    ds_read_b128 a[24:27], v6 offset:6144
    v_mfma_f32_16x16x32_bf16 v[196:199], a[4:7], v[20:23], 0
    v_rcp_f32 v208, v208
    s_waitcnt lgkmcnt(3)
    v_mfma_f32_16x16x32_bf16 v[184:187], a[8:11], v[16:19], 0
    ds_read_b128 a[28:31], v6 offset:7168
    v_mfma_f32_16x16x32_bf16 v[200:203], a[8:11], v[20:23], 0
    v_rcp_f32 v209, v209
    v_mfma_f32_16x16x32_bf16 v[188:191], a[12:15], v[16:19], 0
    ds_read_b128 a[0:3], v6 offset:8192
    v_mul_f32 v210, v210, v208
    v_mfma_f32_16x16x32_bf16 v[204:207], a[12:15], v[20:23], 0
    v_mul_f32 v211, v211, v209
    v_cvt_pk_bf16_f32 v208, v210, v211
    s_waitcnt lgkmcnt(3)
    v_mfma_f32_16x16x32_bf16 v[176:179], a[16:19], v[24:27], v[176:179]
    ds_read_b128 a[4:7], v6 offset:9216
    v_min_u32 v208, -2, v208
    v_mfma_f32_16x16x32_bf16 v[192:195], a[16:19], v[28:31], v[192:195]
    v_mul_f32 v214, v212, v214
    v_mul_f32 v215, v213, v215
    v_mfma_f32_16x16x32_bf16 v[180:183], a[20:23], v[24:27], v[180:183]
    ds_read_b128 a[8:11], v6 offset:10240
    v_mul_f32 v212, v14, v212
    v_mfma_f32_16x16x32_bf16 v[196:199], a[20:23], v[28:31], v[196:199]
    v_mul_f32 v213, v14, v213
    s_waitcnt lgkmcnt(3)
    v_mfma_f32_16x16x32_bf16 v[184:187], a[24:27], v[24:27], v[184:187]
    ds_read_b128 a[12:15], v6 offset:11264
    v_mfma_f32_16x16x32_bf16 v[200:203], a[24:27], v[28:31], v[200:203]
    v_exp_f32 v212, v212
    v_mfma_f32_16x16x32_bf16 v[188:191], a[28:31], v[24:27], v[188:191]
    ds_read_b128 a[16:19], v6 offset:12288
    v_mfma_f32_16x16x32_bf16 v[204:207], a[28:31], v[28:31], v[204:207]
    v_exp_f32 v213, v213
    s_waitcnt lgkmcnt(3)
    v_mfma_f32_16x16x32_bf16 v[176:179], a[0:3], v[32:35], v[176:179]
    ds_read_b128 a[20:23], v6 offset:13312
    v_fma_f32 v212, v212, v0, v0
    v_mfma_f32_16x16x32_bf16 v[192:195], a[0:3], v[36:39], v[192:195]
    v_fma_f32 v213, v213, v0, v0
    v_mfma_f32_16x16x32_bf16 v[180:183], a[4:7], v[32:35], v[180:183]
    ds_read_b128 a[24:27], v6 offset:14336
    v_mfma_f32_16x16x32_bf16 v[196:199], a[4:7], v[36:39], v[196:199]
    v_rcp_f32 v212, v212
    s_waitcnt lgkmcnt(3)
    v_mfma_f32_16x16x32_bf16 v[184:187], a[8:11], v[32:35], v[184:187]
    ds_read_b128 a[28:31], v6 offset:15360
    v_mfma_f32_16x16x32_bf16 v[200:203], a[8:11], v[36:39], v[200:203]
    v_rcp_f32 v213, v213
    v_mfma_f32_16x16x32_bf16 v[188:191], a[12:15], v[32:35], v[188:191]
    ds_read_b128 a[0:3], v6 offset:16384
    v_mul_f32 v214, v214, v212
    v_mfma_f32_16x16x32_bf16 v[204:207], a[12:15], v[36:39], v[204:207]
    v_mul_f32 v215, v215, v213
    v_cvt_pk_bf16_f32 v209, v214, v215
    s_waitcnt lgkmcnt(3)
    v_mfma_f32_16x16x32_bf16 v[176:179], a[16:19], v[40:43], v[176:179]
    ds_read_b128 a[4:7], v6 offset:17408
    v_mul_f32 v218, v216, v218
    v_mfma_f32_16x16x32_bf16 v[192:195], a[16:19], v[44:47], v[192:195]
    v_mul_f32 v219, v217, v219
    v_mul_f32 v216, v14, v216
    v_mfma_f32_16x16x32_bf16 v[180:183], a[20:23], v[40:43], v[180:183]
    ds_read_b128 a[8:11], v6 offset:18432
    v_mul_f32 v217, v14, v217
    v_mfma_f32_16x16x32_bf16 v[196:199], a[20:23], v[44:47], v[196:199]
    v_exp_f32 v216, v216
    s_waitcnt lgkmcnt(3)
    v_mfma_f32_16x16x32_bf16 v[184:187], a[24:27], v[40:43], v[184:187]
    ds_read_b128 a[12:15], v6 offset:19456
    v_mfma_f32_16x16x32_bf16 v[200:203], a[24:27], v[44:47], v[200:203]
    v_exp_f32 v217, v217
    v_mfma_f32_16x16x32_bf16 v[188:191], a[28:31], v[40:43], v[188:191]
    ds_read_b128 a[16:19], v6 offset:20480
    v_fma_f32 v216, v216, v0, v0
    v_mfma_f32_16x16x32_bf16 v[204:207], a[28:31], v[44:47], v[204:207]
    v_fma_f32 v217, v217, v0, v0
    s_waitcnt lgkmcnt(3)
    v_mfma_f32_16x16x32_bf16 v[176:179], a[0:3], v[48:51], v[176:179]
    ds_read_b128 a[20:23], v6 offset:21504
    v_mfma_f32_16x16x32_bf16 v[192:195], a[0:3], v[52:55], v[192:195]
    v_rcp_f32 v216, v216
    v_mfma_f32_16x16x32_bf16 v[180:183], a[4:7], v[48:51], v[180:183]
    ds_read_b128 a[24:27], v6 offset:22528
    v_mfma_f32_16x16x32_bf16 v[196:199], a[4:7], v[52:55], v[196:199]
    v_rcp_f32 v217, v217
    s_waitcnt lgkmcnt(3)
    v_mfma_f32_16x16x32_bf16 v[184:187], a[8:11], v[48:51], v[184:187]
    ds_read_b128 a[28:31], v6 offset:23552
    v_mul_f32 v218, v218, v216
    v_mfma_f32_16x16x32_bf16 v[200:203], a[8:11], v[52:55], v[200:203]
    v_mul_f32 v219, v219, v217
    v_cvt_pk_bf16_f32 v210, v218, v219
    v_mfma_f32_16x16x32_bf16 v[188:191], a[12:15], v[48:51], v[188:191]
    ds_read_b128 a[0:3], v6 offset:24576
    v_mul_f32 v222, v220, v222
    v_mfma_f32_16x16x32_bf16 v[204:207], a[12:15], v[52:55], v[204:207]
    v_mul_f32 v223, v221, v223
    v_mul_f32 v220, v14, v220
    s_waitcnt lgkmcnt(3)
    v_mfma_f32_16x16x32_bf16 v[176:179], a[16:19], v[56:59], v[176:179]
    ds_read_b128 a[4:7], v6 offset:25600
    v_mul_f32 v221, v14, v221
    v_mfma_f32_16x16x32_bf16 v[192:195], a[16:19], v[60:63], v[192:195]
    v_exp_f32 v220, v220
    v_mfma_f32_16x16x32_bf16 v[180:183], a[20:23], v[56:59], v[180:183]
    ds_read_b128 a[8:11], v6 offset:26624
    v_mfma_f32_16x16x32_bf16 v[196:199], a[20:23], v[60:63], v[196:199]
    v_exp_f32 v221, v221
    s_waitcnt lgkmcnt(3)
    v_mfma_f32_16x16x32_bf16 v[184:187], a[24:27], v[56:59], v[184:187]
    ds_read_b128 a[12:15], v6 offset:27648
    v_fma_f32 v220, v220, v0, v0
    v_mfma_f32_16x16x32_bf16 v[200:203], a[24:27], v[60:63], v[200:203]
    v_fma_f32 v221, v221, v0, v0
    v_mfma_f32_16x16x32_bf16 v[188:191], a[28:31], v[56:59], v[188:191]
    ds_read_b128 a[16:19], v6 offset:28672
    v_mfma_f32_16x16x32_bf16 v[204:207], a[28:31], v[60:63], v[204:207]
    v_rcp_f32 v220, v220
    s_waitcnt lgkmcnt(3)
    v_mfma_f32_16x16x32_bf16 v[176:179], a[0:3], v[64:67], v[176:179]
    ds_read_b128 a[20:23], v6 offset:29696
    v_mfma_f32_16x16x32_bf16 v[192:195], a[0:3], v[68:71], v[192:195]
    v_rcp_f32 v221, v221
    v_mfma_f32_16x16x32_bf16 v[180:183], a[4:7], v[64:67], v[180:183]
    ds_read_b128 a[24:27], v6 offset:30720
    v_mul_f32 v222, v222, v220
    v_mfma_f32_16x16x32_bf16 v[196:199], a[4:7], v[68:71], v[196:199]
    v_mul_f32 v223, v223, v221
    v_cvt_pk_bf16_f32 v211, v222, v223
    buffer_store_dwordx4 v[208:211], v3, s[20:23], s35 offen sc1
    s_add_u32 s35, s35, 4096
    s_waitcnt lgkmcnt(3)
    v_mfma_f32_16x16x32_bf16 v[184:187], a[8:11], v[64:67], v[184:187]
    ds_read_b128 a[28:31], v6 offset:31744
    v_mul_f32 v226, v224, v226
    v_mfma_f32_16x16x32_bf16 v[200:203], a[8:11], v[68:71], v[200:203]
    v_mul_f32 v227, v225, v227
    v_mul_f32 v224, v15, v224
    v_mfma_f32_16x16x32_bf16 v[188:191], a[12:15], v[64:67], v[188:191]
    ds_read_b128 a[0:3], v6 offset:32768
    v_mul_f32 v225, v15, v225
    v_mfma_f32_16x16x32_bf16 v[204:207], a[12:15], v[68:71], v[204:207]
    v_exp_f32 v224, v224
    s_waitcnt lgkmcnt(3)
    v_mfma_f32_16x16x32_bf16 v[176:179], a[16:19], v[72:75], v[176:179]
    ds_read_b128 a[4:7], v6 offset:33792
    v_mfma_f32_16x16x32_bf16 v[192:195], a[16:19], v[76:79], v[192:195]
    v_exp_f32 v225, v225
    v_mfma_f32_16x16x32_bf16 v[180:183], a[20:23], v[72:75], v[180:183]
    ds_read_b128 a[8:11], v6 offset:34816
    v_fma_f32 v224, v224, v1, v1
    v_mfma_f32_16x16x32_bf16 v[196:199], a[20:23], v[76:79], v[196:199]
    v_fma_f32 v225, v225, v1, v1
    s_waitcnt lgkmcnt(3)
    v_mfma_f32_16x16x32_bf16 v[184:187], a[24:27], v[72:75], v[184:187]
    ds_read_b128 a[12:15], v6 offset:35840
    v_mfma_f32_16x16x32_bf16 v[200:203], a[24:27], v[76:79], v[200:203]
    v_rcp_f32 v224, v224
    v_mfma_f32_16x16x32_bf16 v[188:191], a[28:31], v[72:75], v[188:191]
    ds_read_b128 a[16:19], v6 offset:36864
    v_mfma_f32_16x16x32_bf16 v[204:207], a[28:31], v[76:79], v[204:207]
    v_rcp_f32 v225, v225
    s_waitcnt lgkmcnt(3)
    v_mfma_f32_16x16x32_bf16 v[176:179], a[0:3], v[80:83], v[176:179]
    ds_read_b128 a[20:23], v6 offset:37888
    v_mul_f32 v226, v226, v224
    v_mfma_f32_16x16x32_bf16 v[192:195], a[0:3], v[84:87], v[192:195]
    v_mul_f32 v227, v227, v225
    v_cvt_pk_bf16_f32 v224, v226, v227
    v_mfma_f32_16x16x32_bf16 v[180:183], a[4:7], v[80:83], v[180:183]
    ds_read_b128 a[24:27], v6 offset:38912
    v_min_u32 v224, -2, v224
    v_mfma_f32_16x16x32_bf16 v[196:199], a[4:7], v[84:87], v[196:199]
    v_mul_f32 v230, v228, v230
    v_mul_f32 v231, v229, v231
    s_waitcnt lgkmcnt(3)
    v_mfma_f32_16x16x32_bf16 v[184:187], a[8:11], v[80:83], v[184:187]
    ds_read_b128 a[28:31], v6 offset:39936
    v_mul_f32 v228, v15, v228
    v_mfma_f32_16x16x32_bf16 v[200:203], a[8:11], v[84:87], v[200:203]
    v_mul_f32 v229, v15, v229
    v_mfma_f32_16x16x32_bf16 v[188:191], a[12:15], v[80:83], v[188:191]
    s_waitcnt vmcnt(12)
    s_barrier
    ds_read_b128 a[0:3], v6 offset:40960
    v_mfma_f32_16x16x32_bf16 v[204:207], a[12:15], v[84:87], v[204:207]
    v_exp_f32 v228, v228
    s_waitcnt lgkmcnt(3)
    v_mfma_f32_16x16x32_bf16 v[176:179], a[16:19], v[88:91], v[176:179]
    ds_read_b128 a[4:7], v6 offset:41984
    v_mfma_f32_16x16x32_bf16 v[192:195], a[16:19], v[92:95], v[192:195]
    v_exp_f32 v229, v229
    v_mfma_f32_16x16x32_bf16 v[180:183], a[20:23], v[88:91], v[180:183]
    ds_read_b128 a[8:11], v6 offset:43008
    v_fma_f32 v228, v228, v1, v1
    v_mfma_f32_16x16x32_bf16 v[196:199], a[20:23], v[92:95], v[196:199]
    v_fma_f32 v229, v229, v1, v1
    s_waitcnt lgkmcnt(3)
    v_mfma_f32_16x16x32_bf16 v[184:187], a[24:27], v[88:91], v[184:187]
    ds_read_b128 a[12:15], v6 offset:44032
    v_mfma_f32_16x16x32_bf16 v[200:203], a[24:27], v[92:95], v[200:203]
    v_rcp_f32 v228, v228
    v_mfma_f32_16x16x32_bf16 v[188:191], a[28:31], v[88:91], v[188:191]
    v_rcp_f32 v229, v229
    v_mfma_f32_16x16x32_bf16 v[204:207], a[28:31], v[92:95], v[204:207]
    v_mul_f32 v230, v230, v228
    v_mul_f32 v231, v231, v229
    s_waitcnt lgkmcnt(2)
    v_mfma_f32_16x16x32_bf16 v[176:179], a[0:3], v[96:99], v[176:179]
    v_cvt_pk_bf16_f32 v225, v230, v231
    v_mul_f32 v234, v232, v234
    v_mfma_f32_16x16x32_bf16 v[192:195], a[0:3], v[100:103], v[192:195]
    v_mul_f32 v235, v233, v235
    v_mul_f32 v232, v15, v232
    v_mfma_f32_16x16x32_bf16 v[180:183], a[4:7], v[96:99], v[180:183]
    v_mul_f32 v233, v15, v233
    v_mfma_f32_16x16x32_bf16 v[196:199], a[4:7], v[100:103], v[196:199]
    v_exp_f32 v232, v232
    s_waitcnt lgkmcnt(0)
    v_mfma_f32_16x16x32_bf16 v[184:187], a[8:11], v[96:99], v[184:187]
    v_exp_f32 v233, v233
    v_mfma_f32_16x16x32_bf16 v[200:203], a[8:11], v[100:103], v[200:203]
    v_fma_f32 v232, v232, v1, v1
    v_fma_f32 v233, v233, v1, v1
    v_mfma_f32_16x16x32_bf16 v[188:191], a[12:15], v[96:99], v[188:191]
    ds_read_b128 a[16:19], v6 offset:45056
    v_mfma_f32_16x16x32_bf16 v[204:207], a[12:15], v[100:103], v[204:207]
    v_rcp_f32 v232, v232
    v_mfma_f32_16x16x16_bf16 v[176:179], a[40:41], a[48:49], v[176:179]
    ds_read_b128 a[20:23], v6 offset:46080
    v_mfma_f32_16x16x16_bf16 v[192:195], a[40:41], a[52:53], v[192:195]
    v_mfma_f32_16x16x16_bf16 v[180:183], a[40:41], a[50:51], v[180:183]
    ds_read_b128 a[24:27], v6 offset:47104
    v_mfma_f32_16x16x16_bf16 v[196:199], a[40:41], a[54:55], v[196:199]
    v_mfma_f32_16x16x16_bf16 v[184:187], a[42:43], a[48:49], v[184:187]
    buffer_load_dword v2, v13, s[20:23], s11 offen offset:0 sc1
    ds_read_b128 a[28:31], v6 offset:48128
    v_mfma_f32_16x16x16_bf16 v[200:203], a[42:43], a[52:53], v[200:203]
    v_mfma_f32_16x16x16_bf16 v[188:191], a[42:43], a[50:51], v[188:191]
    ds_read_b128 a[0:3], v6 offset:49152
    v_mfma_f32_16x16x16_bf16 v[204:207], a[42:43], a[54:55], v[204:207]
    s_waitcnt lgkmcnt(3)
    v_mfma_f32_16x16x32_bf16 v[176:179], a[16:19], v[104:107], v[176:179]
    ds_read_b128 a[4:7], v6 offset:50176
    v_mfma_f32_16x16x32_bf16 v[192:195], a[16:19], v[108:111], v[192:195]
    v_rcp_f32 v233, v233
    v_mfma_f32_16x16x32_bf16 v[180:183], a[20:23], v[104:107], v[180:183]
    ds_read_b128 a[8:11], v6 offset:51200
    v_mul_f32 v234, v234, v232
    v_mfma_f32_16x16x32_bf16 v[196:199], a[20:23], v[108:111], v[196:199]
    v_mul_f32 v235, v235, v233
    v_cvt_pk_bf16_f32 v226, v234, v235
    s_waitcnt lgkmcnt(3)
    v_mfma_f32_16x16x32_bf16 v[184:187], a[24:27], v[104:107], v[184:187]
    ds_read_b128 a[12:15], v6 offset:52224
    v_mul_f32 v238, v236, v238
    v_mfma_f32_16x16x32_bf16 v[200:203], a[24:27], v[108:111], v[200:203]
    v_mul_f32 v239, v237, v239
    v_mul_f32 v236, v15, v236
    v_mfma_f32_16x16x32_bf16 v[188:191], a[28:31], v[104:107], v[188:191]
    ds_read_b128 a[16:19], v6 offset:53248
    v_mul_f32 v237, v15, v237
    v_mfma_f32_16x16x32_bf16 v[204:207], a[28:31], v[108:111], v[204:207]
    v_exp_f32 v236, v236
    s_waitcnt lgkmcnt(3)
    v_mfma_f32_16x16x32_bf16 v[176:179], a[0:3], v[112:115], v[176:179]
    ds_read_b128 a[20:23], v6 offset:54272
    v_mfma_f32_16x16x32_bf16 v[192:195], a[0:3], v[116:119], v[192:195]
    v_exp_f32 v237, v237
    v_mfma_f32_16x16x32_bf16 v[180:183], a[4:7], v[112:115], v[180:183]
    ds_read_b128 a[24:27], v6 offset:55296
    v_fma_f32 v236, v236, v1, v1
    v_mfma_f32_16x16x32_bf16 v[196:199], a[4:7], v[116:119], v[196:199]
    v_fma_f32 v237, v237, v1, v1
    s_waitcnt lgkmcnt(3)
    v_mfma_f32_16x16x32_bf16 v[184:187], a[8:11], v[112:115], v[184:187]
    ds_read_b128 a[28:31], v6 offset:56320
    v_mfma_f32_16x16x32_bf16 v[200:203], a[8:11], v[116:119], v[200:203]
    v_rcp_f32 v236, v236
    v_mfma_f32_16x16x32_bf16 v[188:191], a[12:15], v[112:115], v[188:191]
    ds_read_b128 a[0:3], v6 offset:57344
    v_mfma_f32_16x16x32_bf16 v[204:207], a[12:15], v[116:119], v[204:207]
    v_rcp_f32 v237, v237
    s_waitcnt lgkmcnt(3)
    v_mfma_f32_16x16x32_bf16 v[176:179], a[16:19], v[120:123], v[176:179]
    ds_read_b128 a[4:7], v6 offset:58368
    v_mul_f32 v238, v238, v236
    v_mfma_f32_16x16x32_bf16 v[192:195], a[16:19], v[124:127], v[192:195]
    v_mul_f32 v239, v239, v237
    v_cvt_pk_bf16_f32 v227, v238, v239
    buffer_store_dwordx4 v[224:227], v3, s[20:23], s36 offen sc1
    s_add_u32 s36, s36, 4096
    v_mfma_f32_16x16x32_bf16 v[180:183], a[20:23], v[120:123], v[180:183]
    ds_read_b128 a[8:11], v6 offset:59392
    v_mfma_f32_16x16x32_bf16 v[196:199], a[20:23], v[124:127], v[196:199]
    s_waitcnt lgkmcnt(3)
    v_mfma_f32_16x16x32_bf16 v[184:187], a[24:27], v[120:123], v[184:187]
    ds_read_b128 a[12:15], v6 offset:60416
    v_mfma_f32_16x16x32_bf16 v[200:203], a[24:27], v[124:127], v[200:203]
    v_mfma_f32_16x16x32_bf16 v[188:191], a[28:31], v[120:123], v[188:191]
    ds_read_b128 a[16:19], v7 offset:0
    v_mfma_f32_16x16x32_bf16 v[204:207], a[28:31], v[124:127], v[204:207]
    s_waitcnt lgkmcnt(3)
    v_mfma_f32_16x16x32_bf16 v[176:179], a[0:3], v[128:131], v[176:179]
    ds_read_b128 a[20:23], v7 offset:1024
    v_mfma_f32_16x16x32_bf16 v[192:195], a[0:3], v[132:135], v[192:195]
    v_mfma_f32_16x16x32_bf16 v[180:183], a[4:7], v[128:131], v[180:183]
    ds_read_b128 a[24:27], v7 offset:2048
    v_mfma_f32_16x16x32_bf16 v[196:199], a[4:7], v[132:135], v[196:199]
    s_waitcnt lgkmcnt(3)
    v_mfma_f32_16x16x32_bf16 v[184:187], a[8:11], v[128:131], v[184:187]
    ds_read_b128 a[28:31], v7 offset:3072
    v_mfma_f32_16x16x32_bf16 v[200:203], a[8:11], v[132:135], v[200:203]
    v_mfma_f32_16x16x32_bf16 v[188:191], a[12:15], v[128:131], v[188:191]
    ds_read_b128 a[0:3], v7 offset:4096
    v_mfma_f32_16x16x32_bf16 v[204:207], a[12:15], v[132:135], v[204:207]
    s_waitcnt lgkmcnt(3)
    v_mfma_f32_16x16x32_bf16 v[176:179], a[16:19], v[136:139], v[176:179]
    ds_read_b128 a[4:7], v7 offset:5120
    v_mfma_f32_16x16x32_bf16 v[192:195], a[16:19], v[140:143], v[192:195]
    v_mfma_f32_16x16x32_bf16 v[180:183], a[20:23], v[136:139], v[180:183]
    ds_read_b128 a[8:11], v7 offset:6144
    v_mfma_f32_16x16x32_bf16 v[196:199], a[20:23], v[140:143], v[196:199]
    s_waitcnt lgkmcnt(3)
    v_mfma_f32_16x16x32_bf16 v[184:187], a[24:27], v[136:139], v[184:187]
    ds_read_b128 a[12:15], v7 offset:7168
    v_mfma_f32_16x16x32_bf16 v[200:203], a[24:27], v[140:143], v[200:203]
    v_mfma_f32_16x16x32_bf16 v[188:191], a[28:31], v[136:139], v[188:191]
    ds_read_b128 a[16:19], v7 offset:8192
    v_mfma_f32_16x16x32_bf16 v[204:207], a[28:31], v[140:143], v[204:207]
    s_waitcnt lgkmcnt(3)
    v_mfma_f32_16x16x32_bf16 v[176:179], a[0:3], v[144:147], v[176:179]
    ds_read_b128 a[20:23], v7 offset:9216
    v_mfma_f32_16x16x32_bf16 v[192:195], a[0:3], v[148:151], v[192:195]
    v_mfma_f32_16x16x32_bf16 v[180:183], a[4:7], v[144:147], v[180:183]
    ds_read_b128 a[24:27], v7 offset:10240
    v_mfma_f32_16x16x32_bf16 v[196:199], a[4:7], v[148:151], v[196:199]
    s_waitcnt lgkmcnt(3)
    v_mfma_f32_16x16x32_bf16 v[184:187], a[8:11], v[144:147], v[184:187]
    ds_read_b128 a[28:31], v7 offset:11264
    v_mfma_f32_16x16x32_bf16 v[200:203], a[8:11], v[148:151], v[200:203]
    v_mfma_f32_16x16x32_bf16 v[188:191], a[12:15], v[144:147], v[188:191]
    s_waitcnt vmcnt(1)
    v_cmp_eq_u32 vcc, -1, v2
    s_cbranch_vccnz .rl74
.rl74b:
    ds_read_b128 a[0:3], v7 offset:12288
    v_mfma_f32_16x16x32_bf16 v[204:207], a[12:15], v[148:151], v[204:207]
    buffer_load_dwordx4 a[228:231], v8, s[20:23], s40 offen
    s_waitcnt lgkmcnt(3)
    v_mfma_f32_16x16x32_bf16 v[176:179], a[16:19], v[152:155], v[176:179]
    ds_read_b128 a[4:7], v7 offset:13312
    v_mfma_f32_16x16x32_bf16 v[192:195], a[16:19], v[156:159], v[192:195]
    buffer_load_dwordx4 a[232:235], v8, s[20:23], s41 offen
    v_mfma_f32_16x16x32_bf16 v[180:183], a[20:23], v[152:155], v[180:183]
    ds_read_b128 a[8:11], v7 offset:14336
    v_mfma_f32_16x16x32_bf16 v[196:199], a[20:23], v[156:159], v[196:199]
    buffer_load_dwordx4 a[236:239], v8, s[20:23], s42 offen
    s_waitcnt lgkmcnt(3)
    v_mfma_f32_16x16x32_bf16 v[184:187], a[24:27], v[152:155], v[184:187]
    ds_read_b128 a[12:15], v7 offset:15360
    v_mfma_f32_16x16x32_bf16 v[200:203], a[24:27], v[156:159], v[200:203]
    buffer_load_dwordx4 a[240:243], v8, s[20:23], s43 offen
    v_mfma_f32_16x16x32_bf16 v[188:191], a[28:31], v[152:155], v[188:191]
    ds_read_b128 a[16:19], v7 offset:16384
    v_mfma_f32_16x16x32_bf16 v[204:207], a[28:31], v[156:159], v[204:207]
    s_waitcnt lgkmcnt(3)
    v_mfma_f32_16x16x32_bf16 v[176:179], a[0:3], v[160:163], v[176:179]
    ds_read_b128 a[20:23], v7 offset:17408
    v_mfma_f32_16x16x32_bf16 v[192:195], a[0:3], v[164:167], v[192:195]
    v_mfma_f32_16x16x32_bf16 v[180:183], a[4:7], v[160:163], v[180:183]
    ds_read_b128 a[24:27], v7 offset:18432
    v_mfma_f32_16x16x32_bf16 v[196:199], a[4:7], v[164:167], v[196:199]
    s_waitcnt lgkmcnt(3)
    v_mfma_f32_16x16x32_bf16 v[184:187], a[8:11], v[160:163], v[184:187]
    ds_read_b128 a[28:31], v7 offset:19456
    v_mfma_f32_16x16x32_bf16 v[200:203], a[8:11], v[164:167], v[200:203]
    v_mfma_f32_16x16x32_bf16 v[188:191], a[12:15], v[160:163], v[188:191]
    s_barrier
    ds_read_b128 a[0:3], v7 offset:20480
    v_mfma_f32_16x16x32_bf16 v[204:207], a[12:15], v[164:167], v[204:207]
    s_waitcnt lgkmcnt(3)
    v_mfma_f32_16x16x32_bf16 v[176:179], a[16:19], v[168:171], v[176:179]
    ds_read_b128 a[4:7], v7 offset:21504
    v_mfma_f32_16x16x32_bf16 v[192:195], a[16:19], v[172:175], v[192:195]
    v_mfma_f32_16x16x32_bf16 v[180:183], a[20:23], v[168:171], v[180:183]
    ds_read_b128 a[8:11], v7 offset:22528
    v_mul_f32 v178, v176, v178
    v_mfma_f32_16x16x32_bf16 v[196:199], a[20:23], v[172:175], v[196:199]
    buffer_load_dwordx4 a[244:247], v9, s[20:23], s40 offen
    v_mul_f32 v179, v177, v179
    v_mul_f32 v176, v14, v176
    s_waitcnt lgkmcnt(3)
    v_mfma_f32_16x16x32_bf16 v[184:187], a[24:27], v[168:171], v[184:187]
    ds_read_b128 a[12:15], v7 offset:23552
    v_mul_f32 v177, v14, v177
    v_mfma_f32_16x16x32_bf16 v[200:203], a[24:27], v[172:175], v[200:203]
    buffer_load_dwordx4 a[248:251], v9, s[20:23], s41 offen
    v_exp_f32 v176, v176
    v_mfma_f32_16x16x32_bf16 v[188:191], a[28:31], v[168:171], v[188:191]
    ds_read_b128 a[16:19], v7 offset:24576
    v_mfma_f32_16x16x32_bf16 v[204:207], a[28:31], v[172:175], v[204:207]
    buffer_load_dwordx4 a[252:255], v9, s[20:23], s42 offen
    v_exp_f32 v177, v177
    s_waitcnt lgkmcnt(3)
    v_mfma_f32_16x16x32_bf16 v[208:211], a[0:3], v[16:19], 0
    ds_read_b128 a[20:23], v7 offset:25600
    v_fma_f32 v176, v176, v0, v0
    v_mfma_f32_16x16x32_bf16 v[216:219], a[0:3], v[20:23], 0
    buffer_load_dwordx4 v[232:235], v9, s[20:23], s43 offen
    v_fma_f32 v177, v177, v0, v0
    v_mfma_f32_16x16x32_bf16 v[212:215], a[4:7], v[16:19], 0
    ds_read_b128 a[24:27], v7 offset:26624
    v_mfma_f32_16x16x32_bf16 v[220:223], a[4:7], v[20:23], 0
    buffer_load_dwordx4 a[56:59], v3, s[20:23], s44 offen offset:2048
    v_rcp_f32 v176, v176
    s_waitcnt lgkmcnt(3)
    v_mfma_f32_16x16x32_bf16 v[208:211], a[8:11], v[24:27], v[208:211]
    ds_read_b128 a[28:31], v7 offset:27648
    v_mfma_f32_16x16x32_bf16 v[216:219], a[8:11], v[28:31], v[216:219]
    v_rcp_f32 v177, v177
    v_mfma_f32_16x16x32_bf16 v[212:215], a[12:15], v[24:27], v[212:215]
    ds_read_b128 a[0:3], v7 offset:28672
    v_mul_f32 v178, v178, v176
    v_mfma_f32_16x16x32_bf16 v[220:223], a[12:15], v[28:31], v[220:223]
    buffer_load_dwordx4 v[236:239], v3, s[20:23], s44 offen offset:3072
    v_mul_f32 v179, v179, v177
    v_cvt_pk_bf16_f32 v176, v178, v179
    s_waitcnt lgkmcnt(3)
    v_mfma_f32_16x16x32_bf16 v[208:211], a[16:19], v[32:35], v[208:211]
    ds_read_b128 a[4:7], v7 offset:29696
    v_min_u32 v176, -2, v176
    v_mfma_f32_16x16x32_bf16 v[216:219], a[16:19], v[36:39], v[216:219]
    v_mul_f32 v182, v180, v182
    v_mul_f32 v183, v181, v183
    v_mfma_f32_16x16x32_bf16 v[212:215], a[20:23], v[32:35], v[212:215]
    ds_read_b128 a[8:11], v7 offset:30720
    v_mul_f32 v180, v14, v180
    v_mfma_f32_16x16x32_bf16 v[220:223], a[20:23], v[36:39], v[220:223]
    buffer_load_dwordx4 v[16:19], v4, s[20:23], s44 offen offset:0
    v_mul_f32 v181, v14, v181
    s_waitcnt lgkmcnt(3)
    v_mfma_f32_16x16x32_bf16 v[208:211], a[24:27], v[40:43], v[208:211]
    ds_read_b128 a[12:15], v7 offset:31744
    v_mfma_f32_16x16x32_bf16 v[216:219], a[24:27], v[44:47], v[216:219]
    v_exp_f32 v180, v180
    v_mfma_f32_16x16x32_bf16 v[212:215], a[28:31], v[40:43], v[212:215]
    ds_read_b128 a[16:19], v7 offset:32768
    v_mfma_f32_16x16x32_bf16 v[220:223], a[28:31], v[44:47], v[220:223]
    buffer_load_dwordx4 v[20:23], v10, s[20:23], s40 offen
    v_exp_f32 v181, v181
    s_waitcnt lgkmcnt(3)
    v_mfma_f32_16x16x32_bf16 v[208:211], a[0:3], v[48:51], v[208:211]
    ds_read_b128 a[20:23], v7 offset:33792
    v_fma_f32 v180, v180, v0, v0
    v_mfma_f32_16x16x32_bf16 v[216:219], a[0:3], v[52:55], v[216:219]
    v_fma_f32 v181, v181, v0, v0
    v_mfma_f32_16x16x32_bf16 v[212:215], a[4:7], v[48:51], v[212:215]
    ds_read_b128 a[24:27], v7 offset:34816
    v_mfma_f32_16x16x32_bf16 v[220:223], a[4:7], v[52:55], v[220:223]
    buffer_load_dwordx4 v[24:27], v10, s[20:23], s41 offen
    v_rcp_f32 v180, v180
    s_waitcnt lgkmcnt(3)
    v_mfma_f32_16x16x32_bf16 v[208:211], a[8:11], v[56:59], v[208:211]
    ds_read_b128 a[28:31], v7 offset:35840
    v_mfma_f32_16x16x32_bf16 v[216:219], a[8:11], v[60:63], v[216:219]
    v_rcp_f32 v181, v181
    v_mfma_f32_16x16x32_bf16 v[212:215], a[12:15], v[56:59], v[212:215]
    ds_read_b128 a[0:3], v7 offset:36864
    v_mul_f32 v182, v182, v180
    v_mfma_f32_16x16x32_bf16 v[220:223], a[12:15], v[60:63], v[220:223]
    buffer_load_dwordx4 v[28:31], v10, s[20:23], s42 offen
    v_mul_f32 v183, v183, v181
    v_cvt_pk_bf16_f32 v177, v182, v183
    s_waitcnt lgkmcnt(3)
    v_mfma_f32_16x16x32_bf16 v[208:211], a[16:19], v[64:67], v[208:211]
    ds_read_b128 a[4:7], v7 offset:37888
    v_mul_f32 v186, v184, v186
    v_mfma_f32_16x16x32_bf16 v[216:219], a[16:19], v[68:71], v[216:219]
    v_mul_f32 v187, v185, v187
    v_mul_f32 v184, v14, v184
    v_mfma_f32_16x16x32_bf16 v[212:215], a[20:23], v[64:67], v[212:215]
    ds_read_b128 a[8:11], v7 offset:38912
    v_mul_f32 v185, v14, v185
    v_mfma_f32_16x16x32_bf16 v[220:223], a[20:23], v[68:71], v[220:223]
    buffer_load_dwordx4 v[32:35], v10, s[20:23], s43 offen
    v_exp_f32 v184, v184
    s_waitcnt lgkmcnt(3)
    v_mfma_f32_16x16x32_bf16 v[208:211], a[24:27], v[72:75], v[208:211]
    ds_read_b128 a[12:15], v7 offset:39936
    v_mfma_f32_16x16x32_bf16 v[216:219], a[24:27], v[76:79], v[216:219]
    v_exp_f32 v185, v185
    v_mfma_f32_16x16x32_bf16 v[212:215], a[28:31], v[72:75], v[212:215]
    ds_read_b128 a[16:19], v3 offset:0
    v_fma_f32 v184, v184, v0, v0
    v_mfma_f32_16x16x32_bf16 v[220:223], a[28:31], v[76:79], v[220:223]
    buffer_load_dwordx4 v[36:39], v3, s[20:23], s45 offen offset:0
    v_fma_f32 v185, v185, v0, v0
    s_waitcnt lgkmcnt(3)
    v_mfma_f32_16x16x32_bf16 v[208:211], a[0:3], v[80:83], v[208:211]
    ds_read_b128 a[20:23], v3 offset:1024
    v_mfma_f32_16x16x32_bf16 v[216:219], a[0:3], v[84:87], v[216:219]
    v_rcp_f32 v184, v184
    v_mfma_f32_16x16x32_bf16 v[212:215], a[4:7], v[80:83], v[212:215]
    v_rcp_f32 v185, v185
    v_mfma_f32_16x16x32_bf16 v[220:223], a[4:7], v[84:87], v[220:223]
    buffer_load_dwordx4 v[40:43], v11, s[20:23], s40 offen
    s_add_u32 s40, s40, 4096
    v_mul_f32 v186, v186, v184
    v_mul_f32 v187, v187, v185
    s_waitcnt lgkmcnt(2)
    v_mfma_f32_16x16x32_bf16 v[208:211], a[8:11], v[88:91], v[208:211]
    v_cvt_pk_bf16_f32 v178, v186, v187
    v_mul_f32 v190, v188, v190
    v_mfma_f32_16x16x32_bf16 v[216:219], a[8:11], v[92:95], v[216:219]
    v_mul_f32 v191, v189, v191
    v_mul_f32 v188, v14, v188
    v_mfma_f32_16x16x32_bf16 v[212:215], a[12:15], v[88:91], v[212:215]
    ds_read_b128 a[24:27], v3 offset:2048
    v_mul_f32 v189, v14, v189
    v_mfma_f32_16x16x32_bf16 v[220:223], a[12:15], v[92:95], v[220:223]
    buffer_load_dwordx4 v[44:47], v11, s[20:23], s41 offen
    s_add_u32 s41, s41, 4096
    v_exp_f32 v188, v188
    s_waitcnt lgkmcnt(1)
    v_mfma_f32_16x16x32_bf16 v[208:211], a[16:19], v[96:99], v[208:211]
    ds_read_b128 a[28:31], v3 offset:3072
    v_mfma_f32_16x16x32_bf16 v[216:219], a[16:19], v[100:103], v[216:219]
    v_exp_f32 v189, v189
    v_mfma_f32_16x16x32_bf16 v[212:215], a[20:23], v[96:99], v[212:215]
    ds_read_b128 a[0:3], v3 offset:4096
    v_fma_f32 v188, v188, v0, v0
    v_mfma_f32_16x16x32_bf16 v[220:223], a[20:23], v[100:103], v[220:223]
    buffer_load_dwordx4 v[48:51], v11, s[20:23], s42 offen
    s_add_u32 s42, s42, 4096
    v_fma_f32 v189, v189, v0, v0
    v_mfma_f32_16x16x16_bf16 v[208:211], a[44:45], a[48:49], v[208:211]
    ds_read_b128 a[4:7], v3 offset:5120
    v_mfma_f32_16x16x16_bf16 v[216:219], a[44:45], a[52:53], v[216:219]
    v_mfma_f32_16x16x16_bf16 v[212:215], a[44:45], a[50:51], v[212:215]
    ds_read_b128 a[8:11], v3 offset:6144
    v_mfma_f32_16x16x16_bf16 v[220:223], a[44:45], a[54:55], v[220:223]
    buffer_load_dwordx4 v[52:55], v11, s[20:23], s43 offen
    s_add_u32 s43, s43, 4096
    s_waitcnt lgkmcnt(3)
    v_mfma_f32_16x16x32_bf16 v[208:211], a[24:27], v[104:107], v[208:211]
    ds_read_b128 a[12:15], v3 offset:7168
    v_mfma_f32_16x16x32_bf16 v[216:219], a[24:27], v[108:111], v[216:219]
    v_rcp_f32 v188, v188
    v_mfma_f32_16x16x32_bf16 v[212:215], a[28:31], v[104:107], v[212:215]
    ds_read_b128 a[16:19], v3 offset:8192
    v_mfma_f32_16x16x32_bf16 v[220:223], a[28:31], v[108:111], v[220:223]
    buffer_load_dwordx4 v[56:59], v3, s[20:23], s45 offen offset:1024
    v_rcp_f32 v189, v189
    s_waitcnt lgkmcnt(3)
    v_mfma_f32_16x16x32_bf16 v[208:211], a[0:3], v[112:115], v[208:211]
    ds_read_b128 a[20:23], v3 offset:9216
    v_mul_f32 v190, v190, v188
    v_mfma_f32_16x16x32_bf16 v[216:219], a[0:3], v[116:119], v[216:219]
    v_mul_f32 v191, v191, v189
    v_cvt_pk_bf16_f32 v179, v190, v191
    buffer_store_dwordx4 v[176:179], v3, s[20:23], s35 offen sc1
    v_mfma_f32_16x16x32_bf16 v[212:215], a[4:7], v[112:115], v[212:215]
    ds_read_b128 a[24:27], v3 offset:10240
    v_mul_f32 v194, v192, v194
    v_mfma_f32_16x16x32_bf16 v[220:223], a[4:7], v[116:119], v[220:223]
    buffer_load_dwordx4 v[60:63], v8, s[20:23], s40 offen
    v_mul_f32 v195, v193, v195
    v_mul_f32 v192, v15, v192
    s_waitcnt lgkmcnt(3)
    v_mfma_f32_16x16x32_bf16 v[208:211], a[8:11], v[120:123], v[208:211]
    ds_read_b128 a[28:31], v3 offset:11264
    v_mul_f32 v193, v15, v193
    v_mfma_f32_16x16x32_bf16 v[216:219], a[8:11], v[124:127], v[216:219]
    v_exp_f32 v192, v192
    v_mfma_f32_16x16x32_bf16 v[212:215], a[12:15], v[120:123], v[212:215]
    ds_read_b128 a[0:3], v3 offset:12288
    v_mfma_f32_16x16x32_bf16 v[220:223], a[12:15], v[124:127], v[220:223]
    buffer_load_dwordx4 v[64:67], v8, s[20:23], s41 offen
    v_exp_f32 v193, v193
    s_waitcnt lgkmcnt(3)
    v_mfma_f32_16x16x32_bf16 v[208:211], a[16:19], v[128:131], v[208:211]
    ds_read_b128 a[4:7], v3 offset:13312
    v_fma_f32 v192, v192, v1, v1
    v_mfma_f32_16x16x32_bf16 v[216:219], a[16:19], v[132:135], v[216:219]
    v_fma_f32 v193, v193, v1, v1
    v_mfma_f32_16x16x32_bf16 v[212:215], a[20:23], v[128:131], v[212:215]
    ds_read_b128 a[8:11], v3 offset:14336
    v_mfma_f32_16x16x32_bf16 v[220:223], a[20:23], v[132:135], v[220:223]
    buffer_load_dwordx4 v[68:71], v8, s[20:23], s42 offen
    v_rcp_f32 v192, v192
    s_waitcnt lgkmcnt(3)
    v_mfma_f32_16x16x32_bf16 v[208:211], a[24:27], v[136:139], v[208:211]
    ds_read_b128 a[12:15], v3 offset:15360
    v_mfma_f32_16x16x32_bf16 v[216:219], a[24:27], v[140:143], v[216:219]
    v_rcp_f32 v193, v193
    v_mfma_f32_16x16x32_bf16 v[212:215], a[28:31], v[136:139], v[212:215]
    ds_read_b128 a[16:19], v3 offset:16384
    v_mul_f32 v194, v194, v192
    v_mfma_f32_16x16x32_bf16 v[220:223], a[28:31], v[140:143], v[220:223]
    buffer_load_dwordx4 v[72:75], v8, s[20:23], s43 offen
    v_mul_f32 v195, v195, v193
    v_cvt_pk_bf16_f32 v192, v194, v195
    s_waitcnt lgkmcnt(3)
    v_mfma_f32_16x16x32_bf16 v[208:211], a[0:3], v[144:147], v[208:211]
    ds_read_b128 a[20:23], v3 offset:17408
    v_min_u32 v192, -2, v192
    v_mfma_f32_16x16x32_bf16 v[216:219], a[0:3], v[148:151], v[216:219]
    v_mul_f32 v198, v196, v198
    v_mul_f32 v199, v197, v199
    v_mfma_f32_16x16x32_bf16 v[212:215], a[4:7], v[144:147], v[212:215]
    ds_read_b128 a[24:27], v3 offset:18432
    v_mul_f32 v196, v15, v196
    v_mfma_f32_16x16x32_bf16 v[220:223], a[4:7], v[148:151], v[220:223]
    buffer_load_dwordx4 v[76:79], v3, s[20:23], s45 offen offset:2048
    v_mul_f32 v197, v15, v197
    s_waitcnt lgkmcnt(3)
    v_mfma_f32_16x16x32_bf16 v[208:211], a[8:11], v[152:155], v[208:211]
    ds_read_b128 a[28:31], v3 offset:19456
    v_mfma_f32_16x16x32_bf16 v[216:219], a[8:11], v[156:159], v[216:219]
    v_exp_f32 v196, v196
    v_mfma_f32_16x16x32_bf16 v[212:215], a[12:15], v[152:155], v[212:215]
    v_exp_f32 v197, v197
    v_mfma_f32_16x16x32_bf16 v[220:223], a[12:15], v[156:159], v[220:223]
    buffer_load_dwordx4 v[80:83], v9, s[20:23], s40 offen
    v_fma_f32 v196, v196, v1, v1
    v_fma_f32 v197, v197, v1, v1
    s_waitcnt lgkmcnt(2)
    v_mfma_f32_16x16x32_bf16 v[208:211], a[16:19], v[160:163], v[208:211]
    s_waitcnt vmcnt(24)
    v_accvgpr_read_b32 v5, a228
    v_accvgpr_read_b32 v2, a232
    v_mfma_f32_16x16x32_bf16 v[216:219], a[16:19], v[164:167], v[216:219]
    v_max_u32 v5, v5, v2
    v_accvgpr_read_b32 v2, a236
    v_mfma_f32_16x16x32_bf16 v[212:215], a[20:23], v[160:163], v[212:215]
    v_max_u32 v5, v5, v2
    v_accvgpr_read_b32 v2, a240
    v_mfma_f32_16x16x32_bf16 v[220:223], a[20:23], v[164:167], v[220:223]
    buffer_load_dwordx4 v[84:87], v9, s[20:23], s41 offen
    v_max_u32 v5, v5, v2
    v_cmp_eq_u32 vcc, -1, v5
    s_waitcnt lgkmcnt(0)
    v_mfma_f32_16x16x32_bf16 v[208:211], a[24:27], v[168:171], v[208:211]
    s_cbranch_vccnz .g3r75
.g3r75b:
    v_rcp_f32 v196, v196
    v_mfma_f32_16x16x32_bf16 v[216:219], a[24:27], v[172:175], v[216:219]
    v_rcp_f32 v197, v197
    v_mfma_f32_16x16x32_bf16 v[212:215], a[28:31], v[168:171], v[212:215]
    v_mul_f32 v198, v198, v196
    v_mul_f32 v199, v199, v197
    v_mfma_f32_16x16x32_bf16 v[220:223], a[28:31], v[172:175], v[220:223]
    buffer_load_dwordx4 v[88:91], v9, s[20:23], s42 offen
    v_cvt_pk_bf16_f32 v193, v198, v199
    v_mul_f32 v202, v200, v202
    v_mfma_f32_16x16x32_bf16 a[0:3], a[60:63], a[228:231], 0
    v_mul_f32 v203, v201, v203
    v_mul_f32 v200, v15, v200
    v_mfma_f32_16x16x32_bf16 a[4:7], a[64:67], a[228:231], 0
    v_mul_f32 v201, v15, v201
    v_mfma_f32_16x16x32_bf16 a[8:11], a[68:71], a[228:231], 0
    v_exp_f32 v200, v200
    v_mfma_f32_16x16x32_bf16 a[12:15], a[72:75], a[228:231], 0
    buffer_load_dwordx4 v[92:95], v9, s[20:23], s43 offen
    v_exp_f32 v201, v201
    v_mfma_f32_16x16x32_bf16 a[16:19], a[76:79], a[228:231], 0
    v_fma_f32 v200, v200, v1, v1
    v_fma_f32 v201, v201, v1, v1
    v_mfma_f32_16x16x32_bf16 a[20:23], a[60:63], a[232:235], 0
    v_rcp_f32 v200, v200
    v_mfma_f32_16x16x32_bf16 a[24:27], a[64:67], a[232:235], 0
    v_rcp_f32 v201, v201
    v_mfma_f32_16x16x32_bf16 a[28:31], a[68:71], a[232:235], 0
    buffer_load_dwordx4 a[228:231], v3, s[20:23], s45 offen offset:3072
    v_mul_f32 v202, v202, v200
    v_mul_f32 v203, v203, v201
    v_mfma_f32_16x16x32_bf16 a[32:35], a[72:75], a[232:235], 0
    v_cvt_pk_bf16_f32 v194, v202, v203
    v_mul_f32 v206, v204, v206
    v_mfma_f32_16x16x32_bf16 a[36:39], a[76:79], a[232:235], 0
    v_mul_f32 v207, v205, v207
    v_mul_f32 v204, v15, v204
    v_mfma_f32_16x16x32_bf16 a[40:43], a[60:63], a[236:239], 0
    buffer_load_dwordx4 v[96:99], v10, s[20:23], s40 offen
    v_mul_f32 v205, v15, v205
    v_mfma_f32_16x16x32_bf16 a[44:47], a[64:67], a[236:239], 0
    v_exp_f32 v204, v204
    v_mfma_f32_16x16x32_bf16 a[48:51], a[68:71], a[236:239], 0
    s_waitcnt vmcnt(25)
    v_accvgpr_read_b32 v5, a244
    v_accvgpr_read_b32 v2, a248
    v_mfma_f32_16x16x32_bf16 a[52:55], a[72:75], a[236:239], 0
    v_max3_u32 v5, v5, v2, v232
    v_accvgpr_read_b32 v2, a252
    v_mfma_f32_16x16x32_bf16 v[228:231], a[76:79], a[236:239], 0
    buffer_load_dwordx4 v[100:103], v10, s[20:23], s41 offen
    v_max_u32 v5, v5, v2
    v_cmp_eq_u32 vcc, -1, v5
    v_mfma_f32_16x16x32_bf16 v[240:243], a[60:63], a[240:243], 0
    s_cbranch_vccnz .g3r76
.g3r76b:
    v_exp_f32 v205, v205
    v_mfma_f32_16x16x32_bf16 v[244:247], a[64:67], a[240:243], 0
    v_fma_f32 v204, v204, v1, v1
    v_fma_f32 v205, v205, v1, v1
    v_mfma_f32_16x16x32_bf16 v[248:251], a[68:71], a[240:243], 0
    buffer_load_dwordx4 v[104:107], v10, s[20:23], s42 offen
    v_rcp_f32 v204, v204
    v_mfma_f32_16x16x32_bf16 v[252:255], a[72:75], a[240:243], 0
    v_rcp_f32 v205, v205
    v_mfma_f32_16x16x32_bf16 v[224:227], a[76:79], a[240:243], 0
    v_mul_f32 v206, v206, v204
    v_mul_f32 v207, v207, v205
    v_mfma_f32_16x16x32_bf16 a[0:3], a[80:83], a[244:247], a[0:3]
    v_cvt_pk_bf16_f32 v195, v206, v207
    buffer_store_dwordx4 v[192:195], v3, s[20:23], s36 offen sc1
    v_mul_f32 v210, v208, v210
    v_mfma_f32_16x16x32_bf16 a[4:7], a[84:87], a[244:247], a[4:7]
    buffer_load_dwordx4 v[108:111], v10, s[20:23], s43 offen
    v_mul_f32 v211, v209, v211
    v_mul_f32 v208, v14, v208
    v_mfma_f32_16x16x32_bf16 a[8:11], a[88:91], a[244:247], a[8:11]
    v_mul_f32 v209, v14, v209
    v_mfma_f32_16x16x32_bf16 a[12:15], a[92:95], a[244:247], a[12:15]
    v_exp_f32 v208, v208
    v_mfma_f32_16x16x32_bf16 a[16:19], a[96:99], a[244:247], a[16:19]
    buffer_load_dwordx4 a[232:235], v4, s[20:23], s45 offen offset:0
    v_exp_f32 v209, v209
    v_mfma_f32_16x16x32_bf16 a[20:23], a[80:83], a[248:251], a[20:23]
    v_fma_f32 v208, v208, v0, v0
    v_fma_f32 v209, v209, v0, v0
    v_mfma_f32_16x16x32_bf16 a[24:27], a[84:87], a[248:251], a[24:27]
    v_rcp_f32 v208, v208
    v_mfma_f32_16x16x32_bf16 a[28:31], a[88:91], a[248:251], a[28:31]
    v_rcp_f32 v209, v209
    v_mfma_f32_16x16x32_bf16 a[32:35], a[92:95], a[248:251], a[32:35]
    buffer_load_dwordx4 a[236:239], v3, s[20:23], s46 offen offset:0
    v_mul_f32 v210, v210, v208
    v_mul_f32 v211, v211, v209
    v_mfma_f32_16x16x32_bf16 a[36:39], a[96:99], a[248:251], a[36:39]
    v_cvt_pk_bf16_f32 v208, v210, v211
    v_min_u32 v208, -2, v208
    v_mfma_f32_16x16x32_bf16 a[40:43], a[80:83], a[252:255], a[40:43]
    v_mul_f32 v214, v212, v214
    v_mul_f32 v215, v213, v215
    v_mfma_f32_16x16x32_bf16 a[44:47], a[84:87], a[252:255], a[44:47]
    buffer_load_dwordx4 v[112:115], v11, s[20:23], s40 offen
    s_add_u32 s40, s40, 4096
    v_mul_f32 v212, v14, v212
    v_mul_f32 v213, v14, v213
    v_mfma_f32_16x16x32_bf16 a[48:51], a[88:91], a[252:255], a[48:51]
    s_waitcnt vmcnt(25)
    v_max3_u32 v5, v32, v28, v24
    v_max_u32 v5, v5, v20
    v_mfma_f32_16x16x32_bf16 a[52:55], a[92:95], a[252:255], a[52:55]
    v_cmp_eq_u32 vcc, -1, v5
    s_cbranch_vccnz .g3r77
.g3r77b:
    v_mfma_f32_16x16x32_bf16 v[228:231], a[96:99], a[252:255], v[228:231]
    v_exp_f32 v212, v212
    v_mfma_f32_16x16x32_bf16 v[240:243], a[80:83], v[232:235], v[240:243]
    buffer_load_dwordx4 v[176:179], v11, s[20:23], s41 offen
    s_add_u32 s41, s41, 4096
    v_exp_f32 v213, v213
    v_mfma_f32_16x16x32_bf16 v[244:247], a[84:87], v[232:235], v[244:247]
    v_fma_f32 v212, v212, v0, v0
    v_fma_f32 v213, v213, v0, v0
    v_mfma_f32_16x16x32_bf16 v[248:251], a[88:91], v[232:235], v[248:251]
    v_rcp_f32 v212, v212
    v_mfma_f32_16x16x32_bf16 v[252:255], a[92:95], v[232:235], v[252:255]
    buffer_load_dwordx4 v[180:183], v11, s[20:23], s42 offen
    s_add_u32 s42, s42, 4096
    v_rcp_f32 v213, v213
    v_mfma_f32_16x16x32_bf16 v[224:227], a[96:99], v[232:235], v[224:227]
    v_mul_f32 v214, v214, v212
    v_mul_f32 v215, v215, v213
    v_mfma_f32_16x16x32_bf16 a[0:3], a[100:103], v[20:23], a[0:3]
    v_cvt_pk_bf16_f32 v209, v214, v215
    buffer_store_dwordx2 v[208:209], v12, s[20:23], s37 offen sc1
    v_mul_f32 v218, v216, v218
    v_mfma_f32_16x16x32_bf16 a[4:7], a[104:107], v[20:23], a[4:7]
    v_mul_f32 v219, v217, v219
    v_mul_f32 v216, v15, v216
    v_mfma_f32_16x16x32_bf16 a[8:11], a[108:111], v[20:23], a[8:11]
    buffer_load_dwordx4 v[184:187], v11, s[20:23], s43 offen
    s_add_u32 s43, s43, 4096
    v_mul_f32 v217, v15, v217
    v_mfma_f32_16x16x32_bf16 a[12:15], a[112:115], v[20:23], a[12:15]
    v_exp_f32 v216, v216
    v_mfma_f32_16x16x32_bf16 a[16:19], a[116:119], v[20:23], a[16:19]
    v_exp_f32 v217, v217
    v_mfma_f32_16x16x32_bf16 a[20:23], a[100:103], v[24:27], a[20:23]
    buffer_load_dwordx4 a[60:63], v3, s[20:23], s46 offen offset:1024
    v_fma_f32 v216, v216, v1, v1
    v_fma_f32 v217, v217, v1, v1
    v_mfma_f32_16x16x32_bf16 a[24:27], a[104:107], v[24:27], a[24:27]
    v_rcp_f32 v216, v216
    v_mfma_f32_16x16x32_bf16 a[28:31], a[108:111], v[24:27], a[28:31]
    v_rcp_f32 v217, v217
    v_mfma_f32_16x16x32_bf16 a[32:35], a[112:115], v[24:27], a[32:35]
    v_mul_f32 v218, v218, v216
    v_mul_f32 v219, v219, v217
    v_mfma_f32_16x16x32_bf16 a[36:39], a[116:119], v[24:27], a[36:39]
    buffer_load_dwordx4 a[64:67], v3, s[20:23], s46 offen offset:2048
    v_cvt_pk_bf16_f32 v216, v218, v219
    v_min_u32 v216, -2, v216
    v_mfma_f32_16x16x32_bf16 a[40:43], a[100:103], v[28:31], a[40:43]
    v_mul_f32 v222, v220, v222
    v_mul_f32 v223, v221, v223
    v_mfma_f32_16x16x32_bf16 a[44:47], a[104:107], v[28:31], a[44:47]
    v_mul_f32 v220, v15, v220
    v_mul_f32 v221, v15, v221
    v_mfma_f32_16x16x32_bf16 a[48:51], a[108:111], v[28:31], a[48:51]
    buffer_load_dwordx4 v[188:191], v8, s[20:23], s40 offen
    s_waitcnt vmcnt(27)
    v_max3_u32 v5, v52, v48, v44
    v_max_u32 v5, v5, v40
    v_mfma_f32_16x16x32_bf16 a[52:55], a[112:115], v[28:31], a[52:55]
    v_cmp_eq_u32 vcc, -1, v5
    s_cbranch_vccnz .g3r78
.g3r78b:
    v_mfma_f32_16x16x32_bf16 v[228:231], a[116:119], v[28:31], v[228:231]
    v_exp_f32 v220, v220
    v_mfma_f32_16x16x32_bf16 v[240:243], a[100:103], v[32:35], v[240:243]
    v_exp_f32 v221, v221
    v_mfma_f32_16x16x32_bf16 v[244:247], a[104:107], v[32:35], v[244:247]
    buffer_load_dwordx4 v[116:119], v8, s[20:23], s41 offen
    v_fma_f32 v220, v220, v1, v1
    v_fma_f32 v221, v221, v1, v1
    v_mfma_f32_16x16x32_bf16 v[248:251], a[108:111], v[32:35], v[248:251]
    v_rcp_f32 v220, v220
    v_mfma_f32_16x16x32_bf16 v[252:255], a[112:115], v[32:35], v[252:255]
    v_rcp_f32 v221, v221
    v_mfma_f32_16x16x32_bf16 v[224:227], a[116:119], v[32:35], v[224:227]
    buffer_load_dwordx4 v[120:123], v8, s[20:23], s42 offen
    v_mul_f32 v222, v222, v220
    v_mul_f32 v223, v223, v221
    v_mfma_f32_16x16x32_bf16 a[0:3], a[120:123], v[40:43], a[0:3]
    v_cvt_pk_bf16_f32 v217, v222, v223
    buffer_store_dwordx2 v[216:217], v12, s[20:23], s38 offen sc1
    v_mfma_f32_16x16x32_bf16 a[4:7], a[124:127], v[40:43], a[4:7]
    v_mfma_f32_16x16x32_bf16 a[8:11], a[128:131], v[40:43], a[8:11]
    v_mfma_f32_16x16x32_bf16 a[12:15], a[132:135], v[40:43], a[12:15]
    buffer_load_dwordx4 v[124:127], v8, s[20:23], s43 offen
    v_mfma_f32_16x16x32_bf16 a[16:19], a[136:139], v[40:43], a[16:19]
    v_mfma_f32_16x16x32_bf16 a[20:23], a[120:123], v[44:47], a[20:23]
    v_mfma_f32_16x16x32_bf16 a[24:27], a[124:127], v[44:47], a[24:27]
    buffer_load_dwordx4 a[68:71], v3, s[20:23], s46 offen offset:3072
    v_mfma_f32_16x16x32_bf16 a[28:31], a[128:131], v[44:47], a[28:31]
    v_mfma_f32_16x16x32_bf16 a[32:35], a[132:135], v[44:47], a[32:35]
    v_mfma_f32_16x16x32_bf16 a[36:39], a[136:139], v[44:47], a[36:39]
    v_mfma_f32_16x16x32_bf16 a[40:43], a[120:123], v[48:51], a[40:43]
    buffer_load_dwordx4 v[128:131], v9, s[20:23], s40 offen
    v_mfma_f32_16x16x32_bf16 a[44:47], a[124:127], v[48:51], a[44:47]
    v_mfma_f32_16x16x32_bf16 a[48:51], a[128:131], v[48:51], a[48:51]
    s_waitcnt vmcnt(27)
    v_max3_u32 v5, v72, v68, v64
    v_max_u32 v5, v5, v60
    v_mfma_f32_16x16x32_bf16 a[52:55], a[132:135], v[48:51], a[52:55]
    buffer_load_dwordx4 v[132:135], v9, s[20:23], s41 offen
    v_cmp_eq_u32 vcc, -1, v5
    s_cbranch_vccnz .g3r79
.g3r79b:
    v_mfma_f32_16x16x32_bf16 v[228:231], a[136:139], v[48:51], v[228:231]
    v_mfma_f32_16x16x32_bf16 v[240:243], a[120:123], v[52:55], v[240:243]
    v_mfma_f32_16x16x32_bf16 v[244:247], a[124:127], v[52:55], v[244:247]
    v_mfma_f32_16x16x32_bf16 v[248:251], a[128:131], v[52:55], v[248:251]
    buffer_load_dwordx4 v[136:139], v9, s[20:23], s42 offen
    v_mfma_f32_16x16x32_bf16 v[252:255], a[132:135], v[52:55], v[252:255]
    v_mfma_f32_16x16x32_bf16 v[224:227], a[136:139], v[52:55], v[224:227]
    v_mfma_f32_16x16x32_bf16 a[0:3], a[140:143], v[60:63], a[0:3]
    buffer_load_dwordx4 v[140:143], v9, s[20:23], s43 offen
    v_mfma_f32_16x16x32_bf16 a[4:7], a[144:147], v[60:63], a[4:7]
    v_mfma_f32_16x16x32_bf16 a[8:11], a[148:151], v[60:63], a[8:11]
    v_mfma_f32_16x16x32_bf16 a[12:15], a[152:155], v[60:63], a[12:15]
    v_mfma_f32_16x16x32_bf16 a[16:19], a[156:159], v[60:63], a[16:19]
    buffer_load_dwordx4 a[72:75], v4, s[20:23], s46 offen offset:0
    v_mfma_f32_16x16x32_bf16 a[20:23], a[140:143], v[64:67], a[20:23]
    v_mfma_f32_16x16x32_bf16 a[24:27], a[144:147], v[64:67], a[24:27]
    v_mfma_f32_16x16x32_bf16 a[28:31], a[148:151], v[64:67], a[28:31]
    buffer_load_dwordx4 a[240:243], v3, s[20:23], s47 offen offset:0
    v_mfma_f32_16x16x32_bf16 a[32:35], a[152:155], v[64:67], a[32:35]
    v_mfma_f32_16x16x32_bf16 a[36:39], a[156:159], v[64:67], a[36:39]
    v_mfma_f32_16x16x32_bf16 a[40:43], a[140:143], v[68:71], a[40:43]
    v_mfma_f32_16x16x32_bf16 a[44:47], a[144:147], v[68:71], a[44:47]
    buffer_load_dwordx4 v[144:147], v10, s[20:23], s40 offen
    v_mfma_f32_16x16x32_bf16 a[48:51], a[148:151], v[68:71], a[48:51]
    s_waitcnt vmcnt(28)
    v_max3_u32 v5, v92, v88, v84
    v_max_u32 v5, v5, v80
    v_mfma_f32_16x16x32_bf16 a[52:55], a[152:155], v[68:71], a[52:55]
    v_cmp_eq_u32 vcc, -1, v5
    s_cbranch_vccnz .g3r80
.g3r80b:
    v_mfma_f32_16x16x32_bf16 v[228:231], a[156:159], v[68:71], v[228:231]
    buffer_load_dwordx4 v[148:151], v10, s[20:23], s41 offen
    v_mfma_f32_16x16x32_bf16 v[240:243], a[140:143], v[72:75], v[240:243]
    v_mfma_f32_16x16x32_bf16 v[244:247], a[144:147], v[72:75], v[244:247]
    v_mfma_f32_16x16x32_bf16 v[248:251], a[148:151], v[72:75], v[248:251]
    v_mfma_f32_16x16x32_bf16 v[252:255], a[152:155], v[72:75], v[252:255]
    buffer_load_dwordx4 v[152:155], v10, s[20:23], s42 offen
    v_mfma_f32_16x16x32_bf16 v[224:227], a[156:159], v[72:75], v[224:227]
    v_mfma_f32_16x16x32_bf16 a[0:3], a[160:163], v[80:83], a[0:3]
    v_mfma_f32_16x16x32_bf16 a[4:7], a[164:167], v[80:83], a[4:7]
    buffer_load_dwordx4 v[156:159], v10, s[20:23], s43 offen
    v_mfma_f32_16x16x32_bf16 a[8:11], a[168:171], v[80:83], a[8:11]
    v_mfma_f32_16x16x32_bf16 a[12:15], a[172:175], v[80:83], a[12:15]
    v_mfma_f32_16x16x32_bf16 a[16:19], a[176:179], v[80:83], a[16:19]
    v_mfma_f32_16x16x32_bf16 a[20:23], a[160:163], v[84:87], a[20:23]
    buffer_load_dwordx4 a[76:79], v3, s[20:23], s47 offen offset:1024
    v_mfma_f32_16x16x32_bf16 a[24:27], a[164:167], v[84:87], a[24:27]
    v_mfma_f32_16x16x32_bf16 a[28:31], a[168:171], v[84:87], a[28:31]
    v_mfma_f32_16x16x32_bf16 a[32:35], a[172:175], v[84:87], a[32:35]
    buffer_load_dwordx4 a[244:247], v3, s[20:23], s47 offen offset:2048
    v_mfma_f32_16x16x32_bf16 a[36:39], a[176:179], v[84:87], a[36:39]
    v_mfma_f32_16x16x32_bf16 a[40:43], a[160:163], v[88:91], a[40:43]
    v_mfma_f32_16x16x32_bf16 a[44:47], a[164:167], v[88:91], a[44:47]
    v_mfma_f32_16x16x32_bf16 a[48:51], a[168:171], v[88:91], a[48:51]
    buffer_load_dwordx4 v[160:163], v11, s[20:23], s40 offen
    s_add_u32 s40, s40, 4096
    s_waitcnt vmcnt(28)
    v_max3_u32 v5, v108, v104, v100
    v_max_u32 v5, v5, v96
    v_mfma_f32_16x16x32_bf16 a[52:55], a[172:175], v[88:91], a[52:55]
    v_cmp_eq_u32 vcc, -1, v5
    s_cbranch_vccnz .g3r81
.g3r81b:
    v_mfma_f32_16x16x32_bf16 v[228:231], a[176:179], v[88:91], v[228:231]
    v_mfma_f32_16x16x32_bf16 v[240:243], a[160:163], v[92:95], v[240:243]
    buffer_load_dwordx4 v[164:167], v11, s[20:23], s41 offen
    s_add_u32 s41, s41, 4096
    v_mfma_f32_16x16x32_bf16 v[244:247], a[164:167], v[92:95], v[244:247]
    v_mfma_f32_16x16x32_bf16 v[248:251], a[168:171], v[92:95], v[248:251]
    v_mfma_f32_16x16x32_bf16 v[252:255], a[172:175], v[92:95], v[252:255]
    v_mfma_f32_16x16x32_bf16 v[224:227], a[176:179], v[92:95], v[224:227]
    buffer_load_dwordx4 v[168:171], v11, s[20:23], s42 offen
    s_add_u32 s42, s42, 4096
    v_mfma_f32_16x16x32_bf16 a[0:3], a[180:183], v[96:99], a[0:3]
    v_mfma_f32_16x16x32_bf16 a[4:7], a[184:187], v[96:99], a[4:7]
    v_mfma_f32_16x16x32_bf16 a[8:11], a[188:191], v[96:99], a[8:11]
    buffer_load_dwordx4 v[172:175], v11, s[20:23], s43 offen
    s_add_u32 s43, s43, 4096
    v_mfma_f32_16x16x32_bf16 a[12:15], a[192:195], v[96:99], a[12:15]
    v_mfma_f32_16x16x32_bf16 a[16:19], a[196:199], v[96:99], a[16:19]
    v_mfma_f32_16x16x32_bf16 a[20:23], a[180:183], v[100:103], a[20:23]
    v_mfma_f32_16x16x32_bf16 a[24:27], a[184:187], v[100:103], a[24:27]
    buffer_load_dwordx4 a[248:251], v3, s[20:23], s47 offen offset:3072
    v_mfma_f32_16x16x32_bf16 a[28:31], a[188:191], v[100:103], a[28:31]
    v_mfma_f32_16x16x32_bf16 a[32:35], a[192:195], v[100:103], a[32:35]
    v_mfma_f32_16x16x32_bf16 a[36:39], a[196:199], v[100:103], a[36:39]
    buffer_load_dwordx4 a[252:255], v4, s[20:23], s47 offen offset:0
    v_mfma_f32_16x16x32_bf16 a[40:43], a[180:183], v[104:107], a[40:43]
    v_mfma_f32_16x16x32_bf16 a[44:47], a[184:187], v[104:107], a[44:47]
    v_mfma_f32_16x16x32_bf16 a[48:51], a[188:191], v[104:107], a[48:51]
    s_waitcnt vmcnt(26)
    v_max3_u32 v5, v184, v180, v176
    v_max_u32 v5, v5, v112
    v_mfma_f32_16x16x32_bf16 a[52:55], a[192:195], v[104:107], a[52:55]
    buffer_load_dwordx2 v[192:193], v12, s[20:23], s40 offen offset:0
    v_cmp_eq_u32 vcc, -1, v5
    s_cbranch_vccnz .g3r82
.g3r82b:
    v_mfma_f32_16x16x32_bf16 v[228:231], a[196:199], v[104:107], v[228:231]
    v_mfma_f32_16x16x32_bf16 v[240:243], a[180:183], v[108:111], v[240:243]
    v_mfma_f32_16x16x32_bf16 v[244:247], a[184:187], v[108:111], v[244:247]
    buffer_load_dwordx2 v[194:195], v12, s[20:23], s40 offen offset:512
    v_mfma_f32_16x16x32_bf16 v[248:251], a[188:191], v[108:111], v[248:251]
    v_mfma_f32_16x16x32_bf16 v[252:255], a[192:195], v[108:111], v[252:255]
    v_mfma_f32_16x16x32_bf16 v[224:227], a[196:199], v[108:111], v[224:227]
    v_mfma_f32_16x16x32_bf16 a[0:3], a[200:203], v[112:115], a[0:3]
    buffer_load_dwordx2 v[196:197], v12, s[20:23], s40 offen offset:1024
    v_mfma_f32_16x16x32_bf16 a[4:7], a[204:207], v[112:115], a[4:7]
    v_mfma_f32_16x16x32_bf16 a[8:11], a[208:211], v[112:115], a[8:11]
    v_mfma_f32_16x16x32_bf16 a[12:15], a[212:215], v[112:115], a[12:15]
    buffer_load_dwordx2 v[200:201], v12, s[20:23], s41 offen offset:0
    v_mfma_f32_16x16x32_bf16 a[16:19], a[216:219], v[112:115], a[16:19]
    v_mfma_f32_16x16x32_bf16 a[20:23], a[200:203], v[176:179], a[20:23]
    v_mfma_f32_16x16x32_bf16 a[24:27], a[204:207], v[176:179], a[24:27]
    v_mfma_f32_16x16x32_bf16 a[28:31], a[208:211], v[176:179], a[28:31]
    buffer_load_dwordx2 v[202:203], v12, s[20:23], s41 offen offset:512
    v_mfma_f32_16x16x32_bf16 a[32:35], a[212:215], v[176:179], a[32:35]
    v_mfma_f32_16x16x32_bf16 a[36:39], a[216:219], v[176:179], a[36:39]
    v_mfma_f32_16x16x32_bf16 a[40:43], a[200:203], v[180:183], a[40:43]
    buffer_load_dwordx2 v[198:199], v12, s[20:23], s41 offen offset:1024
    v_mfma_f32_16x16x32_bf16 a[44:47], a[204:207], v[180:183], a[44:47]
    v_mfma_f32_16x16x32_bf16 a[48:51], a[208:211], v[180:183], a[48:51]
    s_waitcnt vmcnt(25)
    v_max3_u32 v5, v124, v120, v116
    v_max_u32 v5, v5, v188
    v_mfma_f32_16x16x32_bf16 a[52:55], a[212:215], v[180:183], a[52:55]
    v_cmp_eq_u32 vcc, -1, v5
    s_cbranch_vccnz .g3r83
.g3r83b:
    v_mfma_f32_16x16x32_bf16 v[228:231], a[216:219], v[180:183], v[228:231]
    buffer_load_dwordx2 v[204:205], v12, s[20:23], s42 offen offset:0
    v_mfma_f32_16x16x32_bf16 v[240:243], a[200:203], v[184:187], v[240:243]
    v_mfma_f32_16x16x32_bf16 v[244:247], a[204:207], v[184:187], v[244:247]
    v_mfma_f32_16x16x32_bf16 v[248:251], a[208:211], v[184:187], v[248:251]
    buffer_load_dwordx2 v[206:207], v12, s[20:23], s42 offen offset:512
    v_mfma_f32_16x16x32_bf16 v[252:255], a[212:215], v[184:187], v[252:255]
    v_mfma_f32_16x16x32_bf16 v[224:227], a[216:219], v[184:187], v[224:227]
    v_mfma_f32_16x16x32_bf16 a[0:3], a[220:223], v[188:191], a[0:3]
    v_mfma_f32_16x16x32_bf16 a[4:7], a[224:227], v[188:191], a[4:7]
    buffer_load_dwordx2 v[232:233], v12, s[20:23], s42 offen offset:1024
    v_mfma_f32_16x16x32_bf16 a[8:11], a[56:59], v[188:191], a[8:11]
    v_mfma_f32_16x16x32_bf16 a[12:15], v[236:239], v[188:191], a[12:15]
    v_mfma_f32_16x16x32_bf16 a[16:19], v[16:19], v[188:191], a[16:19]
    buffer_load_dwordx2 v[208:209], v12, s[20:23], s43 offen offset:0
    v_mfma_f32_16x16x32_bf16 a[20:23], a[220:223], v[116:119], a[20:23]
    v_mfma_f32_16x16x32_bf16 a[24:27], a[224:227], v[116:119], a[24:27]
    v_mfma_f32_16x16x32_bf16 a[28:31], a[56:59], v[116:119], a[28:31]
    v_mfma_f32_16x16x32_bf16 a[32:35], v[236:239], v[116:119], a[32:35]
    buffer_load_dwordx2 v[210:211], v12, s[20:23], s43 offen offset:512
    v_mfma_f32_16x16x32_bf16 a[36:39], v[16:19], v[116:119], a[36:39]
    v_mfma_f32_16x16x32_bf16 a[40:43], a[220:223], v[120:123], a[40:43]
    v_mfma_f32_16x16x32_bf16 a[44:47], a[224:227], v[120:123], a[44:47]
    buffer_load_dwordx2 v[234:235], v12, s[20:23], s43 offen offset:1024
    v_mfma_f32_16x16x32_bf16 a[48:51], a[56:59], v[120:123], a[48:51]
    s_waitcnt vmcnt(26)
    v_max3_u32 v5, v140, v136, v132
    v_max_u32 v5, v5, v128
    v_mfma_f32_16x16x32_bf16 a[52:55], v[236:239], v[120:123], a[52:55]
    v_cmp_eq_u32 vcc, -1, v5
    s_cbranch_vccnz .g3r84
.g3r84b:
    v_mfma_f32_16x16x32_bf16 v[228:231], v[16:19], v[120:123], v[228:231]
    v_mfma_f32_16x16x32_bf16 v[240:243], a[220:223], v[124:127], v[240:243]
    buffer_load_dwordx4 a[80:83], v3, s[20:23], s48 offen offset:0
    v_mfma_f32_16x16x32_bf16 v[244:247], a[224:227], v[124:127], v[244:247]
    v_mfma_f32_16x16x32_bf16 v[248:251], a[56:59], v[124:127], v[248:251]
    v_mfma_f32_16x16x32_bf16 v[252:255], v[236:239], v[124:127], v[252:255]
    buffer_load_dwordx4 a[84:87], v3, s[20:23], s48 offen offset:1024
    v_mfma_f32_16x16x32_bf16 v[224:227], v[16:19], v[124:127], v[224:227]
    v_mfma_f32_16x16x32_bf16 a[0:3], v[36:39], v[128:131], a[0:3]
    v_mfma_f32_16x16x32_bf16 a[4:7], v[56:59], v[128:131], a[4:7]
    v_mfma_f32_16x16x32_bf16 a[8:11], v[76:79], v[128:131], a[8:11]
    buffer_load_dwordx4 a[88:91], v3, s[20:23], s48 offen offset:2048
    v_mfma_f32_16x16x32_bf16 a[12:15], a[228:231], v[128:131], a[12:15]
    v_mfma_f32_16x16x32_bf16 a[16:19], a[232:235], v[128:131], a[16:19]
    v_mfma_f32_16x16x32_bf16 a[20:23], v[36:39], v[132:135], a[20:23]
    buffer_load_dwordx4 a[92:95], v3, s[20:23], s48 offen offset:3072
    v_mfma_f32_16x16x32_bf16 a[24:27], v[56:59], v[132:135], a[24:27]
    v_mfma_f32_16x16x32_bf16 a[28:31], v[76:79], v[132:135], a[28:31]
    v_mfma_f32_16x16x32_bf16 a[32:35], a[228:231], v[132:135], a[32:35]
    v_mfma_f32_16x16x32_bf16 a[36:39], a[232:235], v[132:135], a[36:39]
    buffer_load_dwordx4 a[96:99], v4, s[20:23], s48 offen offset:0
    v_mfma_f32_16x16x32_bf16 a[40:43], v[36:39], v[136:139], a[40:43]
    v_mfma_f32_16x16x32_bf16 a[44:47], v[56:59], v[136:139], a[44:47]
    v_mfma_f32_16x16x32_bf16 a[48:51], v[76:79], v[136:139], a[48:51]
    buffer_load_dwordx2 a[100:101], v3, s[20:23], s49 offen offset:0
    s_waitcnt vmcnt(26)
    v_max3_u32 v5, v156, v152, v148
    v_max_u32 v5, v5, v144
    v_mfma_f32_16x16x32_bf16 a[52:55], a[228:231], v[136:139], a[52:55]
    v_cmp_eq_u32 vcc, -1, v5
    s_cbranch_vccnz .g3r85
.g3r85b:
    v_mfma_f32_16x16x32_bf16 v[228:231], a[232:235], v[136:139], v[228:231]
    v_mfma_f32_16x16x32_bf16 v[240:243], v[36:39], v[140:143], v[240:243]
    v_mfma_f32_16x16x32_bf16 v[244:247], v[56:59], v[140:143], v[244:247]
    buffer_load_dwordx2 a[102:103], v3, s[20:23], s49 offen offset:1024
    v_mfma_f32_16x16x32_bf16 v[248:251], v[76:79], v[140:143], v[248:251]
    v_mfma_f32_16x16x32_bf16 v[252:255], a[228:231], v[140:143], v[252:255]
    v_mfma_f32_16x16x32_bf16 v[224:227], a[232:235], v[140:143], v[224:227]
    buffer_load_dwordx2 a[104:105], v3, s[20:23], s49 offen offset:2048
    v_mfma_f32_16x16x32_bf16 a[0:3], a[236:239], v[144:147], a[0:3]
    v_mfma_f32_16x16x32_bf16 a[4:7], a[60:63], v[144:147], a[4:7]
    v_mfma_f32_16x16x32_bf16 a[8:11], a[64:67], v[144:147], a[8:11]
    v_mfma_f32_16x16x32_bf16 a[12:15], a[68:71], v[144:147], a[12:15]
    buffer_load_dwordx2 a[106:107], v3, s[20:23], s49 offen offset:3072
    v_mfma_f32_16x16x32_bf16 a[16:19], a[72:75], v[144:147], a[16:19]
    v_mfma_f32_16x16x32_bf16 a[20:23], a[236:239], v[148:151], a[20:23]
    v_mfma_f32_16x16x32_bf16 a[24:27], a[60:63], v[148:151], a[24:27]
    buffer_load_dwordx2 a[108:109], v4, s[20:23], s49 offen offset:0
    v_mfma_f32_16x16x32_bf16 a[28:31], a[64:67], v[148:151], a[28:31]
    v_mfma_f32_16x16x32_bf16 a[32:35], a[68:71], v[148:151], a[32:35]
    v_mfma_f32_16x16x32_bf16 a[36:39], a[72:75], v[148:151], a[36:39]
    v_mfma_f32_16x16x32_bf16 a[40:43], a[236:239], v[152:155], a[40:43]
    buffer_load_dwordx2 v[212:213], v3, s[20:23], s50 offen offset:0 sc1
    v_mfma_f32_16x16x32_bf16 a[44:47], a[60:63], v[152:155], a[44:47]
    v_mfma_f32_16x16x32_bf16 a[48:51], a[64:67], v[152:155], a[48:51]
    s_waitcnt vmcnt(25)
    v_max3_u32 v5, v172, v168, v164
    v_max_u32 v5, v5, v160
    v_mfma_f32_16x16x32_bf16 a[52:55], a[68:71], v[152:155], a[52:55]
    buffer_load_dwordx2 v[214:215], v3, s[20:23], s50 offen offset:1024 sc1
    v_cmp_eq_u32 vcc, -1, v5
    s_cbranch_vccnz .g3r86
.g3r86b:
    v_mfma_f32_16x16x32_bf16 v[228:231], a[72:75], v[152:155], v[228:231]
    v_mfma_f32_16x16x32_bf16 v[240:243], a[236:239], v[156:159], v[240:243]
    v_mfma_f32_16x16x32_bf16 v[244:247], a[60:63], v[156:159], v[244:247]
    v_mfma_f32_16x16x32_bf16 v[248:251], a[64:67], v[156:159], v[248:251]
    buffer_load_dwordx2 v[20:21], v3, s[20:23], s50 offen offset:2048 sc1
    v_mfma_f32_16x16x32_bf16 v[252:255], a[68:71], v[156:159], v[252:255]
    v_mfma_f32_16x16x32_bf16 v[224:227], a[72:75], v[156:159], v[224:227]
    v_mfma_f32_16x16x32_bf16 a[0:3], a[240:243], v[160:163], a[0:3]
    buffer_load_dwordx2 v[22:23], v3, s[20:23], s50 offen offset:3072 sc1
    v_mfma_f32_16x16x32_bf16 a[4:7], a[76:79], v[160:163], a[4:7]
    v_mfma_f32_16x16x32_bf16 a[8:11], a[244:247], v[160:163], a[8:11]
    s_waitcnt vmcnt(27)
    v_mfma_f32_16x16x32_bf16 a[12:15], a[248:251], v[160:163], a[12:15]
    s_waitcnt vmcnt(26)
    v_mfma_f32_16x16x32_bf16 a[16:19], a[252:255], v[160:163], a[16:19]
    buffer_load_dwordx2 v[24:25], v4, s[20:23], s50 offen offset:0 sc1
    s_waitcnt vmcnt(15)
    v_max3_u32 v5, v234, v210, v208
    v_max3_u32 v5, v5, v232, v206
    v_mfma_f32_16x16x32_bf16 a[20:23], a[240:243], v[164:167], a[20:23]
    v_max3_u32 v5, v5, v204, v198
    v_max3_u32 v5, v5, v202, v200
    v_mfma_f32_16x16x32_bf16 a[24:27], a[76:79], v[164:167], a[24:27]
    v_max3_u32 v5, v5, v196, v194
    v_max_u32 v5, v5, v192
    v_mfma_f32_16x16x32_bf16 a[28:31], a[244:247], v[164:167], a[28:31]
    v_cmp_eq_u32 vcc, -1, v5
    s_cbranch_vccnz .g3r87
.g3r87b:
    v_mfma_f32_16x16x32_bf16 a[32:35], a[248:251], v[164:167], a[32:35]
    v_mfma_f32_16x16x32_bf16 a[36:39], a[252:255], v[164:167], a[36:39]
    v_mfma_f32_16x16x32_bf16 a[40:43], a[240:243], v[168:171], a[40:43]
    v_mfma_f32_16x16x32_bf16 a[44:47], a[76:79], v[168:171], a[44:47]
    v_mfma_f32_16x16x32_bf16 a[48:51], a[244:247], v[168:171], a[48:51]
    v_mfma_f32_16x16x32_bf16 a[52:55], a[248:251], v[168:171], a[52:55]
    v_mfma_f32_16x16x32_bf16 v[228:231], a[252:255], v[168:171], v[228:231]
    v_mfma_f32_16x16x32_bf16 v[240:243], a[240:243], v[172:175], v[240:243]
    v_mfma_f32_16x16x32_bf16 v[244:247], a[76:79], v[172:175], v[244:247]
    v_mfma_f32_16x16x32_bf16 v[248:251], a[244:247], v[172:175], v[248:251]
    v_mfma_f32_16x16x32_bf16 v[252:255], a[248:251], v[172:175], v[252:255]
    v_mfma_f32_16x16x32_bf16 v[224:227], a[252:255], v[172:175], v[224:227]
    s_waitcnt vmcnt(14)
    v_mfma_f32_16x16x32_bf16 a[0:3], a[80:83], v[192:195], a[0:3]
    s_add_u32 s4, s3, 1
    s_and_b32 s4, s4, 3
    s_mul_i32 s4, s4, 15360
    v_add_u32 v8, s4, v3
    s_add_u32 s4, s3, 2
    s_and_b32 s4, s4, 3
    s_mul_i32 s4, s4, 15360
    v_add_u32 v9, s4, v3
    s_waitcnt vmcnt(13)
    v_mfma_f32_16x16x32_bf16 a[4:7], a[84:87], v[192:195], a[4:7]
    s_add_u32 s4, s3, 3
    s_and_b32 s4, s4, 3
    s_mul_i32 s4, s4, 15360
    v_add_u32 v10, s4, v3
    s_add_u32 s4, s3, 4
    s_and_b32 s4, s4, 3
    s_mul_i32 s4, s4, 15360
    v_add_u32 v11, s4, v3
    s_waitcnt vmcnt(12)
    v_mfma_f32_16x16x32_bf16 a[8:11], a[88:91], v[192:195], a[8:11]
    v_lshrrev_b32 v6, 8, v3
    v_bfe_u32 v7, v3, 4, 4
    s_waitcnt vmcnt(11)
    v_mfma_f32_16x16x32_bf16 a[12:15], a[92:95], v[192:195], a[12:15]
    v_mul_u32_u24 v7, 1280, v7
    v_lshl_add_u32 v7, v6, 3, v7
    s_waitcnt vmcnt(10)
    v_mfma_f32_16x16x32_bf16 a[16:19], a[96:99], v[192:195], a[16:19]
    s_waitcnt vmcnt(9)
    v_mfma_f32_16x16x16_bf16 a[0:3], a[100:101], v[196:197], a[0:3]
    s_waitcnt vmcnt(8)
    v_mfma_f32_16x16x16_bf16 a[4:7], a[102:103], v[196:197], a[4:7]
    s_waitcnt vmcnt(7)
    v_mfma_f32_16x16x16_bf16 a[8:11], a[104:105], v[196:197], a[8:11]
    s_waitcnt vmcnt(6)
    v_mfma_f32_16x16x16_bf16 a[12:15], a[106:107], v[196:197], a[12:15]
    s_waitcnt vmcnt(5)
    v_mfma_f32_16x16x16_bf16 a[16:19], a[108:109], v[196:197], a[16:19]
    ds_write_b128 v8, a[0:3] offset:20480
    v_mfma_f32_16x16x32_bf16 a[20:23], a[80:83], v[200:203], a[20:23]
    ds_write_b128 v8, a[4:7] offset:21504
    v_mfma_f32_16x16x32_bf16 a[24:27], a[84:87], v[200:203], a[24:27]
    ds_write_b128 v8, a[8:11] offset:22528
    v_mfma_f32_16x16x32_bf16 a[28:31], a[88:91], v[200:203], a[28:31]
    ds_write_b128 v8, a[12:15] offset:23552
    v_mfma_f32_16x16x32_bf16 a[32:35], a[92:95], v[200:203], a[32:35]
    ds_write_b128 v8, a[16:19] offset:24576
    v_mfma_f32_16x16x32_bf16 a[36:39], a[96:99], v[200:203], a[36:39]
    v_mfma_f32_16x16x16_bf16 a[20:23], a[100:101], v[198:199], a[20:23]
    v_mfma_f32_16x16x16_bf16 a[24:27], a[102:103], v[198:199], a[24:27]
    v_mfma_f32_16x16x16_bf16 a[28:31], a[104:105], v[198:199], a[28:31]
    v_mfma_f32_16x16x16_bf16 a[32:35], a[106:107], v[198:199], a[32:35]
    v_mfma_f32_16x16x16_bf16 a[36:39], a[108:109], v[198:199], a[36:39]
    ds_write_b128 v9, a[20:23] offset:25600
    v_mfma_f32_16x16x32_bf16 a[40:43], a[80:83], v[204:207], a[40:43]
    ds_write_b128 v9, a[24:27] offset:26624
    v_mfma_f32_16x16x32_bf16 a[44:47], a[84:87], v[204:207], a[44:47]
    ds_write_b128 v9, a[28:31] offset:27648
    v_mfma_f32_16x16x32_bf16 a[48:51], a[88:91], v[204:207], a[48:51]
    ds_write_b128 v9, a[32:35] offset:28672
    v_mfma_f32_16x16x32_bf16 a[52:55], a[92:95], v[204:207], a[52:55]
    ds_write_b128 v9, a[36:39] offset:29696
    v_mfma_f32_16x16x32_bf16 v[228:231], a[96:99], v[204:207], v[228:231]
    v_mfma_f32_16x16x16_bf16 a[40:43], a[100:101], v[232:233], a[40:43]
    v_mfma_f32_16x16x16_bf16 a[44:47], a[102:103], v[232:233], a[44:47]
    v_mfma_f32_16x16x16_bf16 a[48:51], a[104:105], v[232:233], a[48:51]
    v_mfma_f32_16x16x16_bf16 a[52:55], a[106:107], v[232:233], a[52:55]
    v_mfma_f32_16x16x16_bf16 v[228:231], a[108:109], v[232:233], v[228:231]
    ds_write_b128 v10, a[40:43] offset:30720
    v_mfma_f32_16x16x32_bf16 v[240:243], a[80:83], v[208:211], v[240:243]
    ds_write_b128 v10, a[44:47] offset:31744
    v_mfma_f32_16x16x32_bf16 v[244:247], a[84:87], v[208:211], v[244:247]
    ds_write_b128 v10, a[48:51] offset:32768
    v_mfma_f32_16x16x32_bf16 v[248:251], a[88:91], v[208:211], v[248:251]
    ds_write_b128 v10, a[52:55] offset:33792
    v_mfma_f32_16x16x32_bf16 v[252:255], a[92:95], v[208:211], v[252:255]
    ds_write_b128 v10, v[228:231] offset:34816
    v_mfma_f32_16x16x32_bf16 v[224:227], a[96:99], v[208:211], v[224:227]
    v_mfma_f32_16x16x16_bf16 v[240:243], a[100:101], v[234:235], v[240:243]
    v_mfma_f32_16x16x16_bf16 v[244:247], a[102:103], v[234:235], v[244:247]
    v_mfma_f32_16x16x16_bf16 v[248:251], a[104:105], v[234:235], v[248:251]
    v_mfma_f32_16x16x16_bf16 v[252:255], a[106:107], v[234:235], v[252:255]
    v_mfma_f32_16x16x16_bf16 v[224:227], a[108:109], v[234:235], v[224:227]
    s_nop 3
    s_waitcnt lgkmcnt(0)
    s_barrier
    ds_read_b128 v[28:31], v11 offset:20480
    ds_read_b128 v[32:35], v11 offset:21504
    ds_read_b128 v[216:219], v11 offset:22528
    ds_read_b128 v[220:223], v11 offset:23552
    ds_read_b128 v[40:43], v11 offset:24576
    ds_read_b128 v[44:47], v11 offset:25600
    ds_read_b128 v[48:51], v11 offset:26624
    ds_read_b128 v[52:55], v11 offset:27648
    ds_read_b128 v[60:63], v11 offset:28672
    ds_read_b128 v[64:67], v11 offset:29696
    ds_read_b128 v[68:71], v11 offset:30720
    ds_read_b128 v[72:75], v11 offset:31744
    ds_read_b128 v[80:83], v11 offset:32768
    ds_read_b128 v[84:87], v11 offset:33792
    ds_read_b128 v[88:91], v11 offset:34816
    s_waitcnt vmcnt(0)
    v_lshlrev_b32 v92, 16, v212
    v_and_b32 v93, s59, v212
    v_lshlrev_b32 v94, 16, v213
    v_and_b32 v95, s59, v213
    v_lshlrev_b32 v96, 16, v214
    v_and_b32 v97, s59, v214
    v_lshlrev_b32 v98, 16, v215
    v_and_b32 v99, s59, v215
    v_lshlrev_b32 v100, 16, v20
    v_and_b32 v101, s59, v20
    v_lshlrev_b32 v102, 16, v21
    v_and_b32 v103, s59, v21
    v_lshlrev_b32 v104, 16, v22
    v_and_b32 v105, s59, v22
    v_lshlrev_b32 v106, 16, v23
    v_and_b32 v107, s59, v23
    v_lshlrev_b32 v108, 16, v24
    v_and_b32 v109, s59, v24
    v_lshlrev_b32 v110, 16, v25
    v_and_b32 v111, s59, v25
    v_pk_add_f32 v[92:93], v[92:93], v[240:241]
    v_pk_add_f32 v[94:95], v[94:95], v[242:243]
    v_pk_add_f32 v[96:97], v[96:97], v[244:245]
    v_pk_add_f32 v[98:99], v[98:99], v[246:247]
    v_pk_add_f32 v[100:101], v[100:101], v[248:249]
    v_pk_add_f32 v[102:103], v[102:103], v[250:251]
    v_pk_add_f32 v[104:105], v[104:105], v[252:253]
    v_pk_add_f32 v[106:107], v[106:107], v[254:255]
    v_pk_add_f32 v[108:109], v[108:109], v[224:225]
    v_pk_add_f32 v[110:111], v[110:111], v[226:227]
    s_waitcnt lgkmcnt(14)
    v_pk_add_f32 v[92:93], v[92:93], v[28:29]
    v_pk_add_f32 v[94:95], v[94:95], v[30:31]
    s_waitcnt lgkmcnt(13)
    v_pk_add_f32 v[96:97], v[96:97], v[32:33]
    v_pk_add_f32 v[98:99], v[98:99], v[34:35]
    s_waitcnt lgkmcnt(12)
    v_pk_add_f32 v[100:101], v[100:101], v[216:217]
    v_pk_add_f32 v[102:103], v[102:103], v[218:219]
    s_waitcnt lgkmcnt(11)
    v_pk_add_f32 v[104:105], v[104:105], v[220:221]
    v_pk_add_f32 v[106:107], v[106:107], v[222:223]
    s_waitcnt lgkmcnt(10)
    v_pk_add_f32 v[108:109], v[108:109], v[40:41]
    v_pk_add_f32 v[110:111], v[110:111], v[42:43]
    s_waitcnt lgkmcnt(9)
    v_pk_add_f32 v[92:93], v[92:93], v[44:45]
    v_pk_add_f32 v[94:95], v[94:95], v[46:47]
    s_waitcnt lgkmcnt(8)
    v_pk_add_f32 v[96:97], v[96:97], v[48:49]
    v_pk_add_f32 v[98:99], v[98:99], v[50:51]
    s_waitcnt lgkmcnt(7)
    v_pk_add_f32 v[100:101], v[100:101], v[52:53]
    v_pk_add_f32 v[102:103], v[102:103], v[54:55]
    s_waitcnt lgkmcnt(6)
    v_pk_add_f32 v[104:105], v[104:105], v[60:61]
    v_pk_add_f32 v[106:107], v[106:107], v[62:63]
    s_waitcnt lgkmcnt(5)
    v_pk_add_f32 v[108:109], v[108:109], v[64:65]
    v_pk_add_f32 v[110:111], v[110:111], v[66:67]
    s_waitcnt lgkmcnt(4)
    v_pk_add_f32 v[92:93], v[92:93], v[68:69]
    v_pk_add_f32 v[94:95], v[94:95], v[70:71]
    v_cvt_pk_bf16_f32 v92, v92, v93
    v_cvt_pk_bf16_f32 v93, v94, v95
    global_store_dwordx2 v7, v[92:93], s[94:95] offset:0
    s_waitcnt lgkmcnt(3)
    v_pk_add_f32 v[96:97], v[96:97], v[72:73]
    v_pk_add_f32 v[98:99], v[98:99], v[74:75]
    v_cvt_pk_bf16_f32 v96, v96, v97
    v_cvt_pk_bf16_f32 v97, v98, v99
    global_store_dwordx2 v7, v[96:97], s[94:95] offset:32
    s_waitcnt lgkmcnt(2)
    v_pk_add_f32 v[100:101], v[100:101], v[80:81]
    v_pk_add_f32 v[102:103], v[102:103], v[82:83]
    v_cvt_pk_bf16_f32 v100, v100, v101
    v_cvt_pk_bf16_f32 v101, v102, v103
    global_store_dwordx2 v7, v[100:101], s[94:95] offset:64
    s_waitcnt lgkmcnt(1)
    v_pk_add_f32 v[104:105], v[104:105], v[84:85]
    v_pk_add_f32 v[106:107], v[106:107], v[86:87]
    v_cvt_pk_bf16_f32 v104, v104, v105
    v_cvt_pk_bf16_f32 v105, v106, v107
    global_store_dwordx2 v7, v[104:105], s[94:95] offset:96
    s_waitcnt lgkmcnt(0)
    v_pk_add_f32 v[108:109], v[108:109], v[88:89]
    v_pk_add_f32 v[110:111], v[110:111], v[90:91]
    v_cvt_pk_bf16_f32 v108, v108, v109
    v_cvt_pk_bf16_f32 v109, v110, v111
    global_store_dwordx2 v7, v[108:109], s[94:95] offset:128
    s_endpgm
.rl45:
    s_mov_b32 s33, 200000
.rl45l:
    global_load_dword v209, v208, s[16:17] sc1
    s_waitcnt vmcnt(0)
    v_cmp_eq_u32 vcc, 0, v209
    s_cbranch_vccz .rl45b
    s_sub_u32 s33, s33, 1
    s_cmp_lg_u32 s33, 0
    s_cbranch_scc1 .rl45l
    s_branch .rl45b
.rl46:
    s_mov_b32 s33, 200000
.rl46l:
    global_load_dword v209, v208, s[16:17] sc1
    s_waitcnt vmcnt(0)
    v_cmp_eq_u32 vcc, 0, v209
    s_cbranch_vccz .rl46b
    s_sub_u32 s33, s33, 1
    s_cmp_lg_u32 s33, 0
    s_cbranch_scc1 .rl46l
    s_branch .rl46b
.rl48:
    s_mov_b32 s33, 200000
.rl48l:
    global_load_dword v209, v208, s[16:17] sc1
    s_waitcnt vmcnt(0)
    v_cmp_eq_u32 vcc, 0, v209
    s_cbranch_vccz .rl48b
    s_sub_u32 s33, s33, 1
    s_cmp_lg_u32 s33, 0
    s_cbranch_scc1 .rl48l
    s_branch .rl48b
.hr53:
    s_mov_b32 s60, 200000
.hr53l:
    buffer_load_dwordx4 v[16:19], v3, s[20:23], s24 offen offset:0 sc1
    buffer_load_dwordx4 v[20:23], v3, s[20:23], s24 offen offset:1024 sc1
    buffer_load_dwordx4 v[24:27], v3, s[20:23], s24 offen offset:2048 sc1
    buffer_load_dwordx4 v[28:31], v3, s[20:23], s24 offen offset:3072 sc1
    buffer_load_dwordx4 v[32:35], v4, s[20:23], s24 offen offset:0 sc1
    buffer_load_dwordx4 v[36:39], v4, s[20:23], s24 offen offset:1024 sc1
    buffer_load_dwordx4 v[40:43], v4, s[20:23], s24 offen offset:2048 sc1
    buffer_load_dwordx4 v[44:47], v4, s[20:23], s24 offen offset:3072 sc1
    buffer_load_dwordx4 v[48:51], v5, s[20:23], s24 offen offset:0 sc1
    buffer_load_dwordx4 v[52:55], v5, s[20:23], s24 offen offset:1024 sc1
    buffer_load_dwordx4 v[56:59], v3, s[20:23], s25 offen offset:0 sc1
    buffer_load_dwordx4 v[60:63], v3, s[20:23], s25 offen offset:1024 sc1
    buffer_load_dwordx4 v[64:67], v3, s[20:23], s25 offen offset:2048 sc1
    buffer_load_dwordx4 v[68:71], v3, s[20:23], s25 offen offset:3072 sc1
    buffer_load_dwordx4 v[72:75], v4, s[20:23], s25 offen offset:0 sc1
    buffer_load_dwordx4 v[76:79], v4, s[20:23], s25 offen offset:1024 sc1
    s_waitcnt vmcnt(0)
    v_max_u32 v2, v16, v20
    v_cmp_eq_u32 vcc, -1, v2
    s_cbranch_vccz .hr53b
    s_sub_u32 s60, s60, 1
    s_cmp_lg_u32 s60, 0
    s_cbranch_scc1 .hr53l
    s_branch .hr53b
.hr54:
    s_mov_b32 s60, 200000
.hr54l:
    buffer_load_dwordx4 v[24:27], v3, s[20:23], s24 offen offset:2048 sc1
    buffer_load_dwordx4 v[28:31], v3, s[20:23], s24 offen offset:3072 sc1
    buffer_load_dwordx4 v[32:35], v4, s[20:23], s24 offen offset:0 sc1
    buffer_load_dwordx4 v[36:39], v4, s[20:23], s24 offen offset:1024 sc1
    buffer_load_dwordx4 v[40:43], v4, s[20:23], s24 offen offset:2048 sc1
    buffer_load_dwordx4 v[44:47], v4, s[20:23], s24 offen offset:3072 sc1
    buffer_load_dwordx4 v[48:51], v5, s[20:23], s24 offen offset:0 sc1
    buffer_load_dwordx4 v[52:55], v5, s[20:23], s24 offen offset:1024 sc1
    buffer_load_dwordx4 v[56:59], v3, s[20:23], s25 offen offset:0 sc1
    buffer_load_dwordx4 v[60:63], v3, s[20:23], s25 offen offset:1024 sc1
    buffer_load_dwordx4 v[64:67], v3, s[20:23], s25 offen offset:2048 sc1
    buffer_load_dwordx4 v[68:71], v3, s[20:23], s25 offen offset:3072 sc1
    buffer_load_dwordx4 v[72:75], v4, s[20:23], s25 offen offset:0 sc1
    buffer_load_dwordx4 v[76:79], v4, s[20:23], s25 offen offset:1024 sc1
    s_waitcnt vmcnt(0)
    v_max_u32 v2, v24, v28
    v_cmp_eq_u32 vcc, -1, v2
    s_cbranch_vccz .hr54b
    s_sub_u32 s60, s60, 1
    s_cmp_lg_u32 s60, 0
    s_cbranch_scc1 .hr54l
    s_branch .hr54b
.hr55:
    s_mov_b32 s60, 200000
.hr55l:
    buffer_load_dwordx4 v[32:35], v4, s[20:23], s24 offen offset:0 sc1
    buffer_load_dwordx4 v[36:39], v4, s[20:23], s24 offen offset:1024 sc1
    buffer_load_dwordx4 v[40:43], v4, s[20:23], s24 offen offset:2048 sc1
    buffer_load_dwordx4 v[44:47], v4, s[20:23], s24 offen offset:3072 sc1
    buffer_load_dwordx4 v[48:51], v5, s[20:23], s24 offen offset:0 sc1
    buffer_load_dwordx4 v[52:55], v5, s[20:23], s24 offen offset:1024 sc1
    buffer_load_dwordx4 v[56:59], v3, s[20:23], s25 offen offset:0 sc1
    buffer_load_dwordx4 v[60:63], v3, s[20:23], s25 offen offset:1024 sc1
    buffer_load_dwordx4 v[64:67], v3, s[20:23], s25 offen offset:2048 sc1
    buffer_load_dwordx4 v[68:71], v3, s[20:23], s25 offen offset:3072 sc1
    buffer_load_dwordx4 v[72:75], v4, s[20:23], s25 offen offset:0 sc1
    buffer_load_dwordx4 v[76:79], v4, s[20:23], s25 offen offset:1024 sc1
    buffer_load_dwordx4 v[80:83], v4, s[20:23], s25 offen offset:2048 sc1
    buffer_load_dwordx4 v[84:87], v4, s[20:23], s25 offen offset:3072 sc1
    buffer_load_dwordx4 v[88:91], v5, s[20:23], s25 offen offset:0 sc1
    buffer_load_dwordx4 v[92:95], v5, s[20:23], s25 offen offset:1024 sc1
    s_waitcnt vmcnt(0)
    v_max_u32 v2, v32, v36
    v_cmp_eq_u32 vcc, -1, v2
    s_cbranch_vccz .hr55b
    s_sub_u32 s60, s60, 1
    s_cmp_lg_u32 s60, 0
    s_cbranch_scc1 .hr55l
    s_branch .hr55b
.hr56:
    s_mov_b32 s60, 200000
.hr56l:
    buffer_load_dwordx4 v[40:43], v4, s[20:23], s24 offen offset:2048 sc1
    buffer_load_dwordx4 v[44:47], v4, s[20:23], s24 offen offset:3072 sc1
    buffer_load_dwordx4 v[48:51], v5, s[20:23], s24 offen offset:0 sc1
    buffer_load_dwordx4 v[52:55], v5, s[20:23], s24 offen offset:1024 sc1
    buffer_load_dwordx4 v[56:59], v3, s[20:23], s25 offen offset:0 sc1
    buffer_load_dwordx4 v[60:63], v3, s[20:23], s25 offen offset:1024 sc1
    buffer_load_dwordx4 v[64:67], v3, s[20:23], s25 offen offset:2048 sc1
    buffer_load_dwordx4 v[68:71], v3, s[20:23], s25 offen offset:3072 sc1
    buffer_load_dwordx4 v[72:75], v4, s[20:23], s25 offen offset:0 sc1
    buffer_load_dwordx4 v[76:79], v4, s[20:23], s25 offen offset:1024 sc1
    buffer_load_dwordx4 v[80:83], v4, s[20:23], s25 offen offset:2048 sc1
    buffer_load_dwordx4 v[84:87], v4, s[20:23], s25 offen offset:3072 sc1
    buffer_load_dwordx4 v[88:91], v5, s[20:23], s25 offen offset:0 sc1
    buffer_load_dwordx4 v[92:95], v5, s[20:23], s25 offen offset:1024 sc1
    buffer_load_dwordx4 v[96:99], v3, s[20:23], s26 offen offset:0 sc1
    buffer_load_dwordx4 v[100:103], v3, s[20:23], s26 offen offset:1024 sc1
    buffer_load_dwordx4 v[104:107], v3, s[20:23], s26 offen offset:2048 sc1
    buffer_load_dwordx4 v[108:111], v3, s[20:23], s26 offen offset:3072 sc1
    s_waitcnt vmcnt(0)
    v_max_u32 v2, v40, v44
    v_cmp_eq_u32 vcc, -1, v2
    s_cbranch_vccz .hr56b
    s_sub_u32 s60, s60, 1
    s_cmp_lg_u32 s60, 0
    s_cbranch_scc1 .hr56l
    s_branch .hr56b
.hr57:
    s_mov_b32 s60, 200000
.hr57l:
    buffer_load_dwordx4 v[48:51], v5, s[20:23], s24 offen offset:0 sc1
    buffer_load_dwordx4 v[52:55], v5, s[20:23], s24 offen offset:1024 sc1
    buffer_load_dwordx4 v[56:59], v3, s[20:23], s25 offen offset:0 sc1
    buffer_load_dwordx4 v[60:63], v3, s[20:23], s25 offen offset:1024 sc1
    buffer_load_dwordx4 v[64:67], v3, s[20:23], s25 offen offset:2048 sc1
    buffer_load_dwordx4 v[68:71], v3, s[20:23], s25 offen offset:3072 sc1
    buffer_load_dwordx4 v[72:75], v4, s[20:23], s25 offen offset:0 sc1
    buffer_load_dwordx4 v[76:79], v4, s[20:23], s25 offen offset:1024 sc1
    buffer_load_dwordx4 v[80:83], v4, s[20:23], s25 offen offset:2048 sc1
    buffer_load_dwordx4 v[84:87], v4, s[20:23], s25 offen offset:3072 sc1
    buffer_load_dwordx4 v[88:91], v5, s[20:23], s25 offen offset:0 sc1
    buffer_load_dwordx4 v[92:95], v5, s[20:23], s25 offen offset:1024 sc1
    buffer_load_dwordx4 v[96:99], v3, s[20:23], s26 offen offset:0 sc1
    buffer_load_dwordx4 v[100:103], v3, s[20:23], s26 offen offset:1024 sc1
    buffer_load_dwordx4 v[104:107], v3, s[20:23], s26 offen offset:2048 sc1
    buffer_load_dwordx4 v[108:111], v3, s[20:23], s26 offen offset:3072 sc1
    buffer_load_dwordx4 v[112:115], v4, s[20:23], s26 offen offset:0 sc1
    buffer_load_dwordx4 v[116:119], v4, s[20:23], s26 offen offset:1024 sc1
    buffer_load_dwordx4 v[120:123], v4, s[20:23], s26 offen offset:2048 sc1
    buffer_load_dwordx4 v[124:127], v4, s[20:23], s26 offen offset:3072 sc1
    s_waitcnt vmcnt(0)
    v_max_u32 v2, v48, v52
    v_cmp_eq_u32 vcc, -1, v2
    s_cbranch_vccz .hr57b
    s_sub_u32 s60, s60, 1
    s_cmp_lg_u32 s60, 0
    s_cbranch_scc1 .hr57l
    s_branch .hr57b
.hr58:
    s_mov_b32 s60, 200000
.hr58l:
    buffer_load_dwordx4 v[56:59], v3, s[20:23], s25 offen offset:0 sc1
    buffer_load_dwordx4 v[60:63], v3, s[20:23], s25 offen offset:1024 sc1
    buffer_load_dwordx4 v[64:67], v3, s[20:23], s25 offen offset:2048 sc1
    buffer_load_dwordx4 v[68:71], v3, s[20:23], s25 offen offset:3072 sc1
    buffer_load_dwordx4 v[72:75], v4, s[20:23], s25 offen offset:0 sc1
    buffer_load_dwordx4 v[76:79], v4, s[20:23], s25 offen offset:1024 sc1
    buffer_load_dwordx4 v[80:83], v4, s[20:23], s25 offen offset:2048 sc1
    buffer_load_dwordx4 v[84:87], v4, s[20:23], s25 offen offset:3072 sc1
    buffer_load_dwordx4 v[88:91], v5, s[20:23], s25 offen offset:0 sc1
    buffer_load_dwordx4 v[92:95], v5, s[20:23], s25 offen offset:1024 sc1
    buffer_load_dwordx4 v[96:99], v3, s[20:23], s26 offen offset:0 sc1
    buffer_load_dwordx4 v[100:103], v3, s[20:23], s26 offen offset:1024 sc1
    buffer_load_dwordx4 v[104:107], v3, s[20:23], s26 offen offset:2048 sc1
    buffer_load_dwordx4 v[108:111], v3, s[20:23], s26 offen offset:3072 sc1
    buffer_load_dwordx4 v[112:115], v4, s[20:23], s26 offen offset:0 sc1
    buffer_load_dwordx4 v[116:119], v4, s[20:23], s26 offen offset:1024 sc1
    buffer_load_dwordx4 v[120:123], v4, s[20:23], s26 offen offset:2048 sc1
    buffer_load_dwordx4 v[124:127], v4, s[20:23], s26 offen offset:3072 sc1
    buffer_load_dwordx4 v[128:131], v5, s[20:23], s26 offen offset:0 sc1
    buffer_load_dwordx4 v[132:135], v5, s[20:23], s26 offen offset:1024 sc1
    buffer_load_dwordx4 v[136:139], v3, s[20:23], s27 offen offset:0 sc1
    buffer_load_dwordx4 v[140:143], v3, s[20:23], s27 offen offset:1024 sc1
    s_waitcnt vmcnt(0)
    v_max_u32 v2, v56, v60
    v_cmp_eq_u32 vcc, -1, v2
    s_cbranch_vccz .hr58b
    s_sub_u32 s60, s60, 1
    s_cmp_lg_u32 s60, 0
    s_cbranch_scc1 .hr58l
    s_branch .hr58b
.hr59:
    s_mov_b32 s60, 200000
.hr59l:
    buffer_load_dwordx4 v[64:67], v3, s[20:23], s25 offen offset:2048 sc1
    buffer_load_dwordx4 v[68:71], v3, s[20:23], s25 offen offset:3072 sc1
    buffer_load_dwordx4 v[72:75], v4, s[20:23], s25 offen offset:0 sc1
    buffer_load_dwordx4 v[76:79], v4, s[20:23], s25 offen offset:1024 sc1
    buffer_load_dwordx4 v[80:83], v4, s[20:23], s25 offen offset:2048 sc1
    buffer_load_dwordx4 v[84:87], v4, s[20:23], s25 offen offset:3072 sc1
    buffer_load_dwordx4 v[88:91], v5, s[20:23], s25 offen offset:0 sc1
    buffer_load_dwordx4 v[92:95], v5, s[20:23], s25 offen offset:1024 sc1
    buffer_load_dwordx4 v[96:99], v3, s[20:23], s26 offen offset:0 sc1
    buffer_load_dwordx4 v[100:103], v3, s[20:23], s26 offen offset:1024 sc1
    buffer_load_dwordx4 v[104:107], v3, s[20:23], s26 offen offset:2048 sc1
    buffer_load_dwordx4 v[108:111], v3, s[20:23], s26 offen offset:3072 sc1
    buffer_load_dwordx4 v[112:115], v4, s[20:23], s26 offen offset:0 sc1
    buffer_load_dwordx4 v[116:119], v4, s[20:23], s26 offen offset:1024 sc1
    buffer_load_dwordx4 v[120:123], v4, s[20:23], s26 offen offset:2048 sc1
    buffer_load_dwordx4 v[124:127], v4, s[20:23], s26 offen offset:3072 sc1
    buffer_load_dwordx4 v[128:131], v5, s[20:23], s26 offen offset:0 sc1
    buffer_load_dwordx4 v[132:135], v5, s[20:23], s26 offen offset:1024 sc1
    buffer_load_dwordx4 v[136:139], v3, s[20:23], s27 offen offset:0 sc1
    buffer_load_dwordx4 v[140:143], v3, s[20:23], s27 offen offset:1024 sc1
    buffer_load_dwordx4 v[144:147], v3, s[20:23], s27 offen offset:2048 sc1
    buffer_load_dwordx4 v[148:151], v3, s[20:23], s27 offen offset:3072 sc1
    buffer_load_dwordx4 v[152:155], v4, s[20:23], s27 offen offset:0 sc1
    buffer_load_dwordx4 v[156:159], v4, s[20:23], s27 offen offset:1024 sc1
    s_waitcnt vmcnt(0)
    v_max_u32 v2, v64, v68
    v_cmp_eq_u32 vcc, -1, v2
    s_cbranch_vccz .hr59b
    s_sub_u32 s60, s60, 1
    s_cmp_lg_u32 s60, 0
    s_cbranch_scc1 .hr59l
    s_branch .hr59b
.hr60:
    s_mov_b32 s60, 200000
.hr60l:
    buffer_load_dwordx4 v[72:75], v4, s[20:23], s25 offen offset:0 sc1
    buffer_load_dwordx4 v[76:79], v4, s[20:23], s25 offen offset:1024 sc1
    buffer_load_dwordx4 v[80:83], v4, s[20:23], s25 offen offset:2048 sc1
    buffer_load_dwordx4 v[84:87], v4, s[20:23], s25 offen offset:3072 sc1
    buffer_load_dwordx4 v[88:91], v5, s[20:23], s25 offen offset:0 sc1
    buffer_load_dwordx4 v[92:95], v5, s[20:23], s25 offen offset:1024 sc1
    buffer_load_dwordx4 v[96:99], v3, s[20:23], s26 offen offset:0 sc1
    buffer_load_dwordx4 v[100:103], v3, s[20:23], s26 offen offset:1024 sc1
    buffer_load_dwordx4 v[104:107], v3, s[20:23], s26 offen offset:2048 sc1
    buffer_load_dwordx4 v[108:111], v3, s[20:23], s26 offen offset:3072 sc1
    buffer_load_dwordx4 v[112:115], v4, s[20:23], s26 offen offset:0 sc1
    buffer_load_dwordx4 v[116:119], v4, s[20:23], s26 offen offset:1024 sc1
    buffer_load_dwordx4 v[120:123], v4, s[20:23], s26 offen offset:2048 sc1
    buffer_load_dwordx4 v[124:127], v4, s[20:23], s26 offen offset:3072 sc1
    buffer_load_dwordx4 v[128:131], v5, s[20:23], s26 offen offset:0 sc1
    buffer_load_dwordx4 v[132:135], v5, s[20:23], s26 offen offset:1024 sc1
    buffer_load_dwordx4 v[136:139], v3, s[20:23], s27 offen offset:0 sc1
    buffer_load_dwordx4 v[140:143], v3, s[20:23], s27 offen offset:1024 sc1
    buffer_load_dwordx4 v[144:147], v3, s[20:23], s27 offen offset:2048 sc1
    buffer_load_dwordx4 v[148:151], v3, s[20:23], s27 offen offset:3072 sc1
    buffer_load_dwordx4 v[152:155], v4, s[20:23], s27 offen offset:0 sc1
    buffer_load_dwordx4 v[156:159], v4, s[20:23], s27 offen offset:1024 sc1
    buffer_load_dwordx4 v[160:163], v4, s[20:23], s27 offen offset:2048 sc1
    buffer_load_dwordx4 v[164:167], v4, s[20:23], s27 offen offset:3072 sc1
    buffer_load_dwordx4 v[168:171], v5, s[20:23], s27 offen offset:0 sc1
    buffer_load_dwordx4 v[172:175], v5, s[20:23], s27 offen offset:1024 sc1
    s_waitcnt vmcnt(0)
    v_max_u32 v2, v72, v76
    v_cmp_eq_u32 vcc, -1, v2
    s_cbranch_vccz .hr60b
    s_sub_u32 s60, s60, 1
    s_cmp_lg_u32 s60, 0
    s_cbranch_scc1 .hr60l
    s_branch .hr60b
.hr61:
    s_mov_b32 s60, 200000
.hr61l:
    buffer_load_dwordx4 v[80:83], v4, s[20:23], s25 offen offset:2048 sc1
    buffer_load_dwordx4 v[84:87], v4, s[20:23], s25 offen offset:3072 sc1
    buffer_load_dwordx4 v[88:91], v5, s[20:23], s25 offen offset:0 sc1
    buffer_load_dwordx4 v[92:95], v5, s[20:23], s25 offen offset:1024 sc1
    buffer_load_dwordx4 v[96:99], v3, s[20:23], s26 offen offset:0 sc1
    buffer_load_dwordx4 v[100:103], v3, s[20:23], s26 offen offset:1024 sc1
    buffer_load_dwordx4 v[104:107], v3, s[20:23], s26 offen offset:2048 sc1
    buffer_load_dwordx4 v[108:111], v3, s[20:23], s26 offen offset:3072 sc1
    buffer_load_dwordx4 v[112:115], v4, s[20:23], s26 offen offset:0 sc1
    buffer_load_dwordx4 v[116:119], v4, s[20:23], s26 offen offset:1024 sc1
    buffer_load_dwordx4 v[120:123], v4, s[20:23], s26 offen offset:2048 sc1
    buffer_load_dwordx4 v[124:127], v4, s[20:23], s26 offen offset:3072 sc1
    buffer_load_dwordx4 v[128:131], v5, s[20:23], s26 offen offset:0 sc1
    buffer_load_dwordx4 v[132:135], v5, s[20:23], s26 offen offset:1024 sc1
    buffer_load_dwordx4 v[136:139], v3, s[20:23], s27 offen offset:0 sc1
    buffer_load_dwordx4 v[140:143], v3, s[20:23], s27 offen offset:1024 sc1
    buffer_load_dwordx4 v[144:147], v3, s[20:23], s27 offen offset:2048 sc1
    buffer_load_dwordx4 v[148:151], v3, s[20:23], s27 offen offset:3072 sc1
    buffer_load_dwordx4 v[152:155], v4, s[20:23], s27 offen offset:0 sc1
    buffer_load_dwordx4 v[156:159], v4, s[20:23], s27 offen offset:1024 sc1
    buffer_load_dwordx4 v[160:163], v4, s[20:23], s27 offen offset:2048 sc1
    buffer_load_dwordx4 v[164:167], v4, s[20:23], s27 offen offset:3072 sc1
    buffer_load_dwordx4 v[168:171], v5, s[20:23], s27 offen offset:0 sc1
    buffer_load_dwordx4 v[172:175], v5, s[20:23], s27 offen offset:1024 sc1
    s_waitcnt vmcnt(0)
    v_max_u32 v2, v80, v84
    v_cmp_eq_u32 vcc, -1, v2
    s_cbranch_vccz .hr61b
    s_sub_u32 s60, s60, 1
    s_cmp_lg_u32 s60, 0
    s_cbranch_scc1 .hr61l
    s_branch .hr61b
.hr62:
    s_mov_b32 s60, 200000
.hr62l:
    buffer_load_dwordx4 v[88:91], v5, s[20:23], s25 offen offset:0 sc1
    buffer_load_dwordx4 v[92:95], v5, s[20:23], s25 offen offset:1024 sc1
    buffer_load_dwordx4 v[96:99], v3, s[20:23], s26 offen offset:0 sc1
    buffer_load_dwordx4 v[100:103], v3, s[20:23], s26 offen offset:1024 sc1
    buffer_load_dwordx4 v[104:107], v3, s[20:23], s26 offen offset:2048 sc1
    buffer_load_dwordx4 v[108:111], v3, s[20:23], s26 offen offset:3072 sc1
    buffer_load_dwordx4 v[112:115], v4, s[20:23], s26 offen offset:0 sc1
    buffer_load_dwordx4 v[116:119], v4, s[20:23], s26 offen offset:1024 sc1
    buffer_load_dwordx4 v[120:123], v4, s[20:23], s26 offen offset:2048 sc1
    buffer_load_dwordx4 v[124:127], v4, s[20:23], s26 offen offset:3072 sc1
    buffer_load_dwordx4 v[128:131], v5, s[20:23], s26 offen offset:0 sc1
    buffer_load_dwordx4 v[132:135], v5, s[20:23], s26 offen offset:1024 sc1
    buffer_load_dwordx4 v[136:139], v3, s[20:23], s27 offen offset:0 sc1
    buffer_load_dwordx4 v[140:143], v3, s[20:23], s27 offen offset:1024 sc1
    buffer_load_dwordx4 v[144:147], v3, s[20:23], s27 offen offset:2048 sc1
    buffer_load_dwordx4 v[148:151], v3, s[20:23], s27 offen offset:3072 sc1
    buffer_load_dwordx4 v[152:155], v4, s[20:23], s27 offen offset:0 sc1
    buffer_load_dwordx4 v[156:159], v4, s[20:23], s27 offen offset:1024 sc1
    buffer_load_dwordx4 v[160:163], v4, s[20:23], s27 offen offset:2048 sc1
    buffer_load_dwordx4 v[164:167], v4, s[20:23], s27 offen offset:3072 sc1
    buffer_load_dwordx4 v[168:171], v5, s[20:23], s27 offen offset:0 sc1
    buffer_load_dwordx4 v[172:175], v5, s[20:23], s27 offen offset:1024 sc1
    s_waitcnt vmcnt(0)
    v_max_u32 v2, v88, v92
    v_cmp_eq_u32 vcc, -1, v2
    s_cbranch_vccz .hr62b
    s_sub_u32 s60, s60, 1
    s_cmp_lg_u32 s60, 0
    s_cbranch_scc1 .hr62l
    s_branch .hr62b
.rl63:
    s_mov_b32 s60, 200000
.rl63l:
    buffer_load_dword v239, v238, s[20:23], s56 offen sc1
    s_waitcnt vmcnt(0)
    v_cmp_eq_u32 vcc, -1, v239
    s_cbranch_vccz .rl63b
    s_sub_u32 s60, s60, 1
    s_cmp_lg_u32 s60, 0
    s_cbranch_scc1 .rl63l
    s_branch .rl63b
.hr64:
    s_mov_b32 s60, 200000
.hr64l:
    buffer_load_dwordx4 v[96:99], v3, s[20:23], s26 offen offset:0 sc1
    buffer_load_dwordx4 v[100:103], v3, s[20:23], s26 offen offset:1024 sc1
    buffer_load_dwordx4 v[104:107], v3, s[20:23], s26 offen offset:2048 sc1
    buffer_load_dwordx4 v[108:111], v3, s[20:23], s26 offen offset:3072 sc1
    buffer_load_dwordx4 v[112:115], v4, s[20:23], s26 offen offset:0 sc1
    buffer_load_dwordx4 v[116:119], v4, s[20:23], s26 offen offset:1024 sc1
    buffer_load_dwordx4 v[120:123], v4, s[20:23], s26 offen offset:2048 sc1
    buffer_load_dwordx4 v[124:127], v4, s[20:23], s26 offen offset:3072 sc1
    buffer_load_dwordx4 v[128:131], v5, s[20:23], s26 offen offset:0 sc1
    buffer_load_dwordx4 v[132:135], v5, s[20:23], s26 offen offset:1024 sc1
    buffer_load_dwordx4 v[136:139], v3, s[20:23], s27 offen offset:0 sc1
    buffer_load_dwordx4 v[140:143], v3, s[20:23], s27 offen offset:1024 sc1
    buffer_load_dwordx4 v[144:147], v3, s[20:23], s27 offen offset:2048 sc1
    buffer_load_dwordx4 v[148:151], v3, s[20:23], s27 offen offset:3072 sc1
    buffer_load_dwordx4 v[152:155], v4, s[20:23], s27 offen offset:0 sc1
    buffer_load_dwordx4 v[156:159], v4, s[20:23], s27 offen offset:1024 sc1
    buffer_load_dwordx4 v[160:163], v4, s[20:23], s27 offen offset:2048 sc1
    buffer_load_dwordx4 v[164:167], v4, s[20:23], s27 offen offset:3072 sc1
    buffer_load_dwordx4 v[168:171], v5, s[20:23], s27 offen offset:0 sc1
    buffer_load_dwordx4 v[172:175], v5, s[20:23], s27 offen offset:1024 sc1
    s_waitcnt vmcnt(0)
    v_max_u32 v2, v96, v100
    v_cmp_eq_u32 vcc, -1, v2
    s_cbranch_vccz .hr64b
    s_sub_u32 s60, s60, 1
    s_cmp_lg_u32 s60, 0
    s_cbranch_scc1 .hr64l
    s_branch .hr64b
.hr65:
    s_mov_b32 s60, 200000
.hr65l:
    buffer_load_dwordx4 v[104:107], v3, s[20:23], s26 offen offset:2048 sc1
    buffer_load_dwordx4 v[108:111], v3, s[20:23], s26 offen offset:3072 sc1
    buffer_load_dwordx4 v[112:115], v4, s[20:23], s26 offen offset:0 sc1
    buffer_load_dwordx4 v[116:119], v4, s[20:23], s26 offen offset:1024 sc1
    buffer_load_dwordx4 v[120:123], v4, s[20:23], s26 offen offset:2048 sc1
    buffer_load_dwordx4 v[124:127], v4, s[20:23], s26 offen offset:3072 sc1
    buffer_load_dwordx4 v[128:131], v5, s[20:23], s26 offen offset:0 sc1
    buffer_load_dwordx4 v[132:135], v5, s[20:23], s26 offen offset:1024 sc1
    buffer_load_dwordx4 v[136:139], v3, s[20:23], s27 offen offset:0 sc1
    buffer_load_dwordx4 v[140:143], v3, s[20:23], s27 offen offset:1024 sc1
    buffer_load_dwordx4 v[144:147], v3, s[20:23], s27 offen offset:2048 sc1
    buffer_load_dwordx4 v[148:151], v3, s[20:23], s27 offen offset:3072 sc1
    buffer_load_dwordx4 v[152:155], v4, s[20:23], s27 offen offset:0 sc1
    buffer_load_dwordx4 v[156:159], v4, s[20:23], s27 offen offset:1024 sc1
    buffer_load_dwordx4 v[160:163], v4, s[20:23], s27 offen offset:2048 sc1
    buffer_load_dwordx4 v[164:167], v4, s[20:23], s27 offen offset:3072 sc1
    buffer_load_dwordx4 v[168:171], v5, s[20:23], s27 offen offset:0 sc1
    buffer_load_dwordx4 v[172:175], v5, s[20:23], s27 offen offset:1024 sc1
    s_waitcnt vmcnt(0)
    v_max_u32 v2, v104, v108
    v_cmp_eq_u32 vcc, -1, v2
    s_cbranch_vccz .hr65b
    s_sub_u32 s60, s60, 1
    s_cmp_lg_u32 s60, 0
    s_cbranch_scc1 .hr65l
    s_branch .hr65b
.hr66:
    s_mov_b32 s60, 200000
.hr66l:
    buffer_load_dwordx4 v[112:115], v4, s[20:23], s26 offen offset:0 sc1
    buffer_load_dwordx4 v[116:119], v4, s[20:23], s26 offen offset:1024 sc1
    buffer_load_dwordx4 v[120:123], v4, s[20:23], s26 offen offset:2048 sc1
    buffer_load_dwordx4 v[124:127], v4, s[20:23], s26 offen offset:3072 sc1
    buffer_load_dwordx4 v[128:131], v5, s[20:23], s26 offen offset:0 sc1
    buffer_load_dwordx4 v[132:135], v5, s[20:23], s26 offen offset:1024 sc1
    buffer_load_dwordx4 v[136:139], v3, s[20:23], s27 offen offset:0 sc1
    buffer_load_dwordx4 v[140:143], v3, s[20:23], s27 offen offset:1024 sc1
    buffer_load_dwordx4 v[144:147], v3, s[20:23], s27 offen offset:2048 sc1
    buffer_load_dwordx4 v[148:151], v3, s[20:23], s27 offen offset:3072 sc1
    buffer_load_dwordx4 v[152:155], v4, s[20:23], s27 offen offset:0 sc1
    buffer_load_dwordx4 v[156:159], v4, s[20:23], s27 offen offset:1024 sc1
    buffer_load_dwordx4 v[160:163], v4, s[20:23], s27 offen offset:2048 sc1
    buffer_load_dwordx4 v[164:167], v4, s[20:23], s27 offen offset:3072 sc1
    buffer_load_dwordx4 v[168:171], v5, s[20:23], s27 offen offset:0 sc1
    buffer_load_dwordx4 v[172:175], v5, s[20:23], s27 offen offset:1024 sc1
    s_waitcnt vmcnt(0)
    v_max_u32 v2, v112, v116
    v_cmp_eq_u32 vcc, -1, v2
    s_cbranch_vccz .hr66b
    s_sub_u32 s60, s60, 1
    s_cmp_lg_u32 s60, 0
    s_cbranch_scc1 .hr66l
    s_branch .hr66b
.hr67:
    s_mov_b32 s60, 200000
.hr67l:
    buffer_load_dwordx4 v[120:123], v4, s[20:23], s26 offen offset:2048 sc1
    buffer_load_dwordx4 v[124:127], v4, s[20:23], s26 offen offset:3072 sc1
    buffer_load_dwordx4 v[128:131], v5, s[20:23], s26 offen offset:0 sc1
    buffer_load_dwordx4 v[132:135], v5, s[20:23], s26 offen offset:1024 sc1
    buffer_load_dwordx4 v[136:139], v3, s[20:23], s27 offen offset:0 sc1
    buffer_load_dwordx4 v[140:143], v3, s[20:23], s27 offen offset:1024 sc1
    buffer_load_dwordx4 v[144:147], v3, s[20:23], s27 offen offset:2048 sc1
    buffer_load_dwordx4 v[148:151], v3, s[20:23], s27 offen offset:3072 sc1
    buffer_load_dwordx4 v[152:155], v4, s[20:23], s27 offen offset:0 sc1
    buffer_load_dwordx4 v[156:159], v4, s[20:23], s27 offen offset:1024 sc1
    buffer_load_dwordx4 v[160:163], v4, s[20:23], s27 offen offset:2048 sc1
    buffer_load_dwordx4 v[164:167], v4, s[20:23], s27 offen offset:3072 sc1
    buffer_load_dwordx4 v[168:171], v5, s[20:23], s27 offen offset:0 sc1
    buffer_load_dwordx4 v[172:175], v5, s[20:23], s27 offen offset:1024 sc1
    s_waitcnt vmcnt(0)
    v_max_u32 v2, v120, v124
    v_cmp_eq_u32 vcc, -1, v2
    s_cbranch_vccz .hr67b
    s_sub_u32 s60, s60, 1
    s_cmp_lg_u32 s60, 0
    s_cbranch_scc1 .hr67l
    s_branch .hr67b
.hr68:
    s_mov_b32 s60, 200000
.hr68l:
    buffer_load_dwordx4 v[128:131], v5, s[20:23], s26 offen offset:0 sc1
    buffer_load_dwordx4 v[132:135], v5, s[20:23], s26 offen offset:1024 sc1
    buffer_load_dwordx4 v[136:139], v3, s[20:23], s27 offen offset:0 sc1
    buffer_load_dwordx4 v[140:143], v3, s[20:23], s27 offen offset:1024 sc1
    buffer_load_dwordx4 v[144:147], v3, s[20:23], s27 offen offset:2048 sc1
    buffer_load_dwordx4 v[148:151], v3, s[20:23], s27 offen offset:3072 sc1
    buffer_load_dwordx4 v[152:155], v4, s[20:23], s27 offen offset:0 sc1
    buffer_load_dwordx4 v[156:159], v4, s[20:23], s27 offen offset:1024 sc1
    buffer_load_dwordx4 v[160:163], v4, s[20:23], s27 offen offset:2048 sc1
    buffer_load_dwordx4 v[164:167], v4, s[20:23], s27 offen offset:3072 sc1
    buffer_load_dwordx4 v[168:171], v5, s[20:23], s27 offen offset:0 sc1
    buffer_load_dwordx4 v[172:175], v5, s[20:23], s27 offen offset:1024 sc1
    s_waitcnt vmcnt(0)
    v_max_u32 v2, v128, v132
    v_cmp_eq_u32 vcc, -1, v2
    s_cbranch_vccz .hr68b
    s_sub_u32 s60, s60, 1
    s_cmp_lg_u32 s60, 0
    s_cbranch_scc1 .hr68l
    s_branch .hr68b
.hr69:
    s_mov_b32 s60, 200000
.hr69l:
    buffer_load_dwordx4 v[136:139], v3, s[20:23], s27 offen offset:0 sc1
    buffer_load_dwordx4 v[140:143], v3, s[20:23], s27 offen offset:1024 sc1
    buffer_load_dwordx4 v[144:147], v3, s[20:23], s27 offen offset:2048 sc1
    buffer_load_dwordx4 v[148:151], v3, s[20:23], s27 offen offset:3072 sc1
    buffer_load_dwordx4 v[152:155], v4, s[20:23], s27 offen offset:0 sc1
    buffer_load_dwordx4 v[156:159], v4, s[20:23], s27 offen offset:1024 sc1
    buffer_load_dwordx4 v[160:163], v4, s[20:23], s27 offen offset:2048 sc1
    buffer_load_dwordx4 v[164:167], v4, s[20:23], s27 offen offset:3072 sc1
    buffer_load_dwordx4 v[168:171], v5, s[20:23], s27 offen offset:0 sc1
    buffer_load_dwordx4 v[172:175], v5, s[20:23], s27 offen offset:1024 sc1
    s_waitcnt vmcnt(0)
    v_max_u32 v2, v136, v140
    v_cmp_eq_u32 vcc, -1, v2
    s_cbranch_vccz .hr69b
    s_sub_u32 s60, s60, 1
    s_cmp_lg_u32 s60, 0
    s_cbranch_scc1 .hr69l
    s_branch .hr69b
.hr70:
    s_mov_b32 s60, 200000
.hr70l:
    buffer_load_dwordx4 v[144:147], v3, s[20:23], s27 offen offset:2048 sc1
    buffer_load_dwordx4 v[148:151], v3, s[20:23], s27 offen offset:3072 sc1
    buffer_load_dwordx4 v[152:155], v4, s[20:23], s27 offen offset:0 sc1
    buffer_load_dwordx4 v[156:159], v4, s[20:23], s27 offen offset:1024 sc1
    buffer_load_dwordx4 v[160:163], v4, s[20:23], s27 offen offset:2048 sc1
    buffer_load_dwordx4 v[164:167], v4, s[20:23], s27 offen offset:3072 sc1
    buffer_load_dwordx4 v[168:171], v5, s[20:23], s27 offen offset:0 sc1
    buffer_load_dwordx4 v[172:175], v5, s[20:23], s27 offen offset:1024 sc1
    s_waitcnt vmcnt(0)
    v_max_u32 v2, v144, v148
    v_cmp_eq_u32 vcc, -1, v2
    s_cbranch_vccz .hr70b
    s_sub_u32 s60, s60, 1
    s_cmp_lg_u32 s60, 0
    s_cbranch_scc1 .hr70l
    s_branch .hr70b
.hr71:
    s_mov_b32 s60, 200000
.hr71l:
    buffer_load_dwordx4 v[152:155], v4, s[20:23], s27 offen offset:0 sc1
    buffer_load_dwordx4 v[156:159], v4, s[20:23], s27 offen offset:1024 sc1
    buffer_load_dwordx4 v[160:163], v4, s[20:23], s27 offen offset:2048 sc1
    buffer_load_dwordx4 v[164:167], v4, s[20:23], s27 offen offset:3072 sc1
    buffer_load_dwordx4 v[168:171], v5, s[20:23], s27 offen offset:0 sc1
    buffer_load_dwordx4 v[172:175], v5, s[20:23], s27 offen offset:1024 sc1
    s_waitcnt vmcnt(0)
    v_max_u32 v2, v152, v156
    v_cmp_eq_u32 vcc, -1, v2
    s_cbranch_vccz .hr71b
    s_sub_u32 s60, s60, 1
    s_cmp_lg_u32 s60, 0
    s_cbranch_scc1 .hr71l
    s_branch .hr71b
.hr72:
    s_mov_b32 s60, 200000
.hr72l:
    buffer_load_dwordx4 v[160:163], v4, s[20:23], s27 offen offset:2048 sc1
    buffer_load_dwordx4 v[164:167], v4, s[20:23], s27 offen offset:3072 sc1
    buffer_load_dwordx4 v[168:171], v5, s[20:23], s27 offen offset:0 sc1
    buffer_load_dwordx4 v[172:175], v5, s[20:23], s27 offen offset:1024 sc1
    s_waitcnt vmcnt(0)
    v_max_u32 v2, v160, v164
    v_cmp_eq_u32 vcc, -1, v2
    s_cbranch_vccz .hr72b
    s_sub_u32 s60, s60, 1
    s_cmp_lg_u32 s60, 0
    s_cbranch_scc1 .hr72l
    s_branch .hr72b
.hr73:
    s_mov_b32 s60, 200000
.hr73l:
    buffer_load_dwordx4 v[168:171], v5, s[20:23], s27 offen offset:0 sc1
    buffer_load_dwordx4 v[172:175], v5, s[20:23], s27 offen offset:1024 sc1
    s_waitcnt vmcnt(0)
    v_max_u32 v2, v168, v172
    v_cmp_eq_u32 vcc, -1, v2
    s_cbranch_vccz .hr73b
    s_sub_u32 s60, s60, 1
    s_cmp_lg_u32 s60, 0
    s_cbranch_scc1 .hr73l
    s_branch .hr73b
.rl74:
    s_mov_b32 s60, 200000
.rl74l:
    buffer_load_dword v2, v13, s[20:23], s11 offen offset:0 sc1
    s_waitcnt vmcnt(0)
    v_cmp_eq_u32 vcc, -1, v2
    s_cbranch_vccz .rl74b
    s_sub_u32 s60, s60, 1
    s_cmp_lg_u32 s60, 0
    s_cbranch_scc1 .rl74l
    s_branch .rl74b
.g3r75:
    s_mov_b32 s60, 200000
.g3r75l:
    s_sub_u32 s61, s40, 4096
    buffer_load_dwordx4 a[228:231], v8, s[20:23], s61 offen sc1
    s_sub_u32 s61, s41, 4096
    buffer_load_dwordx4 a[232:235], v8, s[20:23], s61 offen sc1
    s_sub_u32 s61, s42, 4096
    buffer_load_dwordx4 a[236:239], v8, s[20:23], s61 offen sc1
    s_sub_u32 s61, s43, 4096
    buffer_load_dwordx4 a[240:243], v8, s[20:23], s61 offen sc1
    s_waitcnt vmcnt(0)
    v_accvgpr_read_b32 v5, a228
    v_accvgpr_read_b32 v2, a232
    v_max_u32 v5, v5, v2
    v_accvgpr_read_b32 v2, a236
    v_max_u32 v5, v5, v2
    v_accvgpr_read_b32 v2, a240
    v_max_u32 v5, v5, v2
    v_cmp_eq_u32 vcc, -1, v5
    s_cbranch_vccz .g3r75b
    s_sub_u32 s60, s60, 1
    s_cmp_lg_u32 s60, 0
    s_cbranch_scc1 .g3r75l
    s_branch .g3r75b
.g3r76:
    s_mov_b32 s60, 200000
.g3r76l:
    s_sub_u32 s61, s40, 4096
    buffer_load_dwordx4 a[244:247], v9, s[20:23], s61 offen sc1
    s_sub_u32 s61, s41, 4096
    buffer_load_dwordx4 a[248:251], v9, s[20:23], s61 offen sc1
    s_sub_u32 s61, s42, 4096
    buffer_load_dwordx4 a[252:255], v9, s[20:23], s61 offen sc1
    s_sub_u32 s61, s43, 4096
    buffer_load_dwordx4 v[232:235], v9, s[20:23], s61 offen sc1
    s_waitcnt vmcnt(0)
    v_accvgpr_read_b32 v5, a244
    v_accvgpr_read_b32 v2, a248
    v_max3_u32 v5, v5, v2, v232
    v_accvgpr_read_b32 v2, a252
    v_max_u32 v5, v5, v2
    v_cmp_eq_u32 vcc, -1, v5
    s_cbranch_vccz .g3r76b
    s_sub_u32 s60, s60, 1
    s_cmp_lg_u32 s60, 0
    s_cbranch_scc1 .g3r76l
    s_branch .g3r76b
.g3r77:
    s_mov_b32 s60, 200000
.g3r77l:
    s_sub_u32 s61, s40, 8192
    buffer_load_dwordx4 v[20:23], v10, s[20:23], s61 offen sc1
    s_sub_u32 s61, s41, 4096
    buffer_load_dwordx4 v[24:27], v10, s[20:23], s61 offen sc1
    s_sub_u32 s61, s42, 4096
    buffer_load_dwordx4 v[28:31], v10, s[20:23], s61 offen sc1
    s_sub_u32 s61, s43, 4096
    buffer_load_dwordx4 v[32:35], v10, s[20:23], s61 offen sc1
    s_waitcnt vmcnt(0)
    v_max3_u32 v5, v32, v28, v24
    v_max_u32 v5, v5, v20
    v_cmp_eq_u32 vcc, -1, v5
    s_cbranch_vccz .g3r77b
    s_sub_u32 s60, s60, 1
    s_cmp_lg_u32 s60, 0
    s_cbranch_scc1 .g3r77l
    s_branch .g3r77b
.g3r78:
    s_mov_b32 s60, 200000
.g3r78l:
    s_sub_u32 s61, s40, 8192
    buffer_load_dwordx4 v[40:43], v11, s[20:23], s61 offen sc1
    s_sub_u32 s61, s41, 8192
    buffer_load_dwordx4 v[44:47], v11, s[20:23], s61 offen sc1
    s_sub_u32 s61, s42, 8192
    buffer_load_dwordx4 v[48:51], v11, s[20:23], s61 offen sc1
    s_sub_u32 s61, s43, 8192
    buffer_load_dwordx4 v[52:55], v11, s[20:23], s61 offen sc1
    s_waitcnt vmcnt(0)
    v_max3_u32 v5, v52, v48, v44
    v_max_u32 v5, v5, v40
    v_cmp_eq_u32 vcc, -1, v5
    s_cbranch_vccz .g3r78b
    s_sub_u32 s60, s60, 1
    s_cmp_lg_u32 s60, 0
    s_cbranch_scc1 .g3r78l
    s_branch .g3r78b
.g3r79:
    s_mov_b32 s60, 200000
.g3r79l:
    s_sub_u32 s61, s40, 4096
    buffer_load_dwordx4 v[60:63], v8, s[20:23], s61 offen sc1
    s_sub_u32 s61, s41, 4096
    buffer_load_dwordx4 v[64:67], v8, s[20:23], s61 offen sc1
    s_sub_u32 s61, s42, 4096
    buffer_load_dwordx4 v[68:71], v8, s[20:23], s61 offen sc1
    s_sub_u32 s61, s43, 4096
    buffer_load_dwordx4 v[72:75], v8, s[20:23], s61 offen sc1
    s_waitcnt vmcnt(0)
    v_max3_u32 v5, v72, v68, v64
    v_max_u32 v5, v5, v60
    v_cmp_eq_u32 vcc, -1, v5
    s_cbranch_vccz .g3r79b
    s_sub_u32 s60, s60, 1
    s_cmp_lg_u32 s60, 0
    s_cbranch_scc1 .g3r79l
    s_branch .g3r79b
.g3r80:
    s_mov_b32 s60, 200000
.g3r80l:
    s_sub_u32 s61, s40, 4096
    buffer_load_dwordx4 v[80:83], v9, s[20:23], s61 offen sc1
    s_sub_u32 s61, s41, 4096
    buffer_load_dwordx4 v[84:87], v9, s[20:23], s61 offen sc1
    s_sub_u32 s61, s42, 4096
    buffer_load_dwordx4 v[88:91], v9, s[20:23], s61 offen sc1
    s_sub_u32 s61, s43, 4096
    buffer_load_dwordx4 v[92:95], v9, s[20:23], s61 offen sc1
    s_waitcnt vmcnt(0)
    v_max3_u32 v5, v92, v88, v84
    v_max_u32 v5, v5, v80
    v_cmp_eq_u32 vcc, -1, v5
    s_cbranch_vccz .g3r80b
    s_sub_u32 s60, s60, 1
    s_cmp_lg_u32 s60, 0
    s_cbranch_scc1 .g3r80l
    s_branch .g3r80b
.g3r81:
    s_mov_b32 s60, 200000
.g3r81l:
    s_sub_u32 s61, s40, 8192
    buffer_load_dwordx4 v[96:99], v10, s[20:23], s61 offen sc1
    s_sub_u32 s61, s41, 4096
    buffer_load_dwordx4 v[100:103], v10, s[20:23], s61 offen sc1
    s_sub_u32 s61, s42, 4096
    buffer_load_dwordx4 v[104:107], v10, s[20:23], s61 offen sc1
    s_sub_u32 s61, s43, 4096
    buffer_load_dwordx4 v[108:111], v10, s[20:23], s61 offen sc1
    s_waitcnt vmcnt(0)
    v_max3_u32 v5, v108, v104, v100
    v_max_u32 v5, v5, v96
    v_cmp_eq_u32 vcc, -1, v5
    s_cbranch_vccz .g3r81b
    s_sub_u32 s60, s60, 1
    s_cmp_lg_u32 s60, 0
    s_cbranch_scc1 .g3r81l
    s_branch .g3r81b
.g3r82:
    s_mov_b32 s60, 200000
.g3r82l:
    s_sub_u32 s61, s40, 8192
    buffer_load_dwordx4 v[112:115], v11, s[20:23], s61 offen sc1
    s_sub_u32 s61, s41, 8192
    buffer_load_dwordx4 v[176:179], v11, s[20:23], s61 offen sc1
    s_sub_u32 s61, s42, 8192
    buffer_load_dwordx4 v[180:183], v11, s[20:23], s61 offen sc1
    s_sub_u32 s61, s43, 8192
    buffer_load_dwordx4 v[184:187], v11, s[20:23], s61 offen sc1
    s_waitcnt vmcnt(0)
    v_max3_u32 v5, v184, v180, v176
    v_max_u32 v5, v5, v112
    v_cmp_eq_u32 vcc, -1, v5
    s_cbranch_vccz .g3r82b
    s_sub_u32 s60, s60, 1
    s_cmp_lg_u32 s60, 0
    s_cbranch_scc1 .g3r82l
    s_branch .g3r82b
.g3r83:
    s_mov_b32 s60, 200000
.g3r83l:
    s_sub_u32 s61, s40, 4096
    buffer_load_dwordx4 v[188:191], v8, s[20:23], s61 offen sc1
    s_sub_u32 s61, s41, 4096
    buffer_load_dwordx4 v[116:119], v8, s[20:23], s61 offen sc1
    s_sub_u32 s61, s42, 4096
    buffer_load_dwordx4 v[120:123], v8, s[20:23], s61 offen sc1
    s_sub_u32 s61, s43, 4096
    buffer_load_dwordx4 v[124:127], v8, s[20:23], s61 offen sc1
    s_waitcnt vmcnt(0)
    v_max3_u32 v5, v124, v120, v116
    v_max_u32 v5, v5, v188
    v_cmp_eq_u32 vcc, -1, v5
    s_cbranch_vccz .g3r83b
    s_sub_u32 s60, s60, 1
    s_cmp_lg_u32 s60, 0
    s_cbranch_scc1 .g3r83l
    s_branch .g3r83b
.g3r84:
    s_mov_b32 s60, 200000
.g3r84l:
    s_sub_u32 s61, s40, 4096
    buffer_load_dwordx4 v[128:131], v9, s[20:23], s61 offen sc1
    s_sub_u32 s61, s41, 4096
    buffer_load_dwordx4 v[132:135], v9, s[20:23], s61 offen sc1
    s_sub_u32 s61, s42, 4096
    buffer_load_dwordx4 v[136:139], v9, s[20:23], s61 offen sc1
    s_sub_u32 s61, s43, 4096
    buffer_load_dwordx4 v[140:143], v9, s[20:23], s61 offen sc1
    s_waitcnt vmcnt(0)
    v_max3_u32 v5, v140, v136, v132
    v_max_u32 v5, v5, v128
    v_cmp_eq_u32 vcc, -1, v5
    s_cbranch_vccz .g3r84b
    s_sub_u32 s60, s60, 1
    s_cmp_lg_u32 s60, 0
    s_cbranch_scc1 .g3r84l
    s_branch .g3r84b
.g3r85:
    s_mov_b32 s60, 200000
.g3r85l:
    s_sub_u32 s61, s40, 4096
    buffer_load_dwordx4 v[144:147], v10, s[20:23], s61 offen sc1
    s_sub_u32 s61, s41, 4096
    buffer_load_dwordx4 v[148:151], v10, s[20:23], s61 offen sc1
    s_sub_u32 s61, s42, 4096
    buffer_load_dwordx4 v[152:155], v10, s[20:23], s61 offen sc1
    s_sub_u32 s61, s43, 4096
    buffer_load_dwordx4 v[156:159], v10, s[20:23], s61 offen sc1
    s_waitcnt vmcnt(0)
    v_max3_u32 v5, v156, v152, v148
    v_max_u32 v5, v5, v144
    v_cmp_eq_u32 vcc, -1, v5
    s_cbranch_vccz .g3r85b
    s_sub_u32 s60, s60, 1
    s_cmp_lg_u32 s60, 0
    s_cbranch_scc1 .g3r85l
    s_branch .g3r85b
.g3r86:
    s_mov_b32 s60, 200000
.g3r86l:
    s_sub_u32 s61, s40, 4096
    buffer_load_dwordx4 v[160:163], v11, s[20:23], s61 offen sc1
    s_sub_u32 s61, s41, 4096
    buffer_load_dwordx4 v[164:167], v11, s[20:23], s61 offen sc1
    s_sub_u32 s61, s42, 4096
    buffer_load_dwordx4 v[168:171], v11, s[20:23], s61 offen sc1
    s_sub_u32 s61, s43, 4096
    buffer_load_dwordx4 v[172:175], v11, s[20:23], s61 offen sc1
    s_waitcnt vmcnt(0)
    v_max3_u32 v5, v172, v168, v164
    v_max_u32 v5, v5, v160
    v_cmp_eq_u32 vcc, -1, v5
    s_cbranch_vccz .g3r86b
    s_sub_u32 s60, s60, 1
    s_cmp_lg_u32 s60, 0
    s_cbranch_scc1 .g3r86l
    s_branch .g3r86b
.g3r87:
    s_mov_b32 s60, 200000
.g3r87l:
    buffer_load_dwordx2 v[192:193], v12, s[20:23], s40 offen offset:0 sc1
    buffer_load_dwordx2 v[194:195], v12, s[20:23], s40 offen offset:512 sc1
    buffer_load_dwordx2 v[196:197], v12, s[20:23], s40 offen offset:1024 sc1
    buffer_load_dwordx2 v[200:201], v12, s[20:23], s41 offen offset:0 sc1
    buffer_load_dwordx2 v[202:203], v12, s[20:23], s41 offen offset:512 sc1
    buffer_load_dwordx2 v[198:199], v12, s[20:23], s41 offen offset:1024 sc1
    buffer_load_dwordx2 v[204:205], v12, s[20:23], s42 offen offset:0 sc1
    buffer_load_dwordx2 v[206:207], v12, s[20:23], s42 offen offset:512 sc1
    buffer_load_dwordx2 v[232:233], v12, s[20:23], s42 offen offset:1024 sc1
    buffer_load_dwordx2 v[208:209], v12, s[20:23], s43 offen offset:0 sc1
    buffer_load_dwordx2 v[210:211], v12, s[20:23], s43 offen offset:512 sc1
    buffer_load_dwordx2 v[234:235], v12, s[20:23], s43 offen offset:1024 sc1
    s_waitcnt vmcnt(0)
    v_max3_u32 v5, v234, v210, v208
    v_max3_u32 v5, v5, v232, v206
    v_max3_u32 v5, v5, v204, v198
    v_max3_u32 v5, v5, v202, v200
    v_max3_u32 v5, v5, v196, v194
    v_max_u32 v5, v5, v192
    v_cmp_eq_u32 vcc, -1, v5
    s_cbranch_vccz .g3r87b
    s_sub_u32 s60, s60, 1
    s_cmp_lg_u32 s60, 0
    s_cbranch_scc1 .g3r87l
    s_branch .g3r87b
.Lfz_end:
    s_endpgm
.section .rodata,"a"
.p2align 6
.amdhsa_kernel sequential_preLN__ssm_conv_h3__swiglu_ffn__prompt_kernel
  .amdhsa_next_free_vgpr 512
  .amdhsa_next_free_sgpr 102
  .amdhsa_accum_offset 256
  .amdhsa_group_segment_fixed_size 0
  .amdhsa_kernarg_size 104
  .amdhsa_user_sgpr_count 2
  .amdhsa_user_sgpr_kernarg_segment_ptr 1
  .amdhsa_system_sgpr_workgroup_id_x 1
.end_amdhsa_kernel
```
